```python
import torch

def _softmax(x, axis=-1):
    return torch.softmax(x, dim=axis)
def _gelu(x):
    return torch.nn.functional.gelu(x, approximate="tanh")
def _silu(x):
    return torch.nn.functional.silu(x)
def _sigmoid(x):
    return torch.sigmoid(x)
def _layernorm(x, axis=-1, eps=1e-5):
    m = x.mean(dim=axis, keepdim=True)
    v = x.var(dim=axis, keepdim=True, unbiased=False)
    return (x - m) / torch.sqrt(v + eps)
def _scatter_add(tgt, idx, src, axis=0):
    return tgt.clone().index_add_(axis, idx, src)
def _segment_sum(src, seg, n):
    out = torch.zeros((n,) + src.shape[1:], dtype=src.dtype)
    return out.index_add_(0, seg, src)
def _pad(x, pw):
    flat = tuple(v for pair in reversed(pw) for v in pair)
    return torch.nn.functional.pad(x, flat)

kernel_name = 'recurrent_scan__sliding_local_dilated__dense_activation_gelu__prompt'

def setup_inputs():

    _w = (lambda a: (lambda t: t.to(torch.bfloat16) if t.is_floating_point() else t)(torch.as_tensor(a)))
    def _A_setup():
        B, S, D = 1, 2048, 576
        return {
            "x": _w((lambda *s: torch.randn(*s, dtype=torch.bfloat16) * 0.05)(B, S, D)),
            "wqkv": _w((lambda *s: torch.randn(*s, dtype=torch.bfloat16) * 0.2)(D, 3 * D)),
            "wo": _w((lambda *s: torch.randn(*s, dtype=torch.bfloat16) * 0.2)(D, D)),
        }
    _A_in = _A_setup()

    def _B_setup():
        B, S, D, F = 1, 2048, 576, 4608
        return {
            "x": _w((lambda *s: torch.randn(*s, dtype=torch.bfloat16) * 0.05)(B, S, D)),
            "w1": _w((lambda *s: torch.randn(*s, dtype=torch.bfloat16) * 0.8)(D, F) * (D ** -0.5)),
            "b1": _w((lambda *s: torch.randn(*s, dtype=torch.bfloat16) * 0.8)(F) * 0.01),
            "w2": _w((lambda *s: torch.randn(*s, dtype=torch.bfloat16) * 0.1)(F, D) * (F ** -0.5)),
            "b2": _w((lambda *s: torch.randn(*s, dtype=torch.bfloat16) * 0.1)(D) * 0.01),
        }
    _B_in = _B_setup()

    return {
        "A_x": _A_in["x"],
        "A_wqkv": _A_in["wqkv"],
        "A_wo": _A_in["wo"],
        "B_x": _B_in["x"],
        "B_w1": _B_in["w1"],
        "B_b1": _B_in["b1"],
        "B_w2": _B_in["w2"],
        "B_b2": _B_in["b2"],
    }

def reference(A_x, A_wqkv, A_wo, B_x, B_w1, B_b1, B_w2, B_b2):
    def _A_ref(x, wqkv, wo):
        B, S, D = x.shape
        H = 32; Dh = D // H
        W, dil = 8, 2
        qkv = (lambda x, *d: x.permute(*d))((x @ wqkv).reshape(B, S, 3, H, Dh), 2, 0, 3, 1, 4)
        q, k, v = qkv[0], qkv[1], qkv[2]
        scale = Dh ** -0.5
        pos = torch.arange(S)
        off = torch.arange(W) * dil
        idx = pos[:, None] - off[None, :]
        mask = idx >= 0
        idx_c = torch.where(mask, idx, 0).reshape(-1)
        kg = k[:, :, idx_c, :].reshape(B, H, S, W, Dh)
        vg = v[:, :, idx_c, :].reshape(B, H, S, W, Dh)
        logits = torch.einsum("bhsd,bhswd->bhsw", q, kg) * scale
        logits = torch.where(mask[None, None, :, :], logits, -1e9)
        attn = _softmax(logits, axis=-1)
        o = torch.einsum("bhsw,bhswd->bhsd", attn, vg)
        return (lambda x, *d: x.permute(*d))(o, 0, 2, 1, 3).reshape(B, S, D) @ wo

    def _B_ref(x, w1, b1, w2, b2):
        h = torch.einsum("bsd,df->bsf", x, w1) + b1
        h = _gelu(h)
        return torch.einsum("bsf,fd->bsd", h, w2) + b2

    x = A_x
    xn = _layernorm(x, axis=-1)
    s = _A_ref(xn, A_wqkv, A_wo)
    g = _silu(_B_ref(xn, B_w1, B_b1, B_w2, B_b2))
    return x + s * g
```

```asm
; @launch kernel=k1_kernel grid=(256,1,1) block=(512,1,1) lds=163840
; @launch kernel=k3_kernel grid=(256,1,1) block=(512,1,1) lds=163840
.amdgcn_target "amdgcn-amd-amdhsa--gfx950"
.text
.globl k1_kernel
.p2align 8
.type k1_kernel,@function
k1_kernel:
    s_cmp_ge_u32 s2, 256
    s_cbranch_scc1 L_k1end_1
    s_load_dwordx2 s[4:5], s[0:1], 0
    s_load_dwordx2 s[6:7], s[0:1], 8
    s_load_dwordx2 s[8:9], s[0:1], 32
    s_load_dwordx2 s[10:11], s[0:1], 40
    s_load_dwordx2 s[12:13], s[0:1], 80
    s_load_dwordx2 s[14:15], s[0:1], 16
    s_load_dwordx2 s[28:29], s[0:1], 48
    v_lshrrev_b32 v1, 6, v0
    v_and_b32 v2, 63, v0
    s_and_b32 s40, s2, 7
    v_readfirstlane_b32 s3, v1
    s_lshl_b32 s40, s40, 5
    s_lshr_b32 s41, s2, 3
    s_add_u32 s40, s40, s41
    s_mul_i32 s41, s40, 6554
    s_lshr_b32 s41, s41, 16
    s_mul_i32 s42, s41, 10
    s_sub_u32 s42, s40, s42
    s_min_u32 s43, s42, 4
    s_mul_i32 s44, s42, 6
    s_add_u32 s43, s43, s44
    s_cmp_lt_u32 s42, 4
    s_cselect_b32 s44, 7, 6
    s_lshl_b32 s45, s41, 3
    s_add_u32 s45, s45, s3
    s_waitcnt lgkmcnt(0)

    s_cmp_lg_u32 s2, 0
    s_cbranch_scc1 L_k1nz_3
    s_add_u32 s16, s12, 104857600
    s_addc_u32 s17, s13, 0
    v_lshlrev_b32 v3, 4, v0
    v_mov_b32 v4, 0
    v_mov_b32 v5, 0
    v_mov_b32 v6, 0
    v_mov_b32 v7, 0
    global_store_dwordx4 v3, v[4:7], s[16:17]
    s_nop 1
L_k1nz_3:

    s_mov_b32 s16, s4
    s_and_b32 s17, s5, 0xffff
    s_mov_b32 s18, 2359296
    s_mov_b32 s19, 0x00020000
    s_and_b32 s54, s3, 3
    s_lshr_b32 s55, s3, 2
    v_lshrrev_b32 v3, 3, v2
    s_lshl_b32 s56, s54, 3
    v_add_u32 v3, s56, v3
    v_mul_u32_u24 v11, 1152, v3
    v_lshrrev_b32 v3, 4, v2
    v_lshlrev_b32 v3, 1, v3
    s_and_b32 s56, s54, 1
    v_or_b32 v3, s56, v3
    v_and_b32 v4, 7, v2
    v_xor_b32 v3, v3, v4
    v_lshl_add_u32 v11, v3, 4, v11
    s_lshl_b32 s56, s55, 7
    v_add_u32 v11, s56, v11
    s_lshl_b32 s47, s55, 12
    s_lshl_b32 s56, s54, 10
    s_add_u32 s47, s47, s56
    s_mul_i32 s49, s43, 36864
    s_cmp_ge_u32 s40, 250
    s_cbranch_scc1 L_k1idle_2

    s_add_u32 m0, s47, 0
    s_nop 0
    buffer_load_dwordx4 v11, s[16:19], s49 offen offset:0 lds
    s_add_u32 m0, s47, 7936
    s_nop 0
    buffer_load_dwordx4 v11, s[16:19], s49 offen offset:256 lds
    s_add_u32 m0, s47, 15872
    s_nop 0
    buffer_load_dwordx4 v11, s[16:19], s49 offen offset:512 lds
    s_add_u32 m0, s47, 23808
    s_nop 0
    buffer_load_dwordx4 v11, s[16:19], s49 offen offset:768 lds
    s_add_u32 m0, s47, 31744
    s_nop 0
    buffer_load_dwordx4 v11, s[16:19], s49 offen offset:1024 lds
    s_add_u32 s49, s49, 36864
    s_mul_i32 s57, s41, 6
    s_add_u32 s57, s57, s42
    s_sub_u32 s57, s57, 4

    s_mov_b32 s36, s10
    s_and_b32 s37, s11, 0xffff
    s_mov_b32 s38, 9216
    s_mov_b32 s39, 0x00020000
    s_cmp_ge_u32 s45, 54
    s_cbranch_scc1 L_isw1_4

    s_mov_b32 s20, s6
    s_and_b32 s21, s7, 0xffff
    s_mov_b32 s22, 1990656
    s_mov_b32 s23, 0x00020000
    s_add_u32 s32, s12, 0
    s_addc_u32 s33, s13, 0
    s_and_b32 s33, s33, 0xffff
    s_mov_b32 s34, 7077888
    s_mov_b32 s35, 0x00020000
    s_mov_b32 s24, 3456
    s_mov_b32 s46, s45
    s_branch L_wdone_5
L_isw1_4:

    s_mov_b32 s20, s8
    s_and_b32 s21, s9, 0xffff
    s_mov_b32 s22, 5308416
    s_mov_b32 s23, 0x00020000
    s_add_u32 s32, s12, 16777216
    s_addc_u32 s33, s13, 0
    s_and_b32 s33, s33, 0xffff
    s_mov_b32 s34, 18874368
    s_mov_b32 s35, 0x00020000
    s_mov_b32 s24, 9216
    s_sub_u32 s46, s45, 54
L_wdone_5:
    s_lshl_b32 s25, s24, 4
    v_lshrrev_b32 v3, 2, v2
    v_and_b32 v3, 7, v3
    s_and_b32 s54, s3, 1
    s_lshl_b32 s55, s54, 3
    v_add_u32 v3, s55, v3
    v_mul_lo_u32 v10, s24, v3
    v_lshrrev_b32 v4, 5, v2
    v_lshl_add_u32 v10, v4, 6, v10
    v_and_b32 v3, 3, v2
    v_lshl_add_u32 v10, v3, 4, v10
    s_lshr_b32 s55, s46, 1
    s_lshl_b32 s55, s55, 7
    v_add_u32 v10, s55, v10
    s_lshr_b32 s55, s3, 1
    s_lshl_b32 s48, s55, 11
    s_lshl_b32 s56, s54, 10
    s_add_u32 s48, s48, s56
    s_mov_b32 s26, 0

    s_add_u32 m0, s48, 40960
    s_nop 0
    buffer_load_dwordx4 v10, s[20:23], s26 offen lds
    s_add_u32 s26, s26, s25
    s_add_u32 m0, s48, 49152
    s_nop 0
    buffer_load_dwordx4 v10, s[20:23], s26 offen lds
    s_add_u32 s26, s26, s25
    s_add_u32 m0, s48, 57344
    s_nop 0
    buffer_load_dwordx4 v10, s[20:23], s26 offen lds
    s_add_u32 s26, s26, s25
    s_add_u32 m0, s48, 65536
    s_nop 0
    buffer_load_dwordx4 v10, s[20:23], s26 offen lds
    s_add_u32 s26, s26, s25
    v_min_u32 v44, 38, v2
    s_mul_i32 s55, s42, 39
    s_add_u32 s55, s55, 192
    v_add_u32 v44, s55, v44
    v_mul_lo_u32 v44, s24, v44
    s_lshl_b32 s55, s46, 6
    v_add_u32 v44, s55, v44
    buffer_load_dword v44, v44, s[20:23], 0 offen

    s_add_u32 m0, s48, 73728
    s_nop 0
    buffer_load_dwordx4 v10, s[20:23], s26 offen lds
    s_add_u32 s26, s26, s25
    s_add_u32 m0, s48, 81920
    s_nop 0
    buffer_load_dwordx4 v10, s[20:23], s26 offen lds
    s_add_u32 s26, s26, s25
    s_add_u32 m0, s48, 90112
    s_nop 0
    buffer_load_dwordx4 v10, s[20:23], s26 offen lds
    s_add_u32 s26, s26, s25
    s_add_u32 m0, s48, 98304
    s_nop 0
    buffer_load_dwordx4 v10, s[20:23], s26 offen lds
    s_add_u32 s26, s26, s25
    s_add_u32 m0, s48, 106496
    s_nop 0
    buffer_load_dwordx4 v10, s[20:23], s26 offen lds
    s_add_u32 s26, s26, s25
    s_add_u32 m0, s48, 114688
    s_nop 0
    buffer_load_dwordx4 v10, s[20:23], s26 offen lds
    s_add_u32 s26, s26, s25
    s_add_u32 m0, s48, 122880
    s_nop 0
    buffer_load_dwordx4 v10, s[20:23], s26 offen lds
    s_add_u32 s26, s26, s25
    s_add_u32 m0, s48, 131072
    s_nop 0
    buffer_load_dwordx4 v10, s[20:23], s26 offen lds
    s_add_u32 s26, s26, s25
    v_and_b32 v3, 31, v2
    s_lshl_b32 s55, s46, 6
    v_and_b32 v7, 19, v3
    v_and_b32 v1, 4, v3
    v_lshl_or_b32 v7, v1, 1, v7
    v_and_b32 v1, 8, v3
    v_lshrrev_b32 v1, 1, v1
    v_or_b32 v7, v7, v1
    v_lshl_add_u32 v7, v7, 1, s55
    buffer_load_ushort v7, v7, s[36:39], 0 offen

    s_mul_i32 s60, s2, 27648
    s_add_u32 s60, s60, 67108864
    s_add_u32 s60, s60, s12
    s_addc_u32 s61, s13, 0
    s_and_b32 s61, s61, 0xffff
    s_mov_b32 s62, 27648
    s_mov_b32 s63, 0x00020000
    v_mov_b32 v36, -1
    v_mov_b32 v37, -1
    v_mov_b32 v38, -1
    v_mov_b32 v39, -1
    v_lshlrev_b32 v40, 4, v0
    s_mov_b32 s58, 8192
    s_mov_b32 s59, 16384
    v_add_u32 v41, 24576, v40

    v_lshrrev_b32 v9, 4, v2
    v_and_b32 v9, 1, v9
    v_lshlrev_b32 v9, 5, v9
    v_and_b32 v1, 1, v2
    v_lshl_add_u32 v9, v1, 4, v9
    v_and_b32 v1, 2, v2
    v_lshl_add_u32 v9, v1, 2, v9
    v_lshrrev_b32 v1, 2, v2
    v_and_b32 v1, 3, v1
    v_lshl_add_u32 v9, v1, 6, v9
    v_lshl_add_u32 v9, v4, 10, v9
    s_lshr_b32 s55, s3, 1
    s_lshl_b32 s55, s55, 11
    s_lshl_b32 s56, s54, 9
    s_add_u32 s55, s55, s56
    s_add_u32 s55, s55, 40960
    v_add_u32 v9, s55, v9
    v_add_u32 v8, 0x10000, v9
    v_lshlrev_b32 v12, 4, v3
    v_lshl_add_u32 v12, v4, 15, v12
    v_lshlrev_b32 v13, 4, v3
    v_add_u32 v13, 155648, v13
    v_lshrrev_b32 v1, 4, v2
    s_lshl_b32 s55, s3, 2
    v_add_u32 v1, s55, v1
    v_lshlrev_b32 v14, 4, v1
    v_add_u32 v14, 155648, v14
    v_lshrrev_b32 v15, 3, v1
    v_lshlrev_b32 v15, 10, v15
    v_and_b32 v1, 7, v1
    v_lshl_add_u32 v15, v1, 7, v15
    v_and_b32 v1, 15, v2
    v_lshl_add_u32 v15, v1, 3, v15
    v_lshrrev_b32 v1, 1, v3
    v_and_b32 v1, 3, v1
    v_lshlrev_b32 v1, 1, v1
    v_lshrrev_b32 v5, 3, v3
    v_and_b32 v6, 1, v5
    v_or_b32 v1, v1, v6
    v_lshlrev_b32 v5, 10, v5
    v_and_b32 v6, 7, v3
    v_lshl_add_u32 v5, v6, 7, v5

    v_add_u32 v6, 0, v4
    v_xor_b32 v6, v6, v1
    v_lshl_add_u32 v16, v6, 4, v5

    v_add_u32 v6, 2, v4
    v_xor_b32 v6, v6, v1
    v_lshl_add_u32 v17, v6, 4, v5

    v_add_u32 v6, 4, v4
    v_xor_b32 v6, v6, v1
    v_lshl_add_u32 v18, v6, 4, v5

    v_add_u32 v6, 6, v4
    v_xor_b32 v6, v6, v1
    v_lshl_add_u32 v19, v6, 4, v5

    s_lshl_b32 s50, s46, 17
    s_lshl_b32 s55, s43, 9
    s_add_u32 s50, s50, s55
    s_add_u32 s51, s50, 0x10000
    s_cmp_lt_u32 s45, 198
    s_cselect_b32 s34, s34, 0
    s_mov_b32 s54, 0x3f803f80
    s_mov_b32 s64, 0
    s_mov_b32 s65, -1
    v_mov_b32 v5, 0
    v_mov_b32 v6, 0

    s_cmp_ge_u32 s45, 54
    s_cbranch_scc1 L_hpath_6

    s_waitcnt vmcnt(12) lgkmcnt(0)
    s_barrier
    s_add_u32 m0, s48, 139264
    s_nop 0
    buffer_load_dwordx4 v10, s[20:23], s26 offen lds
    s_add_u32 s26, s26, s25
    s_add_u32 m0, s48, 147456
    s_nop 0
    buffer_load_dwordx4 v10, s[20:23], s26 offen lds
    s_add_u32 s26, s26, s25
    ds_read_b64_tr_b16 v[112:113], v9 offset:0
    ds_read_b64_tr_b16 v[114:115], v9 offset:256
    ds_read_b128 v[64:67], v16 offset:0
    ds_read_b64_tr_b16 v[116:117], v9 offset:8192
    ds_read_b64_tr_b16 v[118:119], v9 offset:8448
    ds_read_b128 v[68:71], v17 offset:0
    ds_read_b64 v[24:25], v15 offset:0
    s_waitcnt vmcnt(12) lgkmcnt(0)
    s_barrier
    s_add_u32 m0, s48, 40960
    s_nop 0
    buffer_load_dwordx4 v10, s[20:23], s26 offen lds
    s_add_u32 s26, s26, s25
    s_add_u32 m0, s48, 49152
    s_nop 0
    buffer_load_dwordx4 v10, s[20:23], s26 offen lds
    s_add_u32 s26, s26, s25
    ds_read_b64_tr_b16 v[120:121], v9 offset:16384
    ds_read_b64_tr_b16 v[122:123], v9 offset:16640
    ds_read_b128 v[72:75], v18 offset:0
    ds_read_b64_tr_b16 v[124:125], v9 offset:24576
    ds_read_b64_tr_b16 v[126:127], v9 offset:24832
    ds_read_b128 v[76:79], v19 offset:0
    v_dot2_f32_bf16 v5, v112, s54, v5
    v_dot2_f32_bf16 v6, v113, s54, v6
    v_dot2_f32_bf16 v5, v114, s54, v5
    v_dot2_f32_bf16 v6, v115, s54, v6
    v_dot2_f32_bf16 v5, v116, s54, v5
    v_dot2_f32_bf16 v6, v117, s54, v6
    v_dot2_f32_bf16 v5, v118, s54, v5
    v_dot2_f32_bf16 v6, v119, s54, v6
    v_dot2_f32_bf16 v20, v24, s54, 0
    v_dot2_f32_bf16 v21, v24, v24, 0
    v_dot2_f32_bf16 v22, v25, s54, 0
    v_dot2_f32_bf16 v23, v25, v25, 0
    v_mfma_f32_32x32x16_bf16 v[80:95], v[112:115], v[64:67], 0
    v_mfma_f32_32x32x16_bf16 v[80:95], v[116:119], v[68:71], v[80:95]
    ds_read_b64 v[26:27], v15 offset:4096
    s_waitcnt vmcnt(11) lgkmcnt(0)
    s_barrier
    s_add_u32 m0, s48, 57344
    s_nop 0
    buffer_load_dwordx4 v10, s[20:23], s26 offen lds
    s_add_u32 s26, s26, s25
    s_add_u32 m0, s48, 65536
    s_nop 0
    buffer_load_dwordx4 v10, s[20:23], s26 offen lds
    s_add_u32 s26, s26, s25
    ds_read_b64_tr_b16 v[128:129], v9 offset:32768
    ds_read_b64_tr_b16 v[130:131], v9 offset:33024
    ds_read_b128 v[64:67], v16 offset:4096
    ds_read_b64_tr_b16 v[132:133], v9 offset:40960
    ds_read_b64_tr_b16 v[134:135], v9 offset:41216
    ds_read_b128 v[68:71], v17 offset:4096
    v_dot2_f32_bf16 v5, v120, s54, v5
    v_dot2_f32_bf16 v6, v121, s54, v6
    v_dot2_f32_bf16 v5, v122, s54, v5
    v_dot2_f32_bf16 v6, v123, s54, v6
    v_dot2_f32_bf16 v5, v124, s54, v5
    v_dot2_f32_bf16 v6, v125, s54, v6
    v_dot2_f32_bf16 v5, v126, s54, v5
    v_dot2_f32_bf16 v6, v127, s54, v6
    v_dot2_f32_bf16 v20, v26, s54, v20
    v_dot2_f32_bf16 v21, v26, v26, v21
    v_dot2_f32_bf16 v22, v27, s54, v22
    v_dot2_f32_bf16 v23, v27, v27, v23
    v_mfma_f32_32x32x16_bf16 v[80:95], v[120:123], v[72:75], v[80:95]
    v_mfma_f32_32x32x16_bf16 v[80:95], v[124:127], v[76:79], v[80:95]
    ds_read_b64 v[28:29], v15 offset:8192
    s_waitcnt vmcnt(11) lgkmcnt(0)
    s_barrier
    s_add_u32 m0, s48, 73728
    s_nop 0
    buffer_load_dwordx4 v10, s[20:23], s26 offen lds
    s_add_u32 s26, s26, s25
    s_add_u32 m0, s48, 81920
    s_nop 0
    buffer_load_dwordx4 v10, s[20:23], s26 offen lds
    s_add_u32 s26, s26, s25
    buffer_store_dwordx4 v[36:39], v40, s[60:63], 0 offen sc1
    ds_read_b64_tr_b16 v[136:137], v9 offset:49152
    ds_read_b64_tr_b16 v[138:139], v9 offset:49408
    ds_read_b128 v[72:75], v18 offset:4096
    ds_read_b64_tr_b16 v[140:141], v9 offset:57344
    ds_read_b64_tr_b16 v[142:143], v9 offset:57600
    ds_read_b128 v[76:79], v19 offset:4096
    v_dot2_f32_bf16 v5, v128, s54, v5
    v_dot2_f32_bf16 v6, v129, s54, v6
    v_dot2_f32_bf16 v5, v130, s54, v5
    v_dot2_f32_bf16 v6, v131, s54, v6
    v_dot2_f32_bf16 v5, v132, s54, v5
    v_dot2_f32_bf16 v6, v133, s54, v6
    v_dot2_f32_bf16 v5, v134, s54, v5
    v_dot2_f32_bf16 v6, v135, s54, v6
    v_dot2_f32_bf16 v20, v28, s54, v20
    v_dot2_f32_bf16 v21, v28, v28, v21
    v_dot2_f32_bf16 v22, v29, s54, v22
    v_dot2_f32_bf16 v23, v29, v29, v23
    v_mfma_f32_32x32x16_bf16 v[80:95], v[128:131], v[64:67], v[80:95]
    v_mfma_f32_32x32x16_bf16 v[80:95], v[132:135], v[68:71], v[80:95]
    ds_read_b64 v[30:31], v15 offset:12288
    s_waitcnt vmcnt(12) lgkmcnt(0)
    s_barrier
    s_add_u32 m0, s48, 90112
    s_nop 0
    buffer_load_dwordx4 v10, s[20:23], s26 offen lds
    s_add_u32 s26, s26, s25
    s_add_u32 m0, s48, 98304
    s_nop 0
    buffer_load_dwordx4 v10, s[20:23], s26 offen lds
    s_add_u32 s26, s26, s25
    ds_read_b64_tr_b16 v[144:145], v8 offset:0
    ds_read_b64_tr_b16 v[146:147], v8 offset:256
    ds_read_b128 v[64:67], v16 offset:8192
    ds_read_b64_tr_b16 v[148:149], v8 offset:8192
    ds_read_b64_tr_b16 v[150:151], v8 offset:8448
    ds_read_b128 v[68:71], v17 offset:8192
    v_dot2_f32_bf16 v5, v136, s54, v5
    v_dot2_f32_bf16 v6, v137, s54, v6
    v_dot2_f32_bf16 v5, v138, s54, v5
    v_dot2_f32_bf16 v6, v139, s54, v6
    v_dot2_f32_bf16 v5, v140, s54, v5
    v_dot2_f32_bf16 v6, v141, s54, v6
    v_dot2_f32_bf16 v5, v142, s54, v5
    v_dot2_f32_bf16 v6, v143, s54, v6
    v_dot2_f32_bf16 v20, v30, s54, v20
    v_dot2_f32_bf16 v21, v30, v30, v21
    v_dot2_f32_bf16 v22, v31, s54, v22
    v_dot2_f32_bf16 v23, v31, v31, v23
    v_mfma_f32_32x32x16_bf16 v[80:95], v[136:139], v[72:75], v[80:95]
    v_mfma_f32_32x32x16_bf16 v[80:95], v[140:143], v[76:79], v[80:95]
    ds_read_b64 v[32:33], v15 offset:16384
    s_waitcnt vmcnt(12) lgkmcnt(0)
    s_barrier
    s_add_u32 m0, s48, 106496
    s_nop 0
    buffer_load_dwordx4 v10, s[20:23], s26 offen lds
    s_add_u32 s26, s26, s25
    s_add_u32 m0, s48, 114688
    s_nop 0
    buffer_load_dwordx4 v10, s[20:23], s26 offen lds
    s_add_u32 s26, s26, s25
    buffer_store_dwordx4 v[36:39], v40, s[60:63], s58 offen sc1
    ds_read_b64_tr_b16 v[152:153], v8 offset:16384
    ds_read_b64_tr_b16 v[154:155], v8 offset:16640
    ds_read_b128 v[72:75], v18 offset:8192
    ds_read_b64_tr_b16 v[156:157], v8 offset:24576
    ds_read_b64_tr_b16 v[158:159], v8 offset:24832
    ds_read_b128 v[76:79], v19 offset:8192
    v_dot2_f32_bf16 v5, v144, s54, v5
    v_dot2_f32_bf16 v6, v145, s54, v6
    v_dot2_f32_bf16 v5, v146, s54, v5
    v_dot2_f32_bf16 v6, v147, s54, v6
    v_dot2_f32_bf16 v5, v148, s54, v5
    v_dot2_f32_bf16 v6, v149, s54, v6
    v_dot2_f32_bf16 v5, v150, s54, v5
    v_dot2_f32_bf16 v6, v151, s54, v6
    v_dot2_f32_bf16 v20, v32, s54, v20
    v_dot2_f32_bf16 v21, v32, v32, v21
    v_dot2_f32_bf16 v22, v33, s54, v22
    v_dot2_f32_bf16 v23, v33, v33, v23
    v_mfma_f32_32x32x16_bf16 v[80:95], v[144:147], v[64:67], v[80:95]
    v_mfma_f32_32x32x16_bf16 v[80:95], v[148:151], v[68:71], v[80:95]
    ds_read_b64 v[34:35], v15 offset:20480
    s_waitcnt vmcnt(12) lgkmcnt(0)
    s_barrier
    s_add_u32 m0, s48, 122880
    s_nop 0
    buffer_load_dwordx4 v10, s[20:23], s26 offen lds
    s_add_u32 s26, s26, s25
    s_add_u32 m0, s48, 131072
    s_nop 0
    buffer_load_dwordx4 v10, s[20:23], s26 offen lds
    s_add_u32 s26, s26, s25
    ds_read_b64_tr_b16 v[160:161], v8 offset:32768
    ds_read_b64_tr_b16 v[162:163], v8 offset:33024
    ds_read_b128 v[64:67], v16 offset:12288
    ds_read_b64_tr_b16 v[164:165], v8 offset:40960
    ds_read_b64_tr_b16 v[166:167], v8 offset:41216
    ds_read_b128 v[68:71], v17 offset:12288
    v_dot2_f32_bf16 v5, v152, s54, v5
    v_dot2_f32_bf16 v6, v153, s54, v6
    v_dot2_f32_bf16 v5, v154, s54, v5
    v_dot2_f32_bf16 v6, v155, s54, v6
    v_dot2_f32_bf16 v5, v156, s54, v5
    v_dot2_f32_bf16 v6, v157, s54, v6
    v_dot2_f32_bf16 v5, v158, s54, v5
    v_dot2_f32_bf16 v6, v159, s54, v6
    v_dot2_f32_bf16 v20, v34, s54, v20
    v_dot2_f32_bf16 v21, v34, v34, v21
    v_dot2_f32_bf16 v22, v35, s54, v22
    v_dot2_f32_bf16 v23, v35, v35, v23
    v_mfma_f32_32x32x16_bf16 v[80:95], v[152:155], v[72:75], v[80:95]
    v_mfma_f32_32x32x16_bf16 v[80:95], v[156:159], v[76:79], v[80:95]
    ds_read_b64 v[24:25], v15 offset:24576
    s_waitcnt vmcnt(12) lgkmcnt(0)
    s_barrier
    s_add_u32 m0, s48, 139264
    s_nop 0
    buffer_load_dwordx4 v10, s[20:23], s26 offen lds
    s_add_u32 s26, s26, s25
    s_add_u32 m0, s48, 147456
    s_nop 0
    buffer_load_dwordx4 v10, s[20:23], s26 offen lds
    s_add_u32 s26, s26, s25
    buffer_store_dwordx4 v[36:39], v40, s[60:63], s59 offen sc1
    ds_read_b64_tr_b16 v[168:169], v9 offset:0
    ds_read_b64_tr_b16 v[170:171], v9 offset:256
    ds_read_b128 v[72:75], v18 offset:12288
    ds_read_b64_tr_b16 v[172:173], v9 offset:8192
    ds_read_b64_tr_b16 v[174:175], v9 offset:8448
    ds_read_b128 v[76:79], v19 offset:12288
    v_dot2_f32_bf16 v5, v160, s54, v5
    v_dot2_f32_bf16 v6, v161, s54, v6
    v_dot2_f32_bf16 v5, v162, s54, v5
    v_dot2_f32_bf16 v6, v163, s54, v6
    v_dot2_f32_bf16 v5, v164, s54, v5
    v_dot2_f32_bf16 v6, v165, s54, v6
    v_dot2_f32_bf16 v5, v166, s54, v5
    v_dot2_f32_bf16 v6, v167, s54, v6
    v_dot2_f32_bf16 v20, v24, s54, v20
    v_dot2_f32_bf16 v21, v24, v24, v21
    v_dot2_f32_bf16 v22, v25, s54, v22
    v_dot2_f32_bf16 v23, v25, v25, v23
    v_mfma_f32_32x32x16_bf16 v[80:95], v[160:163], v[64:67], v[80:95]
    v_mfma_f32_32x32x16_bf16 v[80:95], v[164:167], v[68:71], v[80:95]
    ds_read_b64 v[26:27], v15 offset:28672
    s_waitcnt vmcnt(13) lgkmcnt(0)
    s_barrier
    s_add_u32 m0, s48, 40960
    s_nop 0
    buffer_load_dwordx4 v10, s[20:23], s26 offen lds
    s_add_u32 s26, s26, s25
    s_add_u32 m0, s48, 49152
    s_nop 0
    buffer_load_dwordx4 v10, s[20:23], s26 offen lds
    s_add_u32 s26, s26, s25
    ds_read_b64_tr_b16 v[176:177], v9 offset:16384
    ds_read_b64_tr_b16 v[178:179], v9 offset:16640
    ds_read_b128 v[64:67], v16 offset:16384
    ds_read_b64_tr_b16 v[180:181], v9 offset:24576
    ds_read_b64_tr_b16 v[182:183], v9 offset:24832
    ds_read_b128 v[68:71], v17 offset:16384
    v_dot2_f32_bf16 v5, v168, s54, v5
    v_dot2_f32_bf16 v6, v169, s54, v6
    v_dot2_f32_bf16 v5, v170, s54, v5
    v_dot2_f32_bf16 v6, v171, s54, v6
    v_dot2_f32_bf16 v5, v172, s54, v5
    v_dot2_f32_bf16 v6, v173, s54, v6
    v_dot2_f32_bf16 v5, v174, s54, v5
    v_dot2_f32_bf16 v6, v175, s54, v6
    v_dot2_f32_bf16 v20, v26, s54, v20
    v_dot2_f32_bf16 v21, v26, v26, v21
    v_dot2_f32_bf16 v22, v27, s54, v22
    v_dot2_f32_bf16 v23, v27, v27, v23
    v_mfma_f32_32x32x16_bf16 v[80:95], v[168:171], v[72:75], v[80:95]
    v_mfma_f32_32x32x16_bf16 v[80:95], v[172:175], v[76:79], v[80:95]
    ds_read_b64 v[28:29], v15 offset:32768
    s_waitcnt vmcnt(13) lgkmcnt(0)
    s_barrier
    s_add_u32 m0, s48, 57344
    s_nop 0
    buffer_load_dwordx4 v10, s[20:23], s26 offen lds
    s_add_u32 s26, s26, s25
    s_add_u32 m0, s48, 65536
    s_nop 0
    buffer_load_dwordx4 v10, s[20:23], s26 offen lds
    s_add_u32 s26, s26, s25
    buffer_store_dwordx4 v[36:39], v41, s[60:63], 0 offen sc1
    ds_read_b64_tr_b16 v[184:185], v9 offset:32768
    ds_read_b64_tr_b16 v[186:187], v9 offset:33024
    ds_read_b128 v[72:75], v18 offset:16384
    ds_read_b64_tr_b16 v[188:189], v9 offset:40960
    ds_read_b64_tr_b16 v[190:191], v9 offset:41216
    ds_read_b128 v[76:79], v19 offset:16384
    v_dot2_f32_bf16 v5, v176, s54, v5
    v_dot2_f32_bf16 v6, v177, s54, v6
    v_dot2_f32_bf16 v5, v178, s54, v5
    v_dot2_f32_bf16 v6, v179, s54, v6
    v_dot2_f32_bf16 v5, v180, s54, v5
    v_dot2_f32_bf16 v6, v181, s54, v6
    v_dot2_f32_bf16 v5, v182, s54, v5
    v_dot2_f32_bf16 v6, v183, s54, v6
    v_dot2_f32_bf16 v20, v28, s54, v20
    v_dot2_f32_bf16 v21, v28, v28, v21
    v_dot2_f32_bf16 v22, v29, s54, v22
    v_dot2_f32_bf16 v23, v29, v29, v23
    v_mfma_f32_32x32x16_bf16 v[80:95], v[176:179], v[64:67], v[80:95]
    v_mfma_f32_32x32x16_bf16 v[80:95], v[180:183], v[68:71], v[80:95]
    s_waitcnt vmcnt(13) lgkmcnt(0)
    s_barrier
    s_add_u32 m0, s48, 73728
    s_nop 0
    buffer_load_dwordx4 v10, s[20:23], s26 offen lds
    s_add_u32 s26, s26, s25
    s_add_u32 m0, s48, 81920
    s_nop 0
    buffer_load_dwordx4 v10, s[20:23], s26 offen lds
    s_add_u32 s26, s26, s25
    ds_read_b64_tr_b16 v[192:193], v9 offset:49152
    ds_read_b64_tr_b16 v[194:195], v9 offset:49408
    ds_read_b128 v[64:67], v16 offset:20480
    ds_read_b64_tr_b16 v[196:197], v9 offset:57344
    ds_read_b64_tr_b16 v[198:199], v9 offset:57600
    ds_read_b128 v[68:71], v17 offset:20480
    v_dot2_f32_bf16 v5, v184, s54, v5
    v_dot2_f32_bf16 v6, v185, s54, v6
    v_dot2_f32_bf16 v5, v186, s54, v5
    v_dot2_f32_bf16 v6, v187, s54, v6
    v_dot2_f32_bf16 v5, v188, s54, v5
    v_dot2_f32_bf16 v6, v189, s54, v6
    v_dot2_f32_bf16 v5, v190, s54, v5
    v_dot2_f32_bf16 v6, v191, s54, v6
    v_mfma_f32_32x32x16_bf16 v[80:95], v[184:187], v[72:75], v[80:95]
    v_mfma_f32_32x32x16_bf16 v[80:95], v[188:191], v[76:79], v[80:95]
    v_add_f32 v20, v20, v22
    v_add_f32 v21, v21, v23
    s_nop 0
    v_add_f32_dpp v20, v20, v20 row_ror:8 row_mask:0xf bank_mask:0xf
    v_add_f32_dpp v21, v21, v21 row_ror:8 row_mask:0xf bank_mask:0xf
    s_waitcnt vmcnt(13) lgkmcnt(0)
    s_barrier
    s_add_u32 m0, s48, 90112
    s_nop 0
    buffer_load_dwordx4 v10, s[20:23], s26 offen lds
    s_add_u32 s26, s26, s25
    s_add_u32 m0, s48, 98304
    s_nop 0
    buffer_load_dwordx4 v10, s[20:23], s26 offen lds
    s_add_u32 s26, s26, s25
    ds_read_b64_tr_b16 v[200:201], v8 offset:0
    ds_read_b64_tr_b16 v[202:203], v8 offset:256
    ds_read_b128 v[72:75], v18 offset:20480
    ds_read_b64_tr_b16 v[204:205], v8 offset:8192
    ds_read_b64_tr_b16 v[206:207], v8 offset:8448
    ds_read_b128 v[76:79], v19 offset:20480
    v_dot2_f32_bf16 v5, v192, s54, v5
    v_dot2_f32_bf16 v6, v193, s54, v6
    v_dot2_f32_bf16 v5, v194, s54, v5
    v_dot2_f32_bf16 v6, v195, s54, v6
    v_dot2_f32_bf16 v5, v196, s54, v5
    v_dot2_f32_bf16 v6, v197, s54, v6
    v_dot2_f32_bf16 v5, v198, s54, v5
    v_dot2_f32_bf16 v6, v199, s54, v6
    v_mfma_f32_32x32x16_bf16 v[80:95], v[192:195], v[64:67], v[80:95]
    v_mfma_f32_32x32x16_bf16 v[80:95], v[196:199], v[68:71], v[80:95]
    v_add_f32_dpp v20, v20, v20 row_ror:4 row_mask:0xf bank_mask:0xf
    v_add_f32_dpp v21, v21, v21 row_ror:4 row_mask:0xf bank_mask:0xf
    s_nop 0
    v_add_f32_dpp v20, v20, v20 row_ror:2 row_mask:0xf bank_mask:0xf
    v_add_f32_dpp v21, v21, v21 row_ror:2 row_mask:0xf bank_mask:0xf
    s_waitcnt vmcnt(12) lgkmcnt(0)
    s_barrier
    ds_read_b64_tr_b16 v[208:209], v8 offset:16384
    ds_read_b64_tr_b16 v[210:211], v8 offset:16640
    ds_read_b128 v[64:67], v16 offset:24576
    ds_read_b64_tr_b16 v[212:213], v8 offset:24576
    ds_read_b64_tr_b16 v[214:215], v8 offset:24832
    ds_read_b128 v[68:71], v17 offset:24576
    v_dot2_f32_bf16 v5, v200, s54, v5
    v_dot2_f32_bf16 v6, v201, s54, v6
    v_dot2_f32_bf16 v5, v202, s54, v5
    v_dot2_f32_bf16 v6, v203, s54, v6
    v_dot2_f32_bf16 v5, v204, s54, v5
    v_dot2_f32_bf16 v6, v205, s54, v6
    v_dot2_f32_bf16 v5, v206, s54, v5
    v_dot2_f32_bf16 v6, v207, s54, v6
    v_mfma_f32_32x32x16_bf16 v[80:95], v[200:203], v[72:75], v[80:95]
    v_mfma_f32_32x32x16_bf16 v[80:95], v[204:207], v[76:79], v[80:95]
    v_add_f32_dpp v20, v20, v20 row_ror:1 row_mask:0xf bank_mask:0xf
    v_add_f32_dpp v21, v21, v21 row_ror:1 row_mask:0xf bank_mask:0xf
    v_mul_f32 v20, 0x3ae38e39, v20
    v_mul_f32 v21, 0x3ae38e39, v21
    s_waitcnt vmcnt(10) lgkmcnt(0)
    s_barrier
    ds_read_b64_tr_b16 v[216:217], v8 offset:32768
    ds_read_b64_tr_b16 v[218:219], v8 offset:33024
    ds_read_b128 v[72:75], v18 offset:24576
    ds_read_b64_tr_b16 v[220:221], v8 offset:40960
    ds_read_b64_tr_b16 v[222:223], v8 offset:41216
    ds_read_b128 v[76:79], v19 offset:24576
    v_dot2_f32_bf16 v5, v208, s54, v5
    v_dot2_f32_bf16 v6, v209, s54, v6
    v_dot2_f32_bf16 v5, v210, s54, v5
    v_dot2_f32_bf16 v6, v211, s54, v6
    v_dot2_f32_bf16 v5, v212, s54, v5
    v_dot2_f32_bf16 v6, v213, s54, v6
    v_dot2_f32_bf16 v5, v214, s54, v5
    v_dot2_f32_bf16 v6, v215, s54, v6
    v_mfma_f32_32x32x16_bf16 v[80:95], v[208:211], v[64:67], v[80:95]
    v_mfma_f32_32x32x16_bf16 v[80:95], v[212:215], v[68:71], v[80:95]
    v_fma_f32 v21, -v20, v20, v21
    v_max_f32 v21, 0, v21
    v_add_f32 v21, 0x3727c5ac, v21
    v_rsq_f32 v26, v21
    s_waitcnt vmcnt(7) lgkmcnt(0)
    s_barrier
    s_add_u32 m0, s47, 106496
    s_nop 0
    buffer_load_dwordx4 v11, s[16:19], s49 offen offset:0 lds
    s_add_u32 m0, s47, 114432
    s_nop 0
    buffer_load_dwordx4 v11, s[16:19], s49 offen offset:256 lds
    s_add_u32 m0, s47, 122368
    s_nop 0
    buffer_load_dwordx4 v11, s[16:19], s49 offen offset:512 lds
    s_add_u32 m0, s47, 130304
    s_nop 0
    buffer_load_dwordx4 v11, s[16:19], s49 offen offset:768 lds
    s_add_u32 m0, s47, 138240
    s_nop 0
    buffer_load_dwordx4 v11, s[16:19], s49 offen offset:1024 lds
    s_add_u32 s49, s49, 36864
    ds_read_b64_tr_b16 v[224:225], v9 offset:0
    ds_read_b64_tr_b16 v[226:227], v9 offset:256
    ds_read_b128 v[64:67], v16 offset:28672
    ds_read_b64_tr_b16 v[228:229], v9 offset:8192
    ds_read_b64_tr_b16 v[230:231], v9 offset:8448
    ds_read_b128 v[68:71], v17 offset:28672
    v_dot2_f32_bf16 v5, v216, s54, v5
    v_dot2_f32_bf16 v6, v217, s54, v6
    v_dot2_f32_bf16 v5, v218, s54, v5
    v_dot2_f32_bf16 v6, v219, s54, v6
    v_dot2_f32_bf16 v5, v220, s54, v5
    v_dot2_f32_bf16 v6, v221, s54, v6
    v_dot2_f32_bf16 v5, v222, s54, v5
    v_dot2_f32_bf16 v6, v223, s54, v6
    v_mfma_f32_32x32x16_bf16 v[80:95], v[216:219], v[72:75], v[80:95]
    v_mfma_f32_32x32x16_bf16 v[80:95], v[220:223], v[76:79], v[80:95]
    v_mul_f32 v27, v21, v26
    v_cvt_pk_bf16_f32 v24, -v20, v27
    v_lshlrev_b32 v28, 16, v24
    v_and_b32 v29, 0xffff0000, v24
    s_waitcnt vmcnt(10) lgkmcnt(0)
    s_barrier
    ds_read_b64_tr_b16 v[232:233], v9 offset:16384
    ds_read_b64_tr_b16 v[234:235], v9 offset:16640
    ds_read_b128 v[72:75], v18 offset:28672
    ds_read_b64_tr_b16 v[236:237], v9 offset:24576
    ds_read_b64_tr_b16 v[238:239], v9 offset:24832
    ds_read_b128 v[76:79], v19 offset:28672
    v_dot2_f32_bf16 v5, v224, s54, v5
    v_dot2_f32_bf16 v6, v225, s54, v6
    v_dot2_f32_bf16 v5, v226, s54, v5
    v_dot2_f32_bf16 v6, v227, s54, v6
    v_dot2_f32_bf16 v5, v228, s54, v5
    v_dot2_f32_bf16 v6, v229, s54, v6
    v_dot2_f32_bf16 v5, v230, s54, v5
    v_dot2_f32_bf16 v6, v231, s54, v6
    v_mfma_f32_32x32x16_bf16 v[80:95], v[224:227], v[64:67], v[80:95]
    v_mfma_f32_32x32x16_bf16 v[80:95], v[228:231], v[68:71], v[80:95]
    v_sub_f32 v28, -v20, v28
    v_sub_f32 v29, v27, v29
    v_cvt_pk_bf16_f32 v25, v28, v29
    ds_write_b128 v14, v[24:27] offset:0
    s_waitcnt vmcnt(7) lgkmcnt(0)
    s_barrier
    ds_read_b64_tr_b16 v[240:241], v9 offset:32768
    ds_read_b64_tr_b16 v[242:243], v9 offset:33024
    ds_read_b128 v[64:67], v16 offset:32768
    ds_read_b64_tr_b16 v[244:245], v9 offset:40960
    ds_read_b64_tr_b16 v[246:247], v9 offset:41216
    ds_read_b128 v[68:71], v17 offset:32768
    v_dot2_f32_bf16 v5, v232, s54, v5
    v_dot2_f32_bf16 v6, v233, s54, v6
    v_dot2_f32_bf16 v5, v234, s54, v5
    v_dot2_f32_bf16 v6, v235, s54, v6
    v_dot2_f32_bf16 v5, v236, s54, v5
    v_dot2_f32_bf16 v6, v237, s54, v6
    v_dot2_f32_bf16 v5, v238, s54, v5
    v_dot2_f32_bf16 v6, v239, s54, v6
    v_mfma_f32_32x32x16_bf16 v[80:95], v[232:235], v[72:75], v[80:95]
    v_mfma_f32_32x32x16_bf16 v[80:95], v[236:239], v[76:79], v[80:95]
    s_waitcnt vmcnt(5) lgkmcnt(0)
    s_barrier
    ds_read_b64_tr_b16 v[248:249], v9 offset:49152
    ds_read_b64_tr_b16 v[250:251], v9 offset:49408
    ds_read_b128 v[72:75], v18 offset:32768
    ds_read_b64_tr_b16 v[252:253], v9 offset:57344
    ds_read_b64_tr_b16 v[254:255], v9 offset:57600
    ds_read_b128 v[76:79], v19 offset:32768
    v_dot2_f32_bf16 v5, v240, s54, v5
    v_dot2_f32_bf16 v6, v241, s54, v6
    v_dot2_f32_bf16 v5, v242, s54, v5
    v_dot2_f32_bf16 v6, v243, s54, v6
    v_dot2_f32_bf16 v5, v244, s54, v5
    v_dot2_f32_bf16 v6, v245, s54, v6
    v_dot2_f32_bf16 v5, v246, s54, v5
    v_dot2_f32_bf16 v6, v247, s54, v6
    v_mfma_f32_32x32x16_bf16 v[80:95], v[240:243], v[64:67], v[80:95]
    v_mfma_f32_32x32x16_bf16 v[80:95], v[244:247], v[68:71], v[80:95]
    s_waitcnt vmcnt(0) lgkmcnt(0)
    s_barrier
    s_cmp_le_u32 s44, 2
    s_cbranch_scc1 L_nox_7
    s_add_u32 m0, s47, 40960
    s_nop 0
    buffer_load_dwordx4 v11, s[16:19], s49 offen offset:0 lds
    s_add_u32 m0, s47, 48896
    s_nop 0
    buffer_load_dwordx4 v11, s[16:19], s49 offen offset:256 lds
    s_add_u32 m0, s47, 56832
    s_nop 0
    buffer_load_dwordx4 v11, s[16:19], s49 offen offset:512 lds
    s_add_u32 m0, s47, 64768
    s_nop 0
    buffer_load_dwordx4 v11, s[16:19], s49 offen offset:768 lds
    s_add_u32 m0, s47, 72704
    s_nop 0
    buffer_load_dwordx4 v11, s[16:19], s49 offen offset:1024 lds
    s_add_u32 s49, s49, 36864
L_nox_7:
    ds_read_b128 v[52:55], v13 offset:0
    v_add_u32 v16, 0x1a000, v16
    v_add_u32 v17, 0x1a000, v17
    v_add_u32 v18, 0x1a000, v18
    v_add_u32 v19, 0x1a000, v19
    v_add_u32 v15, 0x1a000, v15
    ds_read_b128 v[64:67], v16 offset:0
    ds_read_b128 v[68:71], v17 offset:0
    v_mfma_f32_32x32x16_bf16 v[80:95], v[248:251], v[72:75], v[80:95]
    v_dot2_f32_bf16 v5, v248, s54, v5
    v_dot2_f32_bf16 v6, v249, s54, v6
    v_dot2_f32_bf16 v5, v250, s54, v5
    v_dot2_f32_bf16 v6, v251, s54, v6
    ds_read_b128 v[72:75], v18 offset:0
    v_mfma_f32_32x32x16_bf16 v[80:95], v[252:255], v[76:79], v[80:95]
    v_dot2_f32_bf16 v5, v252, s54, v5
    v_dot2_f32_bf16 v6, v253, s54, v6
    v_dot2_f32_bf16 v5, v254, s54, v5
    v_dot2_f32_bf16 v6, v255, s54, v6
    s_nop 3
    v_add_f32 v5, v5, v6
    v_mov_b32 v6, v5
    s_nop 1
    v_permlane32_swap_b32 v5, v6
    s_nop 1
    v_add_f32 v5, v5, v6
    v_cvt_pk_bf16_f32 v6, v5, v5
    v_lshlrev_b32 v1, 16, v6
    v_sub_f32 v1, v5, v1
    v_cvt_pk_bf16_f32 v1, v1, v1
    v_and_b32 v1, 0xffff, v1
    v_and_b32 v6, 0xffff, v6

    v_cndmask_b32 v62, v6, v1, s[64:65]
    v_cndmask_b32 v63, v6, v1, s[64:65]

    ds_read_b128 v[76:79], v19 offset:0
    s_waitcnt lgkmcnt(3)
    v_mfma_f32_32x32x16_bf16 v[96:111], v[112:115], v[64:67], 0
    ds_read_b64 v[24:25], v15 offset:0
    ds_read_b64 v[26:27], v15 offset:4096
    ds_read_b64 v[28:29], v15 offset:8192
    ds_read_b128 v[64:67], v16 offset:4096
    s_waitcnt lgkmcnt(6)
    v_mfma_f32_32x32x16_bf16 v[96:111], v[116:119], v[68:71], v[96:111]
    v_mfma_f32_32x32x8bf16_1k v[80:95], v[62:63], v[52:53], v[80:95]
    ds_read_b64 v[30:31], v15 offset:12288
    ds_read_b64 v[32:33], v15 offset:16384
    ds_read_b64 v[34:35], v15 offset:20480
    ds_read_b128 v[68:71], v17 offset:4096
    s_waitcnt lgkmcnt(9)
    v_mfma_f32_32x32x16_bf16 v[96:111], v[120:123], v[72:75], v[96:111]
    ds_read_b64 v[2:3], v15 offset:24576
    ds_read_b64 v[4:5], v15 offset:28672
    ds_read_b64 v[6:7], v15 offset:32768
    ds_read_b128 v[72:75], v18 offset:4096
    s_waitcnt lgkmcnt(12)
    v_mfma_f32_32x32x16_bf16 v[96:111], v[124:127], v[76:79], v[96:111]
    v_mul_f32 v44, v80, v54
    v_mul_f32 v45, v81, v54
    s_waitcnt lgkmcnt(11)
    v_dot2_f32_bf16 v20, v24, s54, 0
    v_dot2_f32_bf16 v21, v24, v24, 0
    v_dot2_f32_bf16 v22, v25, s54, 0
    v_dot2_f32_bf16 v23, v25, v25, 0
    ds_read_b128 v[76:79], v19 offset:4096
    s_waitcnt lgkmcnt(9)
    v_mfma_f32_32x32x16_bf16 v[96:111], v[128:131], v[64:67], v[96:111]
    v_mul_f32 v46, v82, v54
    v_mul_f32 v47, v83, v54
    v_dot2_f32_bf16 v20, v26, s54, v20
    v_dot2_f32_bf16 v21, v26, v26, v21
    v_dot2_f32_bf16 v22, v27, s54, v22
    v_dot2_f32_bf16 v23, v27, v27, v23
    ds_read_b128 v[64:67], v16 offset:8192
    s_waitcnt lgkmcnt(6)
    v_mfma_f32_32x32x16_bf16 v[96:111], v[132:135], v[68:71], v[96:111]
    v_cvt_pk_bf16_f32 v36, v44, v45
    v_cvt_pk_bf16_f32 v37, v46, v47
    v_dot2_f32_bf16 v20, v28, s54, v20
    v_dot2_f32_bf16 v21, v28, v28, v21
    v_dot2_f32_bf16 v22, v29, s54, v22
    v_dot2_f32_bf16 v23, v29, v29, v23
    ds_read_b128 v[68:71], v17 offset:8192
    s_waitcnt lgkmcnt(3)
    v_mfma_f32_32x32x16_bf16 v[96:111], v[136:139], v[72:75], v[96:111]
    v_mul_f32 v48, v84, v54
    v_dot2_f32_bf16 v20, v30, s54, v20
    v_dot2_f32_bf16 v21, v30, v30, v21
    v_dot2_f32_bf16 v22, v31, s54, v22
    v_dot2_f32_bf16 v23, v31, v31, v23
    ds_read_b128 v[72:75], v18 offset:8192
    s_waitcnt lgkmcnt(3)
    v_mfma_f32_32x32x16_bf16 v[96:111], v[140:143], v[76:79], v[96:111]
    v_mul_f32 v49, v85, v54
    v_mul_f32 v50, v86, v54
    v_dot2_f32_bf16 v20, v32, s54, v20
    v_dot2_f32_bf16 v21, v32, v32, v21
    v_dot2_f32_bf16 v22, v33, s54, v22
    v_dot2_f32_bf16 v23, v33, v33, v23
    ds_read_b128 v[76:79], v19 offset:8192
    s_waitcnt lgkmcnt(3)
    v_mfma_f32_32x32x16_bf16 v[96:111], v[144:147], v[64:67], v[96:111]
    v_mul_f32 v51, v87, v54
    v_cvt_pk_bf16_f32 v38, v48, v49
    v_dot2_f32_bf16 v20, v34, s54, v20
    v_dot2_f32_bf16 v21, v34, v34, v21
    v_dot2_f32_bf16 v22, v35, s54, v22
    v_dot2_f32_bf16 v23, v35, v35, v23
    ds_read_b128 v[64:67], v16 offset:12288
    s_waitcnt lgkmcnt(3)
    v_mfma_f32_32x32x16_bf16 v[96:111], v[148:151], v[68:71], v[96:111]
    v_cvt_pk_bf16_f32 v39, v50, v51
    v_dot2_f32_bf16 v20, v2, s54, v20
    v_dot2_f32_bf16 v21, v2, v2, v21
    v_dot2_f32_bf16 v22, v3, s54, v22
    v_dot2_f32_bf16 v23, v3, v3, v23
    ds_read_b128 v[68:71], v17 offset:12288
    s_waitcnt lgkmcnt(3)
    v_mfma_f32_32x32x16_bf16 v[96:111], v[152:155], v[72:75], v[96:111]
    buffer_store_dwordx4 v[36:39], v12, s[32:35], s50 offen offset:0 sc1
    v_dot2_f32_bf16 v20, v4, s54, v20
    v_dot2_f32_bf16 v21, v4, v4, v21
    v_dot2_f32_bf16 v22, v5, s54, v22
    v_dot2_f32_bf16 v23, v5, v5, v23
    ds_read_b128 v[72:75], v18 offset:12288
    s_waitcnt lgkmcnt(3)
    v_mfma_f32_32x32x16_bf16 v[96:111], v[156:159], v[76:79], v[96:111]
    v_mul_f32 v44, v88, v54
    v_mul_f32 v45, v89, v54
    v_dot2_f32_bf16 v20, v6, s54, v20
    v_dot2_f32_bf16 v21, v6, v6, v21
    v_dot2_f32_bf16 v22, v7, s54, v22
    v_dot2_f32_bf16 v23, v7, v7, v23
    ds_read_b128 v[76:79], v19 offset:12288
    s_waitcnt lgkmcnt(3)
    v_mfma_f32_32x32x16_bf16 v[96:111], v[160:163], v[64:67], v[96:111]
    v_mul_f32 v46, v90, v54
    v_add_f32 v20, v20, v22
    v_add_f32 v21, v21, v23
    ds_read_b128 v[64:67], v16 offset:16384
    s_waitcnt lgkmcnt(3)
    v_mfma_f32_32x32x16_bf16 v[96:111], v[164:167], v[68:71], v[96:111]
    v_add_f32_dpp v20, v20, v20 row_ror:8 row_mask:0xf bank_mask:0xf
    v_add_f32_dpp v21, v21, v21 row_ror:8 row_mask:0xf bank_mask:0xf
    ds_read_b128 v[68:71], v17 offset:16384
    s_waitcnt lgkmcnt(3)
    v_mfma_f32_32x32x16_bf16 v[96:111], v[168:171], v[72:75], v[96:111]
    v_add_f32_dpp v20, v20, v20 row_ror:4 row_mask:0xf bank_mask:0xf
    v_add_f32_dpp v21, v21, v21 row_ror:4 row_mask:0xf bank_mask:0xf
    ds_read_b128 v[72:75], v18 offset:16384
    s_waitcnt lgkmcnt(3)
    v_mfma_f32_32x32x16_bf16 v[96:111], v[172:175], v[76:79], v[96:111]
    v_add_f32_dpp v20, v20, v20 row_ror:2 row_mask:0xf bank_mask:0xf
    v_add_f32_dpp v21, v21, v21 row_ror:2 row_mask:0xf bank_mask:0xf
    ds_read_b128 v[76:79], v19 offset:16384
    s_waitcnt lgkmcnt(3)
    v_mfma_f32_32x32x16_bf16 v[96:111], v[176:179], v[64:67], v[96:111]
    v_add_f32_dpp v20, v20, v20 row_ror:1 row_mask:0xf bank_mask:0xf
    v_add_f32_dpp v21, v21, v21 row_ror:1 row_mask:0xf bank_mask:0xf
    ds_read_b128 v[64:67], v16 offset:20480
    s_waitcnt lgkmcnt(3)
    v_mfma_f32_32x32x16_bf16 v[96:111], v[180:183], v[68:71], v[96:111]
    v_mul_f32 v20, 0x3ae38e39, v20
    v_mul_f32 v21, 0x3ae38e39, v21
    ds_read_b128 v[68:71], v17 offset:20480
    s_waitcnt lgkmcnt(3)
    v_mfma_f32_32x32x16_bf16 v[96:111], v[184:187], v[72:75], v[96:111]
    v_fma_f32 v21, -v20, v20, v21
    v_max_f32 v21, 0, v21
    ds_read_b128 v[72:75], v18 offset:20480
    s_waitcnt lgkmcnt(3)
    v_mfma_f32_32x32x16_bf16 v[96:111], v[188:191], v[76:79], v[96:111]
    v_add_f32 v21, 0x3727c5ac, v21
    v_rsq_f32 v26, v21
    ds_read_b128 v[76:79], v19 offset:20480
    s_waitcnt lgkmcnt(3)
    v_mfma_f32_32x32x16_bf16 v[96:111], v[192:195], v[64:67], v[96:111]
    v_mul_f32 v27, v21, v26
    v_cvt_pk_bf16_f32 v24, -v20, v27
    ds_read_b128 v[64:67], v16 offset:24576
    s_waitcnt lgkmcnt(3)
    v_mfma_f32_32x32x16_bf16 v[96:111], v[196:199], v[68:71], v[96:111]
    v_lshlrev_b32 v28, 16, v24
    v_and_b32 v29, 0xffff0000, v24
    ds_read_b128 v[68:71], v17 offset:24576
    s_waitcnt lgkmcnt(3)
    v_mfma_f32_32x32x16_bf16 v[96:111], v[200:203], v[72:75], v[96:111]
    v_sub_f32 v28, -v20, v28
    v_sub_f32 v29, v27, v29
    ds_read_b128 v[72:75], v18 offset:24576
    s_waitcnt lgkmcnt(3)
    v_mfma_f32_32x32x16_bf16 v[96:111], v[204:207], v[76:79], v[96:111]
    v_cvt_pk_bf16_f32 v25, v28, v29
    ds_write_b128 v14, v[24:27] offset:512
    ds_read_b128 v[76:79], v19 offset:24576
    s_waitcnt lgkmcnt(4)
    v_mfma_f32_32x32x16_bf16 v[96:111], v[208:211], v[64:67], v[96:111]
    ds_read_b128 v[64:67], v16 offset:28672
    s_waitcnt lgkmcnt(4)
    v_mfma_f32_32x32x16_bf16 v[96:111], v[212:215], v[68:71], v[96:111]
    ds_read_b128 v[68:71], v17 offset:28672
    s_waitcnt lgkmcnt(4)
    v_mfma_f32_32x32x16_bf16 v[96:111], v[216:219], v[72:75], v[96:111]
    ds_read_b128 v[72:75], v18 offset:28672
    s_waitcnt lgkmcnt(3)
    v_mfma_f32_32x32x16_bf16 v[96:111], v[220:223], v[76:79], v[96:111]
    v_mul_f32 v47, v91, v54
    ds_read_b128 v[76:79], v19 offset:28672
    s_waitcnt lgkmcnt(3)
    v_mfma_f32_32x32x16_bf16 v[96:111], v[224:227], v[64:67], v[96:111]
    v_cvt_pk_bf16_f32 v40, v44, v45
    v_cvt_pk_bf16_f32 v41, v46, v47
    ds_read_b128 v[64:67], v16 offset:32768
    s_waitcnt lgkmcnt(3)
    v_mfma_f32_32x32x16_bf16 v[96:111], v[228:231], v[68:71], v[96:111]
    v_mul_f32 v48, v92, v54
    v_mul_f32 v49, v93, v54
    ds_read_b128 v[68:71], v17 offset:32768
    s_waitcnt lgkmcnt(3)
    v_mfma_f32_32x32x16_bf16 v[96:111], v[232:235], v[72:75], v[96:111]
    v_mul_f32 v50, v94, v54
    s_waitcnt vmcnt(1)
    s_barrier
    ds_read_b128 v[56:59], v13 offset:512
    ds_read_b128 v[72:75], v18 offset:32768
    s_waitcnt lgkmcnt(4)
    v_mfma_f32_32x32x16_bf16 v[96:111], v[236:239], v[76:79], v[96:111]
    s_add_u32 m0, s47, 0
    s_nop 0
    buffer_load_dwordx4 v11, s[16:19], s49 offen offset:0 lds
    v_mul_f32 v51, v95, v54
    v_cvt_pk_bf16_f32 v42, v48, v49
    ds_read_b128 v[76:79], v19 offset:32768
    s_waitcnt lgkmcnt(4)
    v_mfma_f32_32x32x16_bf16 v[96:111], v[240:243], v[64:67], v[96:111]
    s_add_u32 m0, s47, 7936
    s_nop 0
    buffer_load_dwordx4 v11, s[16:19], s49 offen offset:256 lds
    v_cvt_pk_bf16_f32 v43, v50, v51
    buffer_store_dwordx4 v[40:43], v12, s[32:35], s51 offen offset:0 sc1
    v_add_u32 v16, 0xffff0000, v16
    v_add_u32 v17, 0xffff0000, v17
    v_add_u32 v18, 0xffff0000, v18
    v_add_u32 v19, 0xffff0000, v19
    v_add_u32 v15, 0xffff0000, v15
    ds_read_b128 v[64:67], v16 offset:0
    s_waitcnt lgkmcnt(4)
    v_mfma_f32_32x32x16_bf16 v[96:111], v[244:247], v[68:71], v[96:111]
    s_add_u32 m0, s47, 15872
    s_nop 0
    buffer_load_dwordx4 v11, s[16:19], s49 offen offset:512 lds
    ds_read_b128 v[68:71], v17 offset:0
    s_waitcnt lgkmcnt(3)
    v_mfma_f32_32x32x16_bf16 v[96:111], v[248:251], v[72:75], v[96:111]
    s_add_u32 m0, s47, 23808
    s_nop 0
    buffer_load_dwordx4 v11, s[16:19], s49 offen offset:768 lds
    ds_read_b128 v[72:75], v18 offset:0
    s_waitcnt lgkmcnt(3)
    v_mfma_f32_32x32x16_bf16 v[96:111], v[252:255], v[76:79], v[96:111]
    s_add_u32 m0, s47, 31744
    s_nop 0
    buffer_load_dwordx4 v11, s[16:19], s49 offen offset:1024 lds
    s_add_u32 s49, s49, 36864
    ds_read_b128 v[76:79], v19 offset:0
    s_waitcnt lgkmcnt(3)
    v_mfma_f32_32x32x16_bf16 v[80:95], v[112:115], v[64:67], 0
    ds_read_b64 v[24:25], v15 offset:0
    ds_read_b64 v[26:27], v15 offset:4096
    ds_read_b64 v[28:29], v15 offset:8192
    ds_read_b128 v[64:67], v16 offset:4096
    s_waitcnt lgkmcnt(6)
    v_mfma_f32_32x32x16_bf16 v[80:95], v[116:119], v[68:71], v[80:95]
    v_mfma_f32_32x32x8bf16_1k v[96:111], v[62:63], v[56:57], v[96:111]
    ds_read_b64 v[30:31], v15 offset:12288
    ds_read_b64 v[32:33], v15 offset:16384
    ds_read_b64 v[34:35], v15 offset:20480
    ds_read_b128 v[68:71], v17 offset:4096
    s_waitcnt lgkmcnt(9)
    v_mfma_f32_32x32x16_bf16 v[80:95], v[120:123], v[72:75], v[80:95]
    ds_read_b64 v[2:3], v15 offset:24576
    ds_read_b64 v[4:5], v15 offset:28672
    ds_read_b64 v[6:7], v15 offset:32768
    ds_read_b128 v[72:75], v18 offset:4096
    s_waitcnt lgkmcnt(12)
    v_mfma_f32_32x32x16_bf16 v[80:95], v[124:127], v[76:79], v[80:95]
    v_mul_f32 v44, v96, v58
    v_mul_f32 v45, v97, v58
    s_waitcnt lgkmcnt(11)
    v_dot2_f32_bf16 v20, v24, s54, 0
    v_dot2_f32_bf16 v21, v24, v24, 0
    v_dot2_f32_bf16 v22, v25, s54, 0
    v_dot2_f32_bf16 v23, v25, v25, 0
    ds_read_b128 v[76:79], v19 offset:4096
    s_waitcnt lgkmcnt(9)
    v_mfma_f32_32x32x16_bf16 v[80:95], v[128:131], v[64:67], v[80:95]
    v_mul_f32 v46, v98, v58
    v_mul_f32 v47, v99, v58
    v_dot2_f32_bf16 v20, v26, s54, v20
    v_dot2_f32_bf16 v21, v26, v26, v21
    v_dot2_f32_bf16 v22, v27, s54, v22
    v_dot2_f32_bf16 v23, v27, v27, v23
    ds_read_b128 v[64:67], v16 offset:8192
    s_waitcnt lgkmcnt(6)
    v_mfma_f32_32x32x16_bf16 v[80:95], v[132:135], v[68:71], v[80:95]
    v_cvt_pk_bf16_f32 v36, v44, v45
    v_cvt_pk_bf16_f32 v37, v46, v47
    v_dot2_f32_bf16 v20, v28, s54, v20
    v_dot2_f32_bf16 v21, v28, v28, v21
    v_dot2_f32_bf16 v22, v29, s54, v22
    v_dot2_f32_bf16 v23, v29, v29, v23
    ds_read_b128 v[68:71], v17 offset:8192
    s_waitcnt lgkmcnt(3)
    v_mfma_f32_32x32x16_bf16 v[80:95], v[136:139], v[72:75], v[80:95]
    v_mul_f32 v48, v100, v58
    v_dot2_f32_bf16 v20, v30, s54, v20
    v_dot2_f32_bf16 v21, v30, v30, v21
    v_dot2_f32_bf16 v22, v31, s54, v22
    v_dot2_f32_bf16 v23, v31, v31, v23
    ds_read_b128 v[72:75], v18 offset:8192
    s_waitcnt lgkmcnt(3)
    v_mfma_f32_32x32x16_bf16 v[80:95], v[140:143], v[76:79], v[80:95]
    v_mul_f32 v49, v101, v58
    v_mul_f32 v50, v102, v58
    v_dot2_f32_bf16 v20, v32, s54, v20
    v_dot2_f32_bf16 v21, v32, v32, v21
    v_dot2_f32_bf16 v22, v33, s54, v22
    v_dot2_f32_bf16 v23, v33, v33, v23
    ds_read_b128 v[76:79], v19 offset:8192
    s_waitcnt lgkmcnt(3)
    v_mfma_f32_32x32x16_bf16 v[80:95], v[144:147], v[64:67], v[80:95]
    v_mul_f32 v51, v103, v58
    v_cvt_pk_bf16_f32 v38, v48, v49
    v_dot2_f32_bf16 v20, v34, s54, v20
    v_dot2_f32_bf16 v21, v34, v34, v21
    v_dot2_f32_bf16 v22, v35, s54, v22
    v_dot2_f32_bf16 v23, v35, v35, v23
    ds_read_b128 v[64:67], v16 offset:12288
    s_waitcnt lgkmcnt(3)
    v_mfma_f32_32x32x16_bf16 v[80:95], v[148:151], v[68:71], v[80:95]
    v_cvt_pk_bf16_f32 v39, v50, v51
    v_dot2_f32_bf16 v20, v2, s54, v20
    v_dot2_f32_bf16 v21, v2, v2, v21
    v_dot2_f32_bf16 v22, v3, s54, v22
    v_dot2_f32_bf16 v23, v3, v3, v23
    ds_read_b128 v[68:71], v17 offset:12288
    s_waitcnt lgkmcnt(3)
    v_mfma_f32_32x32x16_bf16 v[80:95], v[152:155], v[72:75], v[80:95]
    buffer_store_dwordx4 v[36:39], v12, s[32:35], s50 offen offset:512 sc1
    v_dot2_f32_bf16 v20, v4, s54, v20
    v_dot2_f32_bf16 v21, v4, v4, v21
    v_dot2_f32_bf16 v22, v5, s54, v22
    v_dot2_f32_bf16 v23, v5, v5, v23
    ds_read_b128 v[72:75], v18 offset:12288
    s_waitcnt lgkmcnt(3)
    v_mfma_f32_32x32x16_bf16 v[80:95], v[156:159], v[76:79], v[80:95]
    v_mul_f32 v44, v104, v58
    v_mul_f32 v45, v105, v58
    v_dot2_f32_bf16 v20, v6, s54, v20
    v_dot2_f32_bf16 v21, v6, v6, v21
    v_dot2_f32_bf16 v22, v7, s54, v22
    v_dot2_f32_bf16 v23, v7, v7, v23
    ds_read_b128 v[76:79], v19 offset:12288
    s_waitcnt lgkmcnt(3)
    v_mfma_f32_32x32x16_bf16 v[80:95], v[160:163], v[64:67], v[80:95]
    v_mul_f32 v46, v106, v58
    v_add_f32 v20, v20, v22
    v_add_f32 v21, v21, v23
    ds_read_b128 v[64:67], v16 offset:16384
    s_waitcnt lgkmcnt(3)
    v_mfma_f32_32x32x16_bf16 v[80:95], v[164:167], v[68:71], v[80:95]
    v_add_f32_dpp v20, v20, v20 row_ror:8 row_mask:0xf bank_mask:0xf
    v_add_f32_dpp v21, v21, v21 row_ror:8 row_mask:0xf bank_mask:0xf
    ds_read_b128 v[68:71], v17 offset:16384
    s_waitcnt lgkmcnt(3)
    v_mfma_f32_32x32x16_bf16 v[80:95], v[168:171], v[72:75], v[80:95]
    v_add_f32_dpp v20, v20, v20 row_ror:4 row_mask:0xf bank_mask:0xf
    v_add_f32_dpp v21, v21, v21 row_ror:4 row_mask:0xf bank_mask:0xf
    ds_read_b128 v[72:75], v18 offset:16384
    s_waitcnt lgkmcnt(3)
    v_mfma_f32_32x32x16_bf16 v[80:95], v[172:175], v[76:79], v[80:95]
    v_add_f32_dpp v20, v20, v20 row_ror:2 row_mask:0xf bank_mask:0xf
    v_add_f32_dpp v21, v21, v21 row_ror:2 row_mask:0xf bank_mask:0xf
    ds_read_b128 v[76:79], v19 offset:16384
    s_waitcnt lgkmcnt(3)
    v_mfma_f32_32x32x16_bf16 v[80:95], v[176:179], v[64:67], v[80:95]
    v_add_f32_dpp v20, v20, v20 row_ror:1 row_mask:0xf bank_mask:0xf
    v_add_f32_dpp v21, v21, v21 row_ror:1 row_mask:0xf bank_mask:0xf
    ds_read_b128 v[64:67], v16 offset:20480
    s_waitcnt lgkmcnt(3)
    v_mfma_f32_32x32x16_bf16 v[80:95], v[180:183], v[68:71], v[80:95]
    v_mul_f32 v20, 0x3ae38e39, v20
    v_mul_f32 v21, 0x3ae38e39, v21
    ds_read_b128 v[68:71], v17 offset:20480
    s_waitcnt lgkmcnt(3)
    v_mfma_f32_32x32x16_bf16 v[80:95], v[184:187], v[72:75], v[80:95]
    v_fma_f32 v21, -v20, v20, v21
    v_max_f32 v21, 0, v21
    ds_read_b128 v[72:75], v18 offset:20480
    s_waitcnt lgkmcnt(3)
    v_mfma_f32_32x32x16_bf16 v[80:95], v[188:191], v[76:79], v[80:95]
    v_add_f32 v21, 0x3727c5ac, v21
    v_rsq_f32 v26, v21
    ds_read_b128 v[76:79], v19 offset:20480
    s_waitcnt lgkmcnt(3)
    v_mfma_f32_32x32x16_bf16 v[80:95], v[192:195], v[64:67], v[80:95]
    v_mul_f32 v27, v21, v26
    v_cvt_pk_bf16_f32 v24, -v20, v27
    ds_read_b128 v[64:67], v16 offset:24576
    s_waitcnt lgkmcnt(3)
    v_mfma_f32_32x32x16_bf16 v[80:95], v[196:199], v[68:71], v[80:95]
    v_lshlrev_b32 v28, 16, v24
    v_and_b32 v29, 0xffff0000, v24
    ds_read_b128 v[68:71], v17 offset:24576
    s_waitcnt lgkmcnt(3)
    v_mfma_f32_32x32x16_bf16 v[80:95], v[200:203], v[72:75], v[80:95]
    v_sub_f32 v28, -v20, v28
    v_sub_f32 v29, v27, v29
    ds_read_b128 v[72:75], v18 offset:24576
    s_waitcnt lgkmcnt(3)
    v_mfma_f32_32x32x16_bf16 v[80:95], v[204:207], v[76:79], v[80:95]
    v_cvt_pk_bf16_f32 v25, v28, v29
    ds_write_b128 v14, v[24:27] offset:0
    ds_read_b128 v[76:79], v19 offset:24576
    s_waitcnt lgkmcnt(4)
    v_mfma_f32_32x32x16_bf16 v[80:95], v[208:211], v[64:67], v[80:95]
    ds_read_b128 v[64:67], v16 offset:28672
    s_waitcnt lgkmcnt(4)
    v_mfma_f32_32x32x16_bf16 v[80:95], v[212:215], v[68:71], v[80:95]
    ds_read_b128 v[68:71], v17 offset:28672
    s_waitcnt lgkmcnt(4)
    v_mfma_f32_32x32x16_bf16 v[80:95], v[216:219], v[72:75], v[80:95]
    ds_read_b128 v[72:75], v18 offset:28672
    s_waitcnt lgkmcnt(3)
    v_mfma_f32_32x32x16_bf16 v[80:95], v[220:223], v[76:79], v[80:95]
    v_mul_f32 v47, v107, v58
    ds_read_b128 v[76:79], v19 offset:28672
    s_waitcnt lgkmcnt(3)
    v_mfma_f32_32x32x16_bf16 v[80:95], v[224:227], v[64:67], v[80:95]
    v_cvt_pk_bf16_f32 v40, v44, v45
    v_cvt_pk_bf16_f32 v41, v46, v47
    ds_read_b128 v[64:67], v16 offset:32768
    s_waitcnt lgkmcnt(3)
    v_mfma_f32_32x32x16_bf16 v[80:95], v[228:231], v[68:71], v[80:95]
    v_mul_f32 v48, v108, v58
    v_mul_f32 v49, v109, v58
    ds_read_b128 v[68:71], v17 offset:32768
    s_waitcnt lgkmcnt(3)
    v_mfma_f32_32x32x16_bf16 v[80:95], v[232:235], v[72:75], v[80:95]
    v_mul_f32 v50, v110, v58
    s_waitcnt vmcnt(1)
    s_barrier
    ds_read_b128 v[52:55], v13 offset:0
    ds_read_b128 v[72:75], v18 offset:32768
    s_waitcnt lgkmcnt(4)
    v_mfma_f32_32x32x16_bf16 v[80:95], v[236:239], v[76:79], v[80:95]
    s_add_u32 m0, s47, 106496
    s_nop 0
    buffer_load_dwordx4 v11, s[16:19], s49 offen offset:0 lds
    v_mul_f32 v51, v111, v58
    v_cvt_pk_bf16_f32 v42, v48, v49
    ds_read_b128 v[76:79], v19 offset:32768
    s_waitcnt lgkmcnt(4)
    v_mfma_f32_32x32x16_bf16 v[80:95], v[240:243], v[64:67], v[80:95]
    s_add_u32 m0, s47, 114432
    s_nop 0
    buffer_load_dwordx4 v11, s[16:19], s49 offen offset:256 lds
    v_cvt_pk_bf16_f32 v43, v50, v51
    buffer_store_dwordx4 v[40:43], v12, s[32:35], s51 offen offset:512 sc1
    v_add_u32 v16, 0xffff6000, v16
    v_add_u32 v17, 0xffff6000, v17
    v_add_u32 v18, 0xffff6000, v18
    v_add_u32 v19, 0xffff6000, v19
    v_add_u32 v15, 0xffff6000, v15
    ds_read_b128 v[64:67], v16 offset:0
    s_waitcnt lgkmcnt(4)
    v_mfma_f32_32x32x16_bf16 v[80:95], v[244:247], v[68:71], v[80:95]
    s_add_u32 m0, s47, 122368
    s_nop 0
    buffer_load_dwordx4 v11, s[16:19], s49 offen offset:512 lds
    ds_read_b128 v[68:71], v17 offset:0
    s_waitcnt lgkmcnt(3)
    v_mfma_f32_32x32x16_bf16 v[80:95], v[248:251], v[72:75], v[80:95]
    s_add_u32 m0, s47, 130304
    s_nop 0
    buffer_load_dwordx4 v11, s[16:19], s49 offen offset:768 lds
    ds_read_b128 v[72:75], v18 offset:0
    s_waitcnt lgkmcnt(3)
    v_mfma_f32_32x32x16_bf16 v[80:95], v[252:255], v[76:79], v[80:95]
    s_add_u32 m0, s47, 138240
    s_nop 0
    buffer_load_dwordx4 v11, s[16:19], s49 offen offset:1024 lds
    s_add_u32 s49, s49, 36864
    ds_read_b128 v[76:79], v19 offset:0
    s_waitcnt lgkmcnt(3)
    v_mfma_f32_32x32x16_bf16 v[96:111], v[112:115], v[64:67], 0
    ds_read_b64 v[24:25], v15 offset:0
    ds_read_b64 v[26:27], v15 offset:4096
    ds_read_b64 v[28:29], v15 offset:8192
    ds_read_b128 v[64:67], v16 offset:4096
    s_waitcnt lgkmcnt(6)
    v_mfma_f32_32x32x16_bf16 v[96:111], v[116:119], v[68:71], v[96:111]
    v_mfma_f32_32x32x8bf16_1k v[80:95], v[62:63], v[52:53], v[80:95]
    ds_read_b64 v[30:31], v15 offset:12288
    ds_read_b64 v[32:33], v15 offset:16384
    ds_read_b64 v[34:35], v15 offset:20480
    ds_read_b128 v[68:71], v17 offset:4096
    s_waitcnt lgkmcnt(9)
    v_mfma_f32_32x32x16_bf16 v[96:111], v[120:123], v[72:75], v[96:111]
    ds_read_b64 v[2:3], v15 offset:24576
    ds_read_b64 v[4:5], v15 offset:28672
    ds_read_b64 v[6:7], v15 offset:32768
    ds_read_b128 v[72:75], v18 offset:4096
    s_waitcnt lgkmcnt(12)
    v_mfma_f32_32x32x16_bf16 v[96:111], v[124:127], v[76:79], v[96:111]
    v_mul_f32 v44, v80, v54
    v_mul_f32 v45, v81, v54
    s_waitcnt lgkmcnt(11)
    v_dot2_f32_bf16 v20, v24, s54, 0
    v_dot2_f32_bf16 v21, v24, v24, 0
    v_dot2_f32_bf16 v22, v25, s54, 0
    v_dot2_f32_bf16 v23, v25, v25, 0
    ds_read_b128 v[76:79], v19 offset:4096
    s_waitcnt lgkmcnt(9)
    v_mfma_f32_32x32x16_bf16 v[96:111], v[128:131], v[64:67], v[96:111]
    v_mul_f32 v46, v82, v54
    v_mul_f32 v47, v83, v54
    v_dot2_f32_bf16 v20, v26, s54, v20
    v_dot2_f32_bf16 v21, v26, v26, v21
    v_dot2_f32_bf16 v22, v27, s54, v22
    v_dot2_f32_bf16 v23, v27, v27, v23
    ds_read_b128 v[64:67], v16 offset:8192
    s_waitcnt lgkmcnt(6)
    v_mfma_f32_32x32x16_bf16 v[96:111], v[132:135], v[68:71], v[96:111]
    v_cvt_pk_bf16_f32 v36, v44, v45
    v_cvt_pk_bf16_f32 v37, v46, v47
    v_dot2_f32_bf16 v20, v28, s54, v20
    v_dot2_f32_bf16 v21, v28, v28, v21
    v_dot2_f32_bf16 v22, v29, s54, v22
    v_dot2_f32_bf16 v23, v29, v29, v23
    ds_read_b128 v[68:71], v17 offset:8192
    s_waitcnt lgkmcnt(3)
    v_mfma_f32_32x32x16_bf16 v[96:111], v[136:139], v[72:75], v[96:111]
    v_mul_f32 v48, v84, v54
    v_dot2_f32_bf16 v20, v30, s54, v20
    v_dot2_f32_bf16 v21, v30, v30, v21
    v_dot2_f32_bf16 v22, v31, s54, v22
    v_dot2_f32_bf16 v23, v31, v31, v23
    ds_read_b128 v[72:75], v18 offset:8192
    s_waitcnt lgkmcnt(3)
    v_mfma_f32_32x32x16_bf16 v[96:111], v[140:143], v[76:79], v[96:111]
    v_mul_f32 v49, v85, v54
    v_mul_f32 v50, v86, v54
    v_dot2_f32_bf16 v20, v32, s54, v20
    v_dot2_f32_bf16 v21, v32, v32, v21
    v_dot2_f32_bf16 v22, v33, s54, v22
    v_dot2_f32_bf16 v23, v33, v33, v23
    ds_read_b128 v[76:79], v19 offset:8192
    s_waitcnt lgkmcnt(3)
    v_mfma_f32_32x32x16_bf16 v[96:111], v[144:147], v[64:67], v[96:111]
    v_mul_f32 v51, v87, v54
    v_cvt_pk_bf16_f32 v38, v48, v49
    v_dot2_f32_bf16 v20, v34, s54, v20
    v_dot2_f32_bf16 v21, v34, v34, v21
    v_dot2_f32_bf16 v22, v35, s54, v22
    v_dot2_f32_bf16 v23, v35, v35, v23
    ds_read_b128 v[64:67], v16 offset:12288
    s_waitcnt lgkmcnt(3)
    v_mfma_f32_32x32x16_bf16 v[96:111], v[148:151], v[68:71], v[96:111]
    v_cvt_pk_bf16_f32 v39, v50, v51
    v_dot2_f32_bf16 v20, v2, s54, v20
    v_dot2_f32_bf16 v21, v2, v2, v21
    v_dot2_f32_bf16 v22, v3, s54, v22
    v_dot2_f32_bf16 v23, v3, v3, v23
    ds_read_b128 v[68:71], v17 offset:12288
    s_waitcnt lgkmcnt(3)
    v_mfma_f32_32x32x16_bf16 v[96:111], v[152:155], v[72:75], v[96:111]
    buffer_store_dwordx4 v[36:39], v12, s[32:35], s50 offen offset:1024 sc1
    v_dot2_f32_bf16 v20, v4, s54, v20
    v_dot2_f32_bf16 v21, v4, v4, v21
    v_dot2_f32_bf16 v22, v5, s54, v22
    v_dot2_f32_bf16 v23, v5, v5, v23
    ds_read_b128 v[72:75], v18 offset:12288
    s_waitcnt lgkmcnt(3)
    v_mfma_f32_32x32x16_bf16 v[96:111], v[156:159], v[76:79], v[96:111]
    v_mul_f32 v44, v88, v54
    v_mul_f32 v45, v89, v54
    v_dot2_f32_bf16 v20, v6, s54, v20
    v_dot2_f32_bf16 v21, v6, v6, v21
    v_dot2_f32_bf16 v22, v7, s54, v22
    v_dot2_f32_bf16 v23, v7, v7, v23
    ds_read_b128 v[76:79], v19 offset:12288
    s_waitcnt lgkmcnt(3)
    v_mfma_f32_32x32x16_bf16 v[96:111], v[160:163], v[64:67], v[96:111]
    v_mul_f32 v46, v90, v54
    v_add_f32 v20, v20, v22
    v_add_f32 v21, v21, v23
    ds_read_b128 v[64:67], v16 offset:16384
    s_waitcnt lgkmcnt(3)
    v_mfma_f32_32x32x16_bf16 v[96:111], v[164:167], v[68:71], v[96:111]
    v_add_f32_dpp v20, v20, v20 row_ror:8 row_mask:0xf bank_mask:0xf
    v_add_f32_dpp v21, v21, v21 row_ror:8 row_mask:0xf bank_mask:0xf
    ds_read_b128 v[68:71], v17 offset:16384
    s_waitcnt lgkmcnt(3)
    v_mfma_f32_32x32x16_bf16 v[96:111], v[168:171], v[72:75], v[96:111]
    v_add_f32_dpp v20, v20, v20 row_ror:4 row_mask:0xf bank_mask:0xf
    v_add_f32_dpp v21, v21, v21 row_ror:4 row_mask:0xf bank_mask:0xf
    ds_read_b128 v[72:75], v18 offset:16384
    s_waitcnt lgkmcnt(3)
    v_mfma_f32_32x32x16_bf16 v[96:111], v[172:175], v[76:79], v[96:111]
    v_add_f32_dpp v20, v20, v20 row_ror:2 row_mask:0xf bank_mask:0xf
    v_add_f32_dpp v21, v21, v21 row_ror:2 row_mask:0xf bank_mask:0xf
    ds_read_b128 v[76:79], v19 offset:16384
    s_waitcnt lgkmcnt(3)
    v_mfma_f32_32x32x16_bf16 v[96:111], v[176:179], v[64:67], v[96:111]
    v_add_f32_dpp v20, v20, v20 row_ror:1 row_mask:0xf bank_mask:0xf
    v_add_f32_dpp v21, v21, v21 row_ror:1 row_mask:0xf bank_mask:0xf
    ds_read_b128 v[64:67], v16 offset:20480
    s_waitcnt lgkmcnt(3)
    v_mfma_f32_32x32x16_bf16 v[96:111], v[180:183], v[68:71], v[96:111]
    v_mul_f32 v20, 0x3ae38e39, v20
    v_mul_f32 v21, 0x3ae38e39, v21
    ds_read_b128 v[68:71], v17 offset:20480
    s_waitcnt lgkmcnt(3)
    v_mfma_f32_32x32x16_bf16 v[96:111], v[184:187], v[72:75], v[96:111]
    v_fma_f32 v21, -v20, v20, v21
    v_max_f32 v21, 0, v21
    ds_read_b128 v[72:75], v18 offset:20480
    s_waitcnt lgkmcnt(3)
    v_mfma_f32_32x32x16_bf16 v[96:111], v[188:191], v[76:79], v[96:111]
    v_add_f32 v21, 0x3727c5ac, v21
    v_rsq_f32 v26, v21
    ds_read_b128 v[76:79], v19 offset:20480
    s_waitcnt lgkmcnt(3)
    v_mfma_f32_32x32x16_bf16 v[96:111], v[192:195], v[64:67], v[96:111]
    v_mul_f32 v27, v21, v26
    v_cvt_pk_bf16_f32 v24, -v20, v27
    ds_read_b128 v[64:67], v16 offset:24576
    s_waitcnt lgkmcnt(3)
    v_mfma_f32_32x32x16_bf16 v[96:111], v[196:199], v[68:71], v[96:111]
    v_lshlrev_b32 v28, 16, v24
    v_and_b32 v29, 0xffff0000, v24
    ds_read_b128 v[68:71], v17 offset:24576
    s_waitcnt lgkmcnt(3)
    v_mfma_f32_32x32x16_bf16 v[96:111], v[200:203], v[72:75], v[96:111]
    v_sub_f32 v28, -v20, v28
    v_sub_f32 v29, v27, v29
    ds_read_b128 v[72:75], v18 offset:24576
    s_waitcnt lgkmcnt(3)
    v_mfma_f32_32x32x16_bf16 v[96:111], v[204:207], v[76:79], v[96:111]
    v_cvt_pk_bf16_f32 v25, v28, v29
    ds_write_b128 v14, v[24:27] offset:512
    ds_read_b128 v[76:79], v19 offset:24576
    s_waitcnt lgkmcnt(4)
    v_mfma_f32_32x32x16_bf16 v[96:111], v[208:211], v[64:67], v[96:111]
    ds_read_b128 v[64:67], v16 offset:28672
    s_waitcnt lgkmcnt(4)
    v_mfma_f32_32x32x16_bf16 v[96:111], v[212:215], v[68:71], v[96:111]
    ds_read_b128 v[68:71], v17 offset:28672
    s_waitcnt lgkmcnt(4)
    v_mfma_f32_32x32x16_bf16 v[96:111], v[216:219], v[72:75], v[96:111]
    ds_read_b128 v[72:75], v18 offset:28672
    s_waitcnt lgkmcnt(3)
    v_mfma_f32_32x32x16_bf16 v[96:111], v[220:223], v[76:79], v[96:111]
    v_mul_f32 v47, v91, v54
    ds_read_b128 v[76:79], v19 offset:28672
    s_waitcnt lgkmcnt(3)
    v_mfma_f32_32x32x16_bf16 v[96:111], v[224:227], v[64:67], v[96:111]
    v_cvt_pk_bf16_f32 v40, v44, v45
    v_cvt_pk_bf16_f32 v41, v46, v47
    ds_read_b128 v[64:67], v16 offset:32768
    s_waitcnt lgkmcnt(3)
    v_mfma_f32_32x32x16_bf16 v[96:111], v[228:231], v[68:71], v[96:111]
    v_mul_f32 v48, v92, v54
    v_mul_f32 v49, v93, v54
    ds_read_b128 v[68:71], v17 offset:32768
    s_waitcnt lgkmcnt(3)
    v_mfma_f32_32x32x16_bf16 v[96:111], v[232:235], v[72:75], v[96:111]
    v_mul_f32 v50, v94, v54
    s_waitcnt vmcnt(1)
    s_barrier
    ds_read_b128 v[56:59], v13 offset:512
    ds_read_b128 v[72:75], v18 offset:32768
    s_waitcnt lgkmcnt(4)
    v_mfma_f32_32x32x16_bf16 v[96:111], v[236:239], v[76:79], v[96:111]
    s_add_u32 m0, s47, 40960
    s_nop 0
    buffer_load_dwordx4 v11, s[16:19], s49 offen offset:0 lds
    v_mul_f32 v51, v95, v54
    v_cvt_pk_bf16_f32 v42, v48, v49
    ds_read_b128 v[76:79], v19 offset:32768
    s_waitcnt lgkmcnt(4)
    v_mfma_f32_32x32x16_bf16 v[96:111], v[240:243], v[64:67], v[96:111]
    s_add_u32 m0, s47, 48896
    s_nop 0
    buffer_load_dwordx4 v11, s[16:19], s49 offen offset:256 lds
    v_cvt_pk_bf16_f32 v43, v50, v51
    buffer_store_dwordx4 v[40:43], v12, s[32:35], s51 offen offset:1024 sc1
    v_add_u32 v16, 0x1a000, v16
    v_add_u32 v17, 0x1a000, v17
    v_add_u32 v18, 0x1a000, v18
    v_add_u32 v19, 0x1a000, v19
    v_add_u32 v15, 0x1a000, v15
    ds_read_b128 v[64:67], v16 offset:0
    s_waitcnt lgkmcnt(4)
    v_mfma_f32_32x32x16_bf16 v[96:111], v[244:247], v[68:71], v[96:111]
    s_add_u32 m0, s47, 56832
    s_nop 0
    buffer_load_dwordx4 v11, s[16:19], s49 offen offset:512 lds
    ds_read_b128 v[68:71], v17 offset:0
    s_waitcnt lgkmcnt(3)
    v_mfma_f32_32x32x16_bf16 v[96:111], v[248:251], v[72:75], v[96:111]
    s_add_u32 m0, s47, 64768
    s_nop 0
    buffer_load_dwordx4 v11, s[16:19], s49 offen offset:768 lds
    ds_read_b128 v[72:75], v18 offset:0
    s_waitcnt lgkmcnt(3)
    v_mfma_f32_32x32x16_bf16 v[96:111], v[252:255], v[76:79], v[96:111]
    s_add_u32 m0, s47, 72704
    s_nop 0
    buffer_load_dwordx4 v11, s[16:19], s49 offen offset:1024 lds
    s_add_u32 s49, s49, 36864
    ds_read_b128 v[76:79], v19 offset:0
    s_waitcnt lgkmcnt(3)
    v_mfma_f32_32x32x16_bf16 v[80:95], v[112:115], v[64:67], 0
    ds_read_b64 v[24:25], v15 offset:0
    ds_read_b64 v[26:27], v15 offset:4096
    ds_read_b64 v[28:29], v15 offset:8192
    ds_read_b128 v[64:67], v16 offset:4096
    s_waitcnt lgkmcnt(6)
    v_mfma_f32_32x32x16_bf16 v[80:95], v[116:119], v[68:71], v[80:95]
    v_mfma_f32_32x32x8bf16_1k v[96:111], v[62:63], v[56:57], v[96:111]
    ds_read_b64 v[30:31], v15 offset:12288
    ds_read_b64 v[32:33], v15 offset:16384
    ds_read_b64 v[34:35], v15 offset:20480
    ds_read_b128 v[68:71], v17 offset:4096
    s_waitcnt lgkmcnt(9)
    v_mfma_f32_32x32x16_bf16 v[80:95], v[120:123], v[72:75], v[80:95]
    ds_read_b64 v[2:3], v15 offset:24576
    ds_read_b64 v[4:5], v15 offset:28672
    ds_read_b64 v[6:7], v15 offset:32768
    ds_read_b128 v[72:75], v18 offset:4096
    s_waitcnt lgkmcnt(12)
    v_mfma_f32_32x32x16_bf16 v[80:95], v[124:127], v[76:79], v[80:95]
    v_mul_f32 v44, v96, v58
    v_mul_f32 v45, v97, v58
    s_waitcnt lgkmcnt(11)
    v_dot2_f32_bf16 v20, v24, s54, 0
    v_dot2_f32_bf16 v21, v24, v24, 0
    v_dot2_f32_bf16 v22, v25, s54, 0
    v_dot2_f32_bf16 v23, v25, v25, 0
    ds_read_b128 v[76:79], v19 offset:4096
    s_waitcnt lgkmcnt(9)
    v_mfma_f32_32x32x16_bf16 v[80:95], v[128:131], v[64:67], v[80:95]
    v_mul_f32 v46, v98, v58
    v_mul_f32 v47, v99, v58
    v_dot2_f32_bf16 v20, v26, s54, v20
    v_dot2_f32_bf16 v21, v26, v26, v21
    v_dot2_f32_bf16 v22, v27, s54, v22
    v_dot2_f32_bf16 v23, v27, v27, v23
    ds_read_b128 v[64:67], v16 offset:8192
    s_waitcnt lgkmcnt(6)
    v_mfma_f32_32x32x16_bf16 v[80:95], v[132:135], v[68:71], v[80:95]
    v_cvt_pk_bf16_f32 v36, v44, v45
    v_cvt_pk_bf16_f32 v37, v46, v47
    v_dot2_f32_bf16 v20, v28, s54, v20
    v_dot2_f32_bf16 v21, v28, v28, v21
    v_dot2_f32_bf16 v22, v29, s54, v22
    v_dot2_f32_bf16 v23, v29, v29, v23
    ds_read_b128 v[68:71], v17 offset:8192
    s_waitcnt lgkmcnt(3)
    v_mfma_f32_32x32x16_bf16 v[80:95], v[136:139], v[72:75], v[80:95]
    v_mul_f32 v48, v100, v58
    v_dot2_f32_bf16 v20, v30, s54, v20
    v_dot2_f32_bf16 v21, v30, v30, v21
    v_dot2_f32_bf16 v22, v31, s54, v22
    v_dot2_f32_bf16 v23, v31, v31, v23
    ds_read_b128 v[72:75], v18 offset:8192
    s_waitcnt lgkmcnt(3)
    v_mfma_f32_32x32x16_bf16 v[80:95], v[140:143], v[76:79], v[80:95]
    v_mul_f32 v49, v101, v58
    v_mul_f32 v50, v102, v58
    v_dot2_f32_bf16 v20, v32, s54, v20
    v_dot2_f32_bf16 v21, v32, v32, v21
    v_dot2_f32_bf16 v22, v33, s54, v22
    v_dot2_f32_bf16 v23, v33, v33, v23
    ds_read_b128 v[76:79], v19 offset:8192
    s_waitcnt lgkmcnt(3)
    v_mfma_f32_32x32x16_bf16 v[80:95], v[144:147], v[64:67], v[80:95]
    v_mul_f32 v51, v103, v58
    v_cvt_pk_bf16_f32 v38, v48, v49
    v_dot2_f32_bf16 v20, v34, s54, v20
    v_dot2_f32_bf16 v21, v34, v34, v21
    v_dot2_f32_bf16 v22, v35, s54, v22
    v_dot2_f32_bf16 v23, v35, v35, v23
    ds_read_b128 v[64:67], v16 offset:12288
    s_waitcnt lgkmcnt(3)
    v_mfma_f32_32x32x16_bf16 v[80:95], v[148:151], v[68:71], v[80:95]
    v_cvt_pk_bf16_f32 v39, v50, v51
    v_dot2_f32_bf16 v20, v2, s54, v20
    v_dot2_f32_bf16 v21, v2, v2, v21
    v_dot2_f32_bf16 v22, v3, s54, v22
    v_dot2_f32_bf16 v23, v3, v3, v23
    ds_read_b128 v[68:71], v17 offset:12288
    s_waitcnt lgkmcnt(3)
    v_mfma_f32_32x32x16_bf16 v[80:95], v[152:155], v[72:75], v[80:95]
    buffer_store_dwordx4 v[36:39], v12, s[32:35], s50 offen offset:1536 sc1
    v_dot2_f32_bf16 v20, v4, s54, v20
    v_dot2_f32_bf16 v21, v4, v4, v21
    v_dot2_f32_bf16 v22, v5, s54, v22
    v_dot2_f32_bf16 v23, v5, v5, v23
    ds_read_b128 v[72:75], v18 offset:12288
    s_waitcnt lgkmcnt(3)
    v_mfma_f32_32x32x16_bf16 v[80:95], v[156:159], v[76:79], v[80:95]
    v_mul_f32 v44, v104, v58
    v_mul_f32 v45, v105, v58
    v_dot2_f32_bf16 v20, v6, s54, v20
    v_dot2_f32_bf16 v21, v6, v6, v21
    v_dot2_f32_bf16 v22, v7, s54, v22
    v_dot2_f32_bf16 v23, v7, v7, v23
    ds_read_b128 v[76:79], v19 offset:12288
    s_waitcnt lgkmcnt(3)
    v_mfma_f32_32x32x16_bf16 v[80:95], v[160:163], v[64:67], v[80:95]
    v_mul_f32 v46, v106, v58
    v_add_f32 v20, v20, v22
    v_add_f32 v21, v21, v23
    ds_read_b128 v[64:67], v16 offset:16384
    s_waitcnt lgkmcnt(3)
    v_mfma_f32_32x32x16_bf16 v[80:95], v[164:167], v[68:71], v[80:95]
    v_add_f32_dpp v20, v20, v20 row_ror:8 row_mask:0xf bank_mask:0xf
    v_add_f32_dpp v21, v21, v21 row_ror:8 row_mask:0xf bank_mask:0xf
    ds_read_b128 v[68:71], v17 offset:16384
    s_waitcnt lgkmcnt(3)
    v_mfma_f32_32x32x16_bf16 v[80:95], v[168:171], v[72:75], v[80:95]
    v_add_f32_dpp v20, v20, v20 row_ror:4 row_mask:0xf bank_mask:0xf
    v_add_f32_dpp v21, v21, v21 row_ror:4 row_mask:0xf bank_mask:0xf
    ds_read_b128 v[72:75], v18 offset:16384
    s_waitcnt lgkmcnt(3)
    v_mfma_f32_32x32x16_bf16 v[80:95], v[172:175], v[76:79], v[80:95]
    v_add_f32_dpp v20, v20, v20 row_ror:2 row_mask:0xf bank_mask:0xf
    v_add_f32_dpp v21, v21, v21 row_ror:2 row_mask:0xf bank_mask:0xf
    ds_read_b128 v[76:79], v19 offset:16384
    s_waitcnt lgkmcnt(3)
    v_mfma_f32_32x32x16_bf16 v[80:95], v[176:179], v[64:67], v[80:95]
    v_add_f32_dpp v20, v20, v20 row_ror:1 row_mask:0xf bank_mask:0xf
    v_add_f32_dpp v21, v21, v21 row_ror:1 row_mask:0xf bank_mask:0xf
    ds_read_b128 v[64:67], v16 offset:20480
    s_waitcnt lgkmcnt(3)
    v_mfma_f32_32x32x16_bf16 v[80:95], v[180:183], v[68:71], v[80:95]
    v_mul_f32 v20, 0x3ae38e39, v20
    v_mul_f32 v21, 0x3ae38e39, v21
    ds_read_b128 v[68:71], v17 offset:20480
    s_waitcnt lgkmcnt(3)
    v_mfma_f32_32x32x16_bf16 v[80:95], v[184:187], v[72:75], v[80:95]
    v_fma_f32 v21, -v20, v20, v21
    v_max_f32 v21, 0, v21
    ds_read_b128 v[72:75], v18 offset:20480
    s_waitcnt lgkmcnt(3)
    v_mfma_f32_32x32x16_bf16 v[80:95], v[188:191], v[76:79], v[80:95]
    v_add_f32 v21, 0x3727c5ac, v21
    v_rsq_f32 v26, v21
    ds_read_b128 v[76:79], v19 offset:20480
    s_waitcnt lgkmcnt(3)
    v_mfma_f32_32x32x16_bf16 v[80:95], v[192:195], v[64:67], v[80:95]
    v_mul_f32 v27, v21, v26
    v_cvt_pk_bf16_f32 v24, -v20, v27
    ds_read_b128 v[64:67], v16 offset:24576
    s_waitcnt lgkmcnt(3)
    v_mfma_f32_32x32x16_bf16 v[80:95], v[196:199], v[68:71], v[80:95]
    v_lshlrev_b32 v28, 16, v24
    v_and_b32 v29, 0xffff0000, v24
    ds_read_b128 v[68:71], v17 offset:24576
    s_waitcnt lgkmcnt(3)
    v_mfma_f32_32x32x16_bf16 v[80:95], v[200:203], v[72:75], v[80:95]
    v_sub_f32 v28, -v20, v28
    v_sub_f32 v29, v27, v29
    ds_read_b128 v[72:75], v18 offset:24576
    s_waitcnt lgkmcnt(3)
    v_mfma_f32_32x32x16_bf16 v[80:95], v[204:207], v[76:79], v[80:95]
    v_cvt_pk_bf16_f32 v25, v28, v29
    ds_write_b128 v14, v[24:27] offset:0
    ds_read_b128 v[76:79], v19 offset:24576
    s_waitcnt lgkmcnt(4)
    v_mfma_f32_32x32x16_bf16 v[80:95], v[208:211], v[64:67], v[80:95]
    ds_read_b128 v[64:67], v16 offset:28672
    s_waitcnt lgkmcnt(4)
    v_mfma_f32_32x32x16_bf16 v[80:95], v[212:215], v[68:71], v[80:95]
    ds_read_b128 v[68:71], v17 offset:28672
    s_waitcnt lgkmcnt(4)
    v_mfma_f32_32x32x16_bf16 v[80:95], v[216:219], v[72:75], v[80:95]
    ds_read_b128 v[72:75], v18 offset:28672
    s_waitcnt lgkmcnt(3)
    v_mfma_f32_32x32x16_bf16 v[80:95], v[220:223], v[76:79], v[80:95]
    v_mul_f32 v47, v107, v58
    ds_read_b128 v[76:79], v19 offset:28672
    s_waitcnt lgkmcnt(3)
    v_mfma_f32_32x32x16_bf16 v[80:95], v[224:227], v[64:67], v[80:95]
    v_cvt_pk_bf16_f32 v40, v44, v45
    v_cvt_pk_bf16_f32 v41, v46, v47
    ds_read_b128 v[64:67], v16 offset:32768
    s_waitcnt lgkmcnt(3)
    v_mfma_f32_32x32x16_bf16 v[80:95], v[228:231], v[68:71], v[80:95]
    v_mul_f32 v48, v108, v58
    v_mul_f32 v49, v109, v58
    ds_read_b128 v[68:71], v17 offset:32768
    s_waitcnt lgkmcnt(3)
    v_mfma_f32_32x32x16_bf16 v[80:95], v[232:235], v[72:75], v[80:95]
    v_mul_f32 v50, v110, v58
    s_waitcnt vmcnt(1)
    s_barrier
    ds_read_b128 v[52:55], v13 offset:0
    s_cmp_gt_u32 s44, 6
    s_cbranch_scc1 L_k1rl_9
    s_cmp_lt_u32 s57, 18
    s_cselect_b32 s16, s14, s28
    s_cselect_b32 s17, s15, s29
    s_and_b32 s17, s17, 0xffff
    s_mov_b32 s18, 5308416
    s_cmp_lt_u32 s57, 18
    s_cselect_b32 s18, 663552, s18
    s_cselect_b32 s49, 0, 18
    s_sub_u32 s49, s57, s49
    s_mul_i32 s49, s49, 36864

L_k1rl_9:
    ds_read_b128 v[72:75], v18 offset:32768
    s_waitcnt lgkmcnt(4)
    v_mfma_f32_32x32x16_bf16 v[80:95], v[236:239], v[76:79], v[80:95]
    s_add_u32 m0, s47, 0
    s_nop 0
    buffer_load_dwordx4 v11, s[16:19], s49 offen offset:0 lds
    v_mul_f32 v51, v111, v58
    v_cvt_pk_bf16_f32 v42, v48, v49
    ds_read_b128 v[76:79], v19 offset:32768
    s_waitcnt lgkmcnt(4)
    v_mfma_f32_32x32x16_bf16 v[80:95], v[240:243], v[64:67], v[80:95]
    s_add_u32 m0, s47, 7936
    s_nop 0
    buffer_load_dwordx4 v11, s[16:19], s49 offen offset:256 lds
    v_cvt_pk_bf16_f32 v43, v50, v51
    buffer_store_dwordx4 v[40:43], v12, s[32:35], s51 offen offset:1536 sc1
    v_add_u32 v16, 0xffff0000, v16
    v_add_u32 v17, 0xffff0000, v17
    v_add_u32 v18, 0xffff0000, v18
    v_add_u32 v19, 0xffff0000, v19
    v_add_u32 v15, 0xffff0000, v15
    ds_read_b128 v[64:67], v16 offset:0
    s_waitcnt lgkmcnt(4)
    v_mfma_f32_32x32x16_bf16 v[80:95], v[244:247], v[68:71], v[80:95]
    s_add_u32 m0, s47, 15872
    s_nop 0
    buffer_load_dwordx4 v11, s[16:19], s49 offen offset:512 lds
    ds_read_b128 v[68:71], v17 offset:0
    s_waitcnt lgkmcnt(3)
    v_mfma_f32_32x32x16_bf16 v[80:95], v[248:251], v[72:75], v[80:95]
    s_add_u32 m0, s47, 23808
    s_nop 0
    buffer_load_dwordx4 v11, s[16:19], s49 offen offset:768 lds
    ds_read_b128 v[72:75], v18 offset:0
    s_waitcnt lgkmcnt(3)
    v_mfma_f32_32x32x16_bf16 v[80:95], v[252:255], v[76:79], v[80:95]
    s_add_u32 m0, s47, 31744
    s_nop 0
    buffer_load_dwordx4 v11, s[16:19], s49 offen offset:1024 lds
    s_add_u32 s49, s49, 36864
    ds_read_b128 v[76:79], v19 offset:0
    s_waitcnt lgkmcnt(3)
    v_mfma_f32_32x32x16_bf16 v[96:111], v[112:115], v[64:67], 0
    ds_read_b64 v[24:25], v15 offset:0
    ds_read_b64 v[26:27], v15 offset:4096
    ds_read_b64 v[28:29], v15 offset:8192
    ds_read_b128 v[64:67], v16 offset:4096
    s_waitcnt lgkmcnt(6)
    v_mfma_f32_32x32x16_bf16 v[96:111], v[116:119], v[68:71], v[96:111]
    v_mfma_f32_32x32x8bf16_1k v[80:95], v[62:63], v[52:53], v[80:95]
    ds_read_b64 v[30:31], v15 offset:12288
    ds_read_b64 v[32:33], v15 offset:16384
    ds_read_b64 v[34:35], v15 offset:20480
    ds_read_b128 v[68:71], v17 offset:4096
    s_waitcnt lgkmcnt(9)
    v_mfma_f32_32x32x16_bf16 v[96:111], v[120:123], v[72:75], v[96:111]
    ds_read_b64 v[2:3], v15 offset:24576
    ds_read_b64 v[4:5], v15 offset:28672
    ds_read_b64 v[6:7], v15 offset:32768
    ds_read_b128 v[72:75], v18 offset:4096
    s_waitcnt lgkmcnt(12)
    v_mfma_f32_32x32x16_bf16 v[96:111], v[124:127], v[76:79], v[96:111]
    v_mul_f32 v44, v80, v54
    v_mul_f32 v45, v81, v54
    s_waitcnt lgkmcnt(11)
    v_dot2_f32_bf16 v20, v24, s54, 0
    v_dot2_f32_bf16 v21, v24, v24, 0
    v_dot2_f32_bf16 v22, v25, s54, 0
    v_dot2_f32_bf16 v23, v25, v25, 0
    ds_read_b128 v[76:79], v19 offset:4096
    s_waitcnt lgkmcnt(9)
    v_mfma_f32_32x32x16_bf16 v[96:111], v[128:131], v[64:67], v[96:111]
    v_mul_f32 v46, v82, v54
    v_mul_f32 v47, v83, v54
    v_dot2_f32_bf16 v20, v26, s54, v20
    v_dot2_f32_bf16 v21, v26, v26, v21
    v_dot2_f32_bf16 v22, v27, s54, v22
    v_dot2_f32_bf16 v23, v27, v27, v23
    ds_read_b128 v[64:67], v16 offset:8192
    s_waitcnt lgkmcnt(6)
    v_mfma_f32_32x32x16_bf16 v[96:111], v[132:135], v[68:71], v[96:111]
    v_cvt_pk_bf16_f32 v36, v44, v45
    v_cvt_pk_bf16_f32 v37, v46, v47
    v_dot2_f32_bf16 v20, v28, s54, v20
    v_dot2_f32_bf16 v21, v28, v28, v21
    v_dot2_f32_bf16 v22, v29, s54, v22
    v_dot2_f32_bf16 v23, v29, v29, v23
    ds_read_b128 v[68:71], v17 offset:8192
    s_waitcnt lgkmcnt(3)
    v_mfma_f32_32x32x16_bf16 v[96:111], v[136:139], v[72:75], v[96:111]
    v_mul_f32 v48, v84, v54
    v_dot2_f32_bf16 v20, v30, s54, v20
    v_dot2_f32_bf16 v21, v30, v30, v21
    v_dot2_f32_bf16 v22, v31, s54, v22
    v_dot2_f32_bf16 v23, v31, v31, v23
    ds_read_b128 v[72:75], v18 offset:8192
    s_waitcnt lgkmcnt(3)
    v_mfma_f32_32x32x16_bf16 v[96:111], v[140:143], v[76:79], v[96:111]
    v_mul_f32 v49, v85, v54
    v_mul_f32 v50, v86, v54
    v_dot2_f32_bf16 v20, v32, s54, v20
    v_dot2_f32_bf16 v21, v32, v32, v21
    v_dot2_f32_bf16 v22, v33, s54, v22
    v_dot2_f32_bf16 v23, v33, v33, v23
    ds_read_b128 v[76:79], v19 offset:8192
    s_waitcnt lgkmcnt(3)
    v_mfma_f32_32x32x16_bf16 v[96:111], v[144:147], v[64:67], v[96:111]
    v_mul_f32 v51, v87, v54
    v_cvt_pk_bf16_f32 v38, v48, v49
    v_dot2_f32_bf16 v20, v34, s54, v20
    v_dot2_f32_bf16 v21, v34, v34, v21
    v_dot2_f32_bf16 v22, v35, s54, v22
    v_dot2_f32_bf16 v23, v35, v35, v23
    ds_read_b128 v[64:67], v16 offset:12288
    s_waitcnt lgkmcnt(3)
    v_mfma_f32_32x32x16_bf16 v[96:111], v[148:151], v[68:71], v[96:111]
    v_cvt_pk_bf16_f32 v39, v50, v51
    v_dot2_f32_bf16 v20, v2, s54, v20
    v_dot2_f32_bf16 v21, v2, v2, v21
    v_dot2_f32_bf16 v22, v3, s54, v22
    v_dot2_f32_bf16 v23, v3, v3, v23
    ds_read_b128 v[68:71], v17 offset:12288
    s_waitcnt lgkmcnt(3)
    v_mfma_f32_32x32x16_bf16 v[96:111], v[152:155], v[72:75], v[96:111]
    buffer_store_dwordx4 v[36:39], v12, s[32:35], s50 offen offset:2048 sc1
    v_dot2_f32_bf16 v20, v4, s54, v20
    v_dot2_f32_bf16 v21, v4, v4, v21
    v_dot2_f32_bf16 v22, v5, s54, v22
    v_dot2_f32_bf16 v23, v5, v5, v23
    ds_read_b128 v[72:75], v18 offset:12288
    s_waitcnt lgkmcnt(3)
    v_mfma_f32_32x32x16_bf16 v[96:111], v[156:159], v[76:79], v[96:111]
    v_mul_f32 v44, v88, v54
    v_mul_f32 v45, v89, v54
    v_dot2_f32_bf16 v20, v6, s54, v20
    v_dot2_f32_bf16 v21, v6, v6, v21
    v_dot2_f32_bf16 v22, v7, s54, v22
    v_dot2_f32_bf16 v23, v7, v7, v23
    ds_read_b128 v[76:79], v19 offset:12288
    s_waitcnt lgkmcnt(3)
    v_mfma_f32_32x32x16_bf16 v[96:111], v[160:163], v[64:67], v[96:111]
    v_mul_f32 v46, v90, v54
    v_add_f32 v20, v20, v22
    v_add_f32 v21, v21, v23
    ds_read_b128 v[64:67], v16 offset:16384
    s_waitcnt lgkmcnt(3)
    v_mfma_f32_32x32x16_bf16 v[96:111], v[164:167], v[68:71], v[96:111]
    v_add_f32_dpp v20, v20, v20 row_ror:8 row_mask:0xf bank_mask:0xf
    v_add_f32_dpp v21, v21, v21 row_ror:8 row_mask:0xf bank_mask:0xf
    ds_read_b128 v[68:71], v17 offset:16384
    s_waitcnt lgkmcnt(3)
    v_mfma_f32_32x32x16_bf16 v[96:111], v[168:171], v[72:75], v[96:111]
    v_add_f32_dpp v20, v20, v20 row_ror:4 row_mask:0xf bank_mask:0xf
    v_add_f32_dpp v21, v21, v21 row_ror:4 row_mask:0xf bank_mask:0xf
    ds_read_b128 v[72:75], v18 offset:16384
    s_waitcnt lgkmcnt(3)
    v_mfma_f32_32x32x16_bf16 v[96:111], v[172:175], v[76:79], v[96:111]
    v_add_f32_dpp v20, v20, v20 row_ror:2 row_mask:0xf bank_mask:0xf
    v_add_f32_dpp v21, v21, v21 row_ror:2 row_mask:0xf bank_mask:0xf
    ds_read_b128 v[76:79], v19 offset:16384
    s_waitcnt lgkmcnt(3)
    v_mfma_f32_32x32x16_bf16 v[96:111], v[176:179], v[64:67], v[96:111]
    v_add_f32_dpp v20, v20, v20 row_ror:1 row_mask:0xf bank_mask:0xf
    v_add_f32_dpp v21, v21, v21 row_ror:1 row_mask:0xf bank_mask:0xf
    ds_read_b128 v[64:67], v16 offset:20480
    s_waitcnt lgkmcnt(3)
    v_mfma_f32_32x32x16_bf16 v[96:111], v[180:183], v[68:71], v[96:111]
    v_mul_f32 v20, 0x3ae38e39, v20
    v_mul_f32 v21, 0x3ae38e39, v21
    ds_read_b128 v[68:71], v17 offset:20480
    s_waitcnt lgkmcnt(3)
    v_mfma_f32_32x32x16_bf16 v[96:111], v[184:187], v[72:75], v[96:111]
    v_fma_f32 v21, -v20, v20, v21
    v_max_f32 v21, 0, v21
    ds_read_b128 v[72:75], v18 offset:20480
    s_waitcnt lgkmcnt(3)
    v_mfma_f32_32x32x16_bf16 v[96:111], v[188:191], v[76:79], v[96:111]
    v_add_f32 v21, 0x3727c5ac, v21
    v_rsq_f32 v26, v21
    ds_read_b128 v[76:79], v19 offset:20480
    s_waitcnt lgkmcnt(3)
    v_mfma_f32_32x32x16_bf16 v[96:111], v[192:195], v[64:67], v[96:111]
    v_mul_f32 v27, v21, v26
    v_cvt_pk_bf16_f32 v24, -v20, v27
    ds_read_b128 v[64:67], v16 offset:24576
    s_waitcnt lgkmcnt(3)
    v_mfma_f32_32x32x16_bf16 v[96:111], v[196:199], v[68:71], v[96:111]
    v_lshlrev_b32 v28, 16, v24
    v_and_b32 v29, 0xffff0000, v24
    ds_read_b128 v[68:71], v17 offset:24576
    s_waitcnt lgkmcnt(3)
    v_mfma_f32_32x32x16_bf16 v[96:111], v[200:203], v[72:75], v[96:111]
    v_sub_f32 v28, -v20, v28
    v_sub_f32 v29, v27, v29
    ds_read_b128 v[72:75], v18 offset:24576
    s_waitcnt lgkmcnt(3)
    v_mfma_f32_32x32x16_bf16 v[96:111], v[204:207], v[76:79], v[96:111]
    v_cvt_pk_bf16_f32 v25, v28, v29
    ds_write_b128 v14, v[24:27] offset:512
    ds_read_b128 v[76:79], v19 offset:24576
    s_waitcnt lgkmcnt(4)
    v_mfma_f32_32x32x16_bf16 v[96:111], v[208:211], v[64:67], v[96:111]
    ds_read_b128 v[64:67], v16 offset:28672
    s_waitcnt lgkmcnt(4)
    v_mfma_f32_32x32x16_bf16 v[96:111], v[212:215], v[68:71], v[96:111]
    ds_read_b128 v[68:71], v17 offset:28672
    s_waitcnt lgkmcnt(4)
    v_mfma_f32_32x32x16_bf16 v[96:111], v[216:219], v[72:75], v[96:111]
    ds_read_b128 v[72:75], v18 offset:28672
    s_waitcnt lgkmcnt(3)
    v_mfma_f32_32x32x16_bf16 v[96:111], v[220:223], v[76:79], v[96:111]
    v_mul_f32 v47, v91, v54
    ds_read_b128 v[76:79], v19 offset:28672
    s_waitcnt lgkmcnt(3)
    v_mfma_f32_32x32x16_bf16 v[96:111], v[224:227], v[64:67], v[96:111]
    v_cvt_pk_bf16_f32 v40, v44, v45
    v_cvt_pk_bf16_f32 v41, v46, v47
    ds_read_b128 v[64:67], v16 offset:32768
    s_waitcnt lgkmcnt(3)
    v_mfma_f32_32x32x16_bf16 v[96:111], v[228:231], v[68:71], v[96:111]
    v_mul_f32 v48, v92, v54
    v_mul_f32 v49, v93, v54
    ds_read_b128 v[68:71], v17 offset:32768
    s_waitcnt lgkmcnt(3)
    v_mfma_f32_32x32x16_bf16 v[96:111], v[232:235], v[72:75], v[96:111]
    v_mul_f32 v50, v94, v54
    s_waitcnt vmcnt(1)
    s_barrier
    ds_read_b128 v[56:59], v13 offset:512
    ds_read_b128 v[72:75], v18 offset:32768
    s_waitcnt lgkmcnt(4)
    v_mfma_f32_32x32x16_bf16 v[96:111], v[236:239], v[76:79], v[96:111]
    v_mul_f32 v51, v95, v54
    v_cvt_pk_bf16_f32 v42, v48, v49
    ds_read_b128 v[76:79], v19 offset:32768
    s_waitcnt lgkmcnt(4)
    v_mfma_f32_32x32x16_bf16 v[96:111], v[240:243], v[64:67], v[96:111]
    v_cvt_pk_bf16_f32 v43, v50, v51
    buffer_store_dwordx4 v[40:43], v12, s[32:35], s51 offen offset:2048 sc1
    v_add_u32 v16, 0xffff6000, v16
    v_add_u32 v17, 0xffff6000, v17
    v_add_u32 v18, 0xffff6000, v18
    v_add_u32 v19, 0xffff6000, v19
    v_add_u32 v15, 0xffff6000, v15
    ds_read_b128 v[64:67], v16 offset:0
    s_waitcnt lgkmcnt(4)
    v_mfma_f32_32x32x16_bf16 v[96:111], v[244:247], v[68:71], v[96:111]
    ds_read_b128 v[68:71], v17 offset:0
    s_waitcnt lgkmcnt(3)
    v_mfma_f32_32x32x16_bf16 v[96:111], v[248:251], v[72:75], v[96:111]
    ds_read_b128 v[72:75], v18 offset:0
    s_waitcnt lgkmcnt(3)
    v_mfma_f32_32x32x16_bf16 v[96:111], v[252:255], v[76:79], v[96:111]
    s_cmp_le_u32 s44, 6
    s_cbranch_scc1 L_k1tail5_8
    ds_read_b128 v[76:79], v19 offset:0
    s_waitcnt lgkmcnt(3)
    v_mfma_f32_32x32x16_bf16 v[80:95], v[112:115], v[64:67], 0
    ds_read_b64 v[24:25], v15 offset:0
    ds_read_b64 v[26:27], v15 offset:4096
    ds_read_b64 v[28:29], v15 offset:8192
    ds_read_b128 v[64:67], v16 offset:4096
    s_waitcnt lgkmcnt(6)
    v_mfma_f32_32x32x16_bf16 v[80:95], v[116:119], v[68:71], v[80:95]
    v_mfma_f32_32x32x8bf16_1k v[96:111], v[62:63], v[56:57], v[96:111]
    ds_read_b64 v[30:31], v15 offset:12288
    ds_read_b64 v[32:33], v15 offset:16384
    ds_read_b64 v[34:35], v15 offset:20480
    ds_read_b128 v[68:71], v17 offset:4096
    s_waitcnt lgkmcnt(9)
    v_mfma_f32_32x32x16_bf16 v[80:95], v[120:123], v[72:75], v[80:95]
    ds_read_b64 v[2:3], v15 offset:24576
    ds_read_b64 v[4:5], v15 offset:28672
    ds_read_b64 v[6:7], v15 offset:32768
    ds_read_b128 v[72:75], v18 offset:4096
    s_waitcnt lgkmcnt(12)
    v_mfma_f32_32x32x16_bf16 v[80:95], v[124:127], v[76:79], v[80:95]
    v_mul_f32 v44, v96, v58
    v_mul_f32 v45, v97, v58
    s_waitcnt lgkmcnt(11)
    v_dot2_f32_bf16 v20, v24, s54, 0
    v_dot2_f32_bf16 v21, v24, v24, 0
    v_dot2_f32_bf16 v22, v25, s54, 0
    v_dot2_f32_bf16 v23, v25, v25, 0
    ds_read_b128 v[76:79], v19 offset:4096
    s_waitcnt lgkmcnt(9)
    v_mfma_f32_32x32x16_bf16 v[80:95], v[128:131], v[64:67], v[80:95]
    v_mul_f32 v46, v98, v58
    v_mul_f32 v47, v99, v58
    v_dot2_f32_bf16 v20, v26, s54, v20
    v_dot2_f32_bf16 v21, v26, v26, v21
    v_dot2_f32_bf16 v22, v27, s54, v22
    v_dot2_f32_bf16 v23, v27, v27, v23
    ds_read_b128 v[64:67], v16 offset:8192
    s_waitcnt lgkmcnt(6)
    v_mfma_f32_32x32x16_bf16 v[80:95], v[132:135], v[68:71], v[80:95]
    v_cvt_pk_bf16_f32 v36, v44, v45
    v_cvt_pk_bf16_f32 v37, v46, v47
    v_dot2_f32_bf16 v20, v28, s54, v20
    v_dot2_f32_bf16 v21, v28, v28, v21
    v_dot2_f32_bf16 v22, v29, s54, v22
    v_dot2_f32_bf16 v23, v29, v29, v23
    ds_read_b128 v[68:71], v17 offset:8192
    s_waitcnt lgkmcnt(3)
    v_mfma_f32_32x32x16_bf16 v[80:95], v[136:139], v[72:75], v[80:95]
    v_mul_f32 v48, v100, v58
    v_dot2_f32_bf16 v20, v30, s54, v20
    v_dot2_f32_bf16 v21, v30, v30, v21
    v_dot2_f32_bf16 v22, v31, s54, v22
    v_dot2_f32_bf16 v23, v31, v31, v23
    ds_read_b128 v[72:75], v18 offset:8192
    s_waitcnt lgkmcnt(3)
    v_mfma_f32_32x32x16_bf16 v[80:95], v[140:143], v[76:79], v[80:95]
    v_mul_f32 v49, v101, v58
    v_mul_f32 v50, v102, v58
    v_dot2_f32_bf16 v20, v32, s54, v20
    v_dot2_f32_bf16 v21, v32, v32, v21
    v_dot2_f32_bf16 v22, v33, s54, v22
    v_dot2_f32_bf16 v23, v33, v33, v23
    ds_read_b128 v[76:79], v19 offset:8192
    s_waitcnt lgkmcnt(3)
    v_mfma_f32_32x32x16_bf16 v[80:95], v[144:147], v[64:67], v[80:95]
    v_mul_f32 v51, v103, v58
    v_cvt_pk_bf16_f32 v38, v48, v49
    v_dot2_f32_bf16 v20, v34, s54, v20
    v_dot2_f32_bf16 v21, v34, v34, v21
    v_dot2_f32_bf16 v22, v35, s54, v22
    v_dot2_f32_bf16 v23, v35, v35, v23
    ds_read_b128 v[64:67], v16 offset:12288
    s_waitcnt lgkmcnt(3)
    v_mfma_f32_32x32x16_bf16 v[80:95], v[148:151], v[68:71], v[80:95]
    v_cvt_pk_bf16_f32 v39, v50, v51
    v_dot2_f32_bf16 v20, v2, s54, v20
    v_dot2_f32_bf16 v21, v2, v2, v21
    v_dot2_f32_bf16 v22, v3, s54, v22
    v_dot2_f32_bf16 v23, v3, v3, v23
    ds_read_b128 v[68:71], v17 offset:12288
    s_waitcnt lgkmcnt(3)
    v_mfma_f32_32x32x16_bf16 v[80:95], v[152:155], v[72:75], v[80:95]
    buffer_store_dwordx4 v[36:39], v12, s[32:35], s50 offen offset:2560 sc1
    v_dot2_f32_bf16 v20, v4, s54, v20
    v_dot2_f32_bf16 v21, v4, v4, v21
    v_dot2_f32_bf16 v22, v5, s54, v22
    v_dot2_f32_bf16 v23, v5, v5, v23
    ds_read_b128 v[72:75], v18 offset:12288
    s_waitcnt lgkmcnt(3)
    v_mfma_f32_32x32x16_bf16 v[80:95], v[156:159], v[76:79], v[80:95]
    v_mul_f32 v44, v104, v58
    v_mul_f32 v45, v105, v58
    v_dot2_f32_bf16 v20, v6, s54, v20
    v_dot2_f32_bf16 v21, v6, v6, v21
    v_dot2_f32_bf16 v22, v7, s54, v22
    v_dot2_f32_bf16 v23, v7, v7, v23
    ds_read_b128 v[76:79], v19 offset:12288
    s_waitcnt lgkmcnt(3)
    v_mfma_f32_32x32x16_bf16 v[80:95], v[160:163], v[64:67], v[80:95]
    v_mul_f32 v46, v106, v58
    v_add_f32 v20, v20, v22
    v_add_f32 v21, v21, v23
    ds_read_b128 v[64:67], v16 offset:16384
    s_waitcnt lgkmcnt(3)
    v_mfma_f32_32x32x16_bf16 v[80:95], v[164:167], v[68:71], v[80:95]
    v_add_f32_dpp v20, v20, v20 row_ror:8 row_mask:0xf bank_mask:0xf
    v_add_f32_dpp v21, v21, v21 row_ror:8 row_mask:0xf bank_mask:0xf
    ds_read_b128 v[68:71], v17 offset:16384
    s_waitcnt lgkmcnt(3)
    v_mfma_f32_32x32x16_bf16 v[80:95], v[168:171], v[72:75], v[80:95]
    v_add_f32_dpp v20, v20, v20 row_ror:4 row_mask:0xf bank_mask:0xf
    v_add_f32_dpp v21, v21, v21 row_ror:4 row_mask:0xf bank_mask:0xf
    ds_read_b128 v[72:75], v18 offset:16384
    s_waitcnt lgkmcnt(3)
    v_mfma_f32_32x32x16_bf16 v[80:95], v[172:175], v[76:79], v[80:95]
    v_add_f32_dpp v20, v20, v20 row_ror:2 row_mask:0xf bank_mask:0xf
    v_add_f32_dpp v21, v21, v21 row_ror:2 row_mask:0xf bank_mask:0xf
    ds_read_b128 v[76:79], v19 offset:16384
    s_waitcnt lgkmcnt(3)
    v_mfma_f32_32x32x16_bf16 v[80:95], v[176:179], v[64:67], v[80:95]
    v_add_f32_dpp v20, v20, v20 row_ror:1 row_mask:0xf bank_mask:0xf
    v_add_f32_dpp v21, v21, v21 row_ror:1 row_mask:0xf bank_mask:0xf
    ds_read_b128 v[64:67], v16 offset:20480
    s_waitcnt lgkmcnt(3)
    v_mfma_f32_32x32x16_bf16 v[80:95], v[180:183], v[68:71], v[80:95]
    v_mul_f32 v20, 0x3ae38e39, v20
    v_mul_f32 v21, 0x3ae38e39, v21
    ds_read_b128 v[68:71], v17 offset:20480
    s_waitcnt lgkmcnt(3)
    v_mfma_f32_32x32x16_bf16 v[80:95], v[184:187], v[72:75], v[80:95]
    v_fma_f32 v21, -v20, v20, v21
    v_max_f32 v21, 0, v21
    ds_read_b128 v[72:75], v18 offset:20480
    s_waitcnt lgkmcnt(3)
    v_mfma_f32_32x32x16_bf16 v[80:95], v[188:191], v[76:79], v[80:95]
    v_add_f32 v21, 0x3727c5ac, v21
    v_rsq_f32 v26, v21
    ds_read_b128 v[76:79], v19 offset:20480
    s_waitcnt lgkmcnt(3)
    v_mfma_f32_32x32x16_bf16 v[80:95], v[192:195], v[64:67], v[80:95]
    v_mul_f32 v27, v21, v26
    v_cvt_pk_bf16_f32 v24, -v20, v27
    ds_read_b128 v[64:67], v16 offset:24576
    s_waitcnt lgkmcnt(3)
    v_mfma_f32_32x32x16_bf16 v[80:95], v[196:199], v[68:71], v[80:95]
    v_lshlrev_b32 v28, 16, v24
    v_and_b32 v29, 0xffff0000, v24
    ds_read_b128 v[68:71], v17 offset:24576
    s_waitcnt lgkmcnt(3)
    v_mfma_f32_32x32x16_bf16 v[80:95], v[200:203], v[72:75], v[80:95]
    v_sub_f32 v28, -v20, v28
    v_sub_f32 v29, v27, v29
    ds_read_b128 v[72:75], v18 offset:24576
    s_waitcnt lgkmcnt(3)
    v_mfma_f32_32x32x16_bf16 v[80:95], v[204:207], v[76:79], v[80:95]
    v_cvt_pk_bf16_f32 v25, v28, v29
    ds_write_b128 v14, v[24:27] offset:0
    ds_read_b128 v[76:79], v19 offset:24576
    s_waitcnt lgkmcnt(4)
    v_mfma_f32_32x32x16_bf16 v[80:95], v[208:211], v[64:67], v[80:95]
    ds_read_b128 v[64:67], v16 offset:28672
    s_waitcnt lgkmcnt(4)
    v_mfma_f32_32x32x16_bf16 v[80:95], v[212:215], v[68:71], v[80:95]
    ds_read_b128 v[68:71], v17 offset:28672
    s_waitcnt lgkmcnt(4)
    v_mfma_f32_32x32x16_bf16 v[80:95], v[216:219], v[72:75], v[80:95]
    ds_read_b128 v[72:75], v18 offset:28672
    s_waitcnt lgkmcnt(3)
    v_mfma_f32_32x32x16_bf16 v[80:95], v[220:223], v[76:79], v[80:95]
    v_mul_f32 v47, v107, v58
    ds_read_b128 v[76:79], v19 offset:28672
    s_waitcnt lgkmcnt(3)
    v_mfma_f32_32x32x16_bf16 v[80:95], v[224:227], v[64:67], v[80:95]
    v_cvt_pk_bf16_f32 v40, v44, v45
    v_cvt_pk_bf16_f32 v41, v46, v47
    ds_read_b128 v[64:67], v16 offset:32768
    s_waitcnt lgkmcnt(3)
    v_mfma_f32_32x32x16_bf16 v[80:95], v[228:231], v[68:71], v[80:95]
    v_mul_f32 v48, v108, v58
    v_mul_f32 v49, v109, v58
    ds_read_b128 v[68:71], v17 offset:32768
    s_waitcnt lgkmcnt(3)
    v_mfma_f32_32x32x16_bf16 v[80:95], v[232:235], v[72:75], v[80:95]
    v_mul_f32 v50, v110, v58
    s_waitcnt vmcnt(1)
    s_barrier
    ds_read_b128 v[52:55], v13 offset:0
    ds_read_b128 v[72:75], v18 offset:32768
    s_waitcnt lgkmcnt(4)
    v_mfma_f32_32x32x16_bf16 v[80:95], v[236:239], v[76:79], v[80:95]
    v_mul_f32 v51, v111, v58
    v_cvt_pk_bf16_f32 v42, v48, v49
    ds_read_b128 v[76:79], v19 offset:32768
    s_waitcnt lgkmcnt(4)
    v_mfma_f32_32x32x16_bf16 v[80:95], v[240:243], v[64:67], v[80:95]
    v_cvt_pk_bf16_f32 v43, v50, v51
    buffer_store_dwordx4 v[40:43], v12, s[32:35], s51 offen offset:2560 sc1
    s_waitcnt lgkmcnt(3)
    v_mfma_f32_32x32x16_bf16 v[80:95], v[244:247], v[68:71], v[80:95]
    s_waitcnt lgkmcnt(1)
    v_mfma_f32_32x32x16_bf16 v[80:95], v[248:251], v[72:75], v[80:95]
    s_waitcnt lgkmcnt(0)
    v_mfma_f32_32x32x16_bf16 v[80:95], v[252:255], v[76:79], v[80:95]
    s_nop 7
    v_mfma_f32_32x32x8bf16_1k v[80:95], v[62:63], v[52:53], v[80:95]
    s_nop 7
    s_nop 7
    s_nop 7
    v_mul_f32 v44, v80, v54
    v_mul_f32 v45, v81, v54
    v_mul_f32 v46, v82, v54
    v_mul_f32 v47, v83, v54
    v_cvt_pk_bf16_f32 v36, v44, v45
    v_cvt_pk_bf16_f32 v37, v46, v47
    v_mul_f32 v48, v84, v54
    v_mul_f32 v49, v85, v54
    v_mul_f32 v50, v86, v54
    v_mul_f32 v51, v87, v54
    v_cvt_pk_bf16_f32 v38, v48, v49
    v_cvt_pk_bf16_f32 v39, v50, v51
    buffer_store_dwordx4 v[36:39], v12, s[32:35], s50 offen offset:3072 sc1
    v_mul_f32 v44, v88, v54
    v_mul_f32 v45, v89, v54
    v_mul_f32 v46, v90, v54
    v_mul_f32 v47, v91, v54
    v_cvt_pk_bf16_f32 v40, v44, v45
    v_cvt_pk_bf16_f32 v41, v46, v47
    v_mul_f32 v48, v92, v54
    v_mul_f32 v49, v93, v54
    v_mul_f32 v50, v94, v54
    v_mul_f32 v51, v95, v54
    v_cvt_pk_bf16_f32 v42, v48, v49
    v_cvt_pk_bf16_f32 v43, v50, v51
    buffer_store_dwordx4 v[40:43], v12, s[32:35], s51 offen offset:3072 sc1
    s_branch L_k1end_1
L_k1tail5_8:
    s_nop 7
    v_mfma_f32_32x32x8bf16_1k v[96:111], v[62:63], v[56:57], v[96:111]
    s_nop 7
    s_nop 7
    s_nop 7
    v_mul_f32 v44, v96, v58
    v_mul_f32 v45, v97, v58
    v_mul_f32 v46, v98, v58
    v_mul_f32 v47, v99, v58
    v_cvt_pk_bf16_f32 v36, v44, v45
    v_cvt_pk_bf16_f32 v37, v46, v47
    v_mul_f32 v48, v100, v58
    v_mul_f32 v49, v101, v58
    v_mul_f32 v50, v102, v58
    v_mul_f32 v51, v103, v58
    v_cvt_pk_bf16_f32 v38, v48, v49
    v_cvt_pk_bf16_f32 v39, v50, v51
    buffer_store_dwordx4 v[36:39], v12, s[32:35], s50 offen offset:2560 sc1
    v_mul_f32 v44, v104, v58
    v_mul_f32 v45, v105, v58
    v_mul_f32 v46, v106, v58
    v_mul_f32 v47, v107, v58
    v_cvt_pk_bf16_f32 v40, v44, v45
    v_cvt_pk_bf16_f32 v41, v46, v47
    v_mul_f32 v48, v108, v58
    v_mul_f32 v49, v109, v58
    v_mul_f32 v50, v110, v58
    v_mul_f32 v51, v111, v58
    v_cvt_pk_bf16_f32 v42, v48, v49
    v_cvt_pk_bf16_f32 v43, v50, v51
    buffer_store_dwordx4 v[40:43], v12, s[32:35], s51 offen offset:2560 sc1
    s_waitcnt lgkmcnt(0)
    s_add_u32 s20, s12, 41943040
    s_addc_u32 s21, s13, 0
    s_and_b32 s21, s21, 0xffff
    s_mov_b32 s22, 5971968
    s_mov_b32 s23, 0x00020000
    v_and_b32 v2, 63, v0
    v_lshrrev_b32 v3, 4, v2
    v_lshlrev_b32 v4, 3, v3
    v_lshrrev_b32 v5, 2, v2
    v_and_b32 v5, 3, v5
    v_add_u32 v4, v4, v5
    v_lshlrev_b32 v6, 7, v4
    v_and_b32 v5, 2, v5
    v_and_b32 v3, 1, v3
    v_or_b32 v3, v3, v5
    s_and_b32 s58, s3, 3
    s_lshl_b32 s58, s58, 1
    v_lshrrev_b32 v5, 1, v2
    v_and_b32 v5, 1, v5
    v_or_b32 v5, s58, v5
    v_xor_b32 v3, v3, v5
    v_lshl_add_u32 v6, v3, 4, v6
    v_and_b32 v5, 1, v2
    v_lshl_add_u32 v6, v5, 3, v6
    s_lshr_b32 s58, s3, 2
    s_lshl_b32 s58, s58, 12
    s_add_u32 s58, s58, 0
    v_add_u32 v6, s58, v6
    v_xor_b32 v7, 64, v6
    v_lshlrev_b32 v3, 4, v2
    s_mul_i32 s59, s57, 9216

    ds_read_b64_tr_b16 v[64:65], v6 offset:0
    ds_read_b64_tr_b16 v[66:67], v7 offset:512
    ds_read_b64_tr_b16 v[68:69], v6 offset:8192
    ds_read_b64_tr_b16 v[70:71], v7 offset:8704
    ds_read_b64_tr_b16 v[72:73], v6 offset:16384
    ds_read_b64_tr_b16 v[74:75], v7 offset:16896
    ds_read_b64_tr_b16 v[76:77], v6 offset:24576
    ds_read_b64_tr_b16 v[78:79], v7 offset:25088
    ds_read_b64_tr_b16 v[80:81], v6 offset:32768
    ds_read_b64_tr_b16 v[82:83], v7 offset:33280
    s_add_u32 s58, s3, 0
    s_mul_i32 s60, s58, 57
    s_lshr_b32 s60, s60, 9
    s_mul_i32 s61, s60, 1483776
    s_lshl_b32 s58, s58, 10
    s_add_u32 s58, s58, s61
    s_add_u32 s58, s58, s59
    s_waitcnt lgkmcnt(8)
    buffer_store_dwordx4 v[64:67], v3, s[20:23], s58 offen sc1

    s_add_u32 s58, s3, 8
    s_mul_i32 s60, s58, 57
    s_lshr_b32 s60, s60, 9
    s_mul_i32 s61, s60, 1483776
    s_lshl_b32 s58, s58, 10
    s_add_u32 s58, s58, s61
    s_add_u32 s58, s58, s59
    s_waitcnt lgkmcnt(6)
    buffer_store_dwordx4 v[68:71], v3, s[20:23], s58 offen sc1

    s_add_u32 s58, s3, 16
    s_mul_i32 s60, s58, 57
    s_lshr_b32 s60, s60, 9
    s_mul_i32 s61, s60, 1483776
    s_lshl_b32 s58, s58, 10
    s_add_u32 s58, s58, s61
    s_add_u32 s58, s58, s59
    s_waitcnt lgkmcnt(4)
    buffer_store_dwordx4 v[72:75], v3, s[20:23], s58 offen sc1

    s_add_u32 s58, s3, 24
    s_mul_i32 s60, s58, 57
    s_lshr_b32 s60, s60, 9
    s_mul_i32 s61, s60, 1483776
    s_lshl_b32 s58, s58, 10
    s_add_u32 s58, s58, s61
    s_add_u32 s58, s58, s59
    s_waitcnt lgkmcnt(2)
    buffer_store_dwordx4 v[76:79], v3, s[20:23], s58 offen sc1

    s_cmp_ge_u32 s3, 4
    s_cbranch_scc1 L_rlskip_10
    s_add_u32 s58, s3, 32
    s_mul_i32 s60, s58, 57
    s_lshr_b32 s60, s60, 9
    s_mul_i32 s61, s60, 1483776
    s_lshl_b32 s58, s58, 10
    s_add_u32 s58, s58, s61
    s_add_u32 s58, s58, s59
    s_waitcnt lgkmcnt(0)
    buffer_store_dwordx4 v[80:83], v3, s[20:23], s58 offen sc1

L_rlskip_10:
    s_waitcnt lgkmcnt(0)
    s_branch L_k1end_1
L_hpath_6:
    s_waitcnt vmcnt(12) lgkmcnt(0)
    s_barrier
    s_add_u32 m0, s48, 139264
    s_nop 0
    buffer_load_dwordx4 v10, s[20:23], s26 offen lds
    s_add_u32 s26, s26, s25
    s_add_u32 m0, s48, 147456
    s_nop 0
    buffer_load_dwordx4 v10, s[20:23], s26 offen lds
    s_add_u32 s26, s26, s25
    ds_read_b64_tr_b16 v[112:113], v9 offset:0
    ds_read_b64_tr_b16 v[114:115], v9 offset:256
    ds_read_b128 v[64:67], v16 offset:0
    ds_read_b64_tr_b16 v[116:117], v9 offset:8192
    ds_read_b64_tr_b16 v[118:119], v9 offset:8448
    ds_read_b128 v[68:71], v17 offset:0
    ds_read_b64 v[24:25], v15 offset:0
    s_waitcnt vmcnt(12) lgkmcnt(0)
    s_barrier
    s_add_u32 m0, s48, 40960
    s_nop 0
    buffer_load_dwordx4 v10, s[20:23], s26 offen lds
    s_add_u32 s26, s26, s25
    s_add_u32 m0, s48, 49152
    s_nop 0
    buffer_load_dwordx4 v10, s[20:23], s26 offen lds
    s_add_u32 s26, s26, s25
    ds_read_b64_tr_b16 v[120:121], v9 offset:16384
    ds_read_b64_tr_b16 v[122:123], v9 offset:16640
    ds_read_b128 v[72:75], v18 offset:0
    ds_read_b64_tr_b16 v[124:125], v9 offset:24576
    ds_read_b64_tr_b16 v[126:127], v9 offset:24832
    ds_read_b128 v[76:79], v19 offset:0
    v_dot2_f32_bf16 v5, v112, s54, v5
    v_dot2_f32_bf16 v6, v113, s54, v6
    v_dot2_f32_bf16 v5, v114, s54, v5
    v_dot2_f32_bf16 v6, v115, s54, v6
    v_dot2_f32_bf16 v5, v116, s54, v5
    v_dot2_f32_bf16 v6, v117, s54, v6
    v_dot2_f32_bf16 v5, v118, s54, v5
    v_dot2_f32_bf16 v6, v119, s54, v6
    v_dot2_f32_bf16 v20, v24, s54, 0
    v_dot2_f32_bf16 v21, v24, v24, 0
    v_dot2_f32_bf16 v22, v25, s54, 0
    v_dot2_f32_bf16 v23, v25, v25, 0
    v_mfma_f32_32x32x16_bf16 v[80:95], v[112:115], v[64:67], 0
    v_mfma_f32_32x32x16_bf16 v[80:95], v[116:119], v[68:71], v[80:95]
    ds_read_b64 v[26:27], v15 offset:4096
    s_waitcnt vmcnt(11) lgkmcnt(0)
    s_barrier
    s_add_u32 m0, s48, 57344
    s_nop 0
    buffer_load_dwordx4 v10, s[20:23], s26 offen lds
    s_add_u32 s26, s26, s25
    s_add_u32 m0, s48, 65536
    s_nop 0
    buffer_load_dwordx4 v10, s[20:23], s26 offen lds
    s_add_u32 s26, s26, s25
    ds_read_b64_tr_b16 v[128:129], v9 offset:32768
    ds_read_b64_tr_b16 v[130:131], v9 offset:33024
    ds_read_b128 v[64:67], v16 offset:4096
    ds_read_b64_tr_b16 v[132:133], v9 offset:40960
    ds_read_b64_tr_b16 v[134:135], v9 offset:41216
    ds_read_b128 v[68:71], v17 offset:4096
    v_dot2_f32_bf16 v5, v120, s54, v5
    v_dot2_f32_bf16 v6, v121, s54, v6
    v_dot2_f32_bf16 v5, v122, s54, v5
    v_dot2_f32_bf16 v6, v123, s54, v6
    v_dot2_f32_bf16 v5, v124, s54, v5
    v_dot2_f32_bf16 v6, v125, s54, v6
    v_dot2_f32_bf16 v5, v126, s54, v5
    v_dot2_f32_bf16 v6, v127, s54, v6
    v_dot2_f32_bf16 v20, v26, s54, v20
    v_dot2_f32_bf16 v21, v26, v26, v21
    v_dot2_f32_bf16 v22, v27, s54, v22
    v_dot2_f32_bf16 v23, v27, v27, v23
    v_mfma_f32_32x32x16_bf16 v[80:95], v[120:123], v[72:75], v[80:95]
    v_mfma_f32_32x32x16_bf16 v[80:95], v[124:127], v[76:79], v[80:95]
    ds_read_b64 v[28:29], v15 offset:8192
    s_waitcnt vmcnt(11) lgkmcnt(0)
    s_barrier
    s_add_u32 m0, s48, 73728
    s_nop 0
    buffer_load_dwordx4 v10, s[20:23], s26 offen lds
    s_add_u32 s26, s26, s25
    s_add_u32 m0, s48, 81920
    s_nop 0
    buffer_load_dwordx4 v10, s[20:23], s26 offen lds
    s_add_u32 s26, s26, s25
    buffer_store_dwordx4 v[36:39], v40, s[60:63], 0 offen sc1
    ds_read_b64_tr_b16 v[136:137], v9 offset:49152
    ds_read_b64_tr_b16 v[138:139], v9 offset:49408
    ds_read_b128 v[72:75], v18 offset:4096
    ds_read_b64_tr_b16 v[140:141], v9 offset:57344
    ds_read_b64_tr_b16 v[142:143], v9 offset:57600
    ds_read_b128 v[76:79], v19 offset:4096
    v_dot2_f32_bf16 v5, v128, s54, v5
    v_dot2_f32_bf16 v6, v129, s54, v6
    v_dot2_f32_bf16 v5, v130, s54, v5
    v_dot2_f32_bf16 v6, v131, s54, v6
    v_dot2_f32_bf16 v5, v132, s54, v5
    v_dot2_f32_bf16 v6, v133, s54, v6
    v_dot2_f32_bf16 v5, v134, s54, v5
    v_dot2_f32_bf16 v6, v135, s54, v6
    v_dot2_f32_bf16 v20, v28, s54, v20
    v_dot2_f32_bf16 v21, v28, v28, v21
    v_dot2_f32_bf16 v22, v29, s54, v22
    v_dot2_f32_bf16 v23, v29, v29, v23
    v_mfma_f32_32x32x16_bf16 v[80:95], v[128:131], v[64:67], v[80:95]
    v_mfma_f32_32x32x16_bf16 v[80:95], v[132:135], v[68:71], v[80:95]
    ds_read_b64 v[30:31], v15 offset:12288
    s_waitcnt vmcnt(12) lgkmcnt(0)
    s_barrier
    s_add_u32 m0, s48, 90112
    s_nop 0
    buffer_load_dwordx4 v10, s[20:23], s26 offen lds
    s_add_u32 s26, s26, s25
    s_add_u32 m0, s48, 98304
    s_nop 0
    buffer_load_dwordx4 v10, s[20:23], s26 offen lds
    s_add_u32 s26, s26, s25
    ds_read_b64_tr_b16 v[144:145], v8 offset:0
    ds_read_b64_tr_b16 v[146:147], v8 offset:256
    ds_read_b128 v[64:67], v16 offset:8192
    ds_read_b64_tr_b16 v[148:149], v8 offset:8192
    ds_read_b64_tr_b16 v[150:151], v8 offset:8448
    ds_read_b128 v[68:71], v17 offset:8192
    v_dot2_f32_bf16 v5, v136, s54, v5
    v_dot2_f32_bf16 v6, v137, s54, v6
    v_dot2_f32_bf16 v5, v138, s54, v5
    v_dot2_f32_bf16 v6, v139, s54, v6
    v_dot2_f32_bf16 v5, v140, s54, v5
    v_dot2_f32_bf16 v6, v141, s54, v6
    v_dot2_f32_bf16 v5, v142, s54, v5
    v_dot2_f32_bf16 v6, v143, s54, v6
    v_dot2_f32_bf16 v20, v30, s54, v20
    v_dot2_f32_bf16 v21, v30, v30, v21
    v_dot2_f32_bf16 v22, v31, s54, v22
    v_dot2_f32_bf16 v23, v31, v31, v23
    v_mfma_f32_32x32x16_bf16 v[80:95], v[136:139], v[72:75], v[80:95]
    v_mfma_f32_32x32x16_bf16 v[80:95], v[140:143], v[76:79], v[80:95]
    ds_read_b64 v[32:33], v15 offset:16384
    s_waitcnt vmcnt(12) lgkmcnt(0)
    s_barrier
    s_add_u32 m0, s48, 106496
    s_nop 0
    buffer_load_dwordx4 v10, s[20:23], s26 offen lds
    s_add_u32 s26, s26, s25
    s_add_u32 m0, s48, 114688
    s_nop 0
    buffer_load_dwordx4 v10, s[20:23], s26 offen lds
    s_add_u32 s26, s26, s25
    buffer_store_dwordx4 v[36:39], v40, s[60:63], s58 offen sc1
    ds_read_b64_tr_b16 v[152:153], v8 offset:16384
    ds_read_b64_tr_b16 v[154:155], v8 offset:16640
    ds_read_b128 v[72:75], v18 offset:8192
    ds_read_b64_tr_b16 v[156:157], v8 offset:24576
    ds_read_b64_tr_b16 v[158:159], v8 offset:24832
    ds_read_b128 v[76:79], v19 offset:8192
    v_dot2_f32_bf16 v5, v144, s54, v5
    v_dot2_f32_bf16 v6, v145, s54, v6
    v_dot2_f32_bf16 v5, v146, s54, v5
    v_dot2_f32_bf16 v6, v147, s54, v6
    v_dot2_f32_bf16 v5, v148, s54, v5
    v_dot2_f32_bf16 v6, v149, s54, v6
    v_dot2_f32_bf16 v5, v150, s54, v5
    v_dot2_f32_bf16 v6, v151, s54, v6
    v_dot2_f32_bf16 v20, v32, s54, v20
    v_dot2_f32_bf16 v21, v32, v32, v21
    v_dot2_f32_bf16 v22, v33, s54, v22
    v_dot2_f32_bf16 v23, v33, v33, v23
    v_mfma_f32_32x32x16_bf16 v[80:95], v[144:147], v[64:67], v[80:95]
    v_mfma_f32_32x32x16_bf16 v[80:95], v[148:151], v[68:71], v[80:95]
    ds_read_b64 v[34:35], v15 offset:20480
    s_waitcnt vmcnt(12) lgkmcnt(0)
    s_barrier
    s_add_u32 m0, s48, 122880
    s_nop 0
    buffer_load_dwordx4 v10, s[20:23], s26 offen lds
    s_add_u32 s26, s26, s25
    s_add_u32 m0, s48, 131072
    s_nop 0
    buffer_load_dwordx4 v10, s[20:23], s26 offen lds
    s_add_u32 s26, s26, s25
    ds_read_b64_tr_b16 v[160:161], v8 offset:32768
    ds_read_b64_tr_b16 v[162:163], v8 offset:33024
    ds_read_b128 v[64:67], v16 offset:12288
    ds_read_b64_tr_b16 v[164:165], v8 offset:40960
    ds_read_b64_tr_b16 v[166:167], v8 offset:41216
    ds_read_b128 v[68:71], v17 offset:12288
    v_dot2_f32_bf16 v5, v152, s54, v5
    v_dot2_f32_bf16 v6, v153, s54, v6
    v_dot2_f32_bf16 v5, v154, s54, v5
    v_dot2_f32_bf16 v6, v155, s54, v6
    v_dot2_f32_bf16 v5, v156, s54, v5
    v_dot2_f32_bf16 v6, v157, s54, v6
    v_dot2_f32_bf16 v5, v158, s54, v5
    v_dot2_f32_bf16 v6, v159, s54, v6
    v_dot2_f32_bf16 v20, v34, s54, v20
    v_dot2_f32_bf16 v21, v34, v34, v21
    v_dot2_f32_bf16 v22, v35, s54, v22
    v_dot2_f32_bf16 v23, v35, v35, v23
    v_mfma_f32_32x32x16_bf16 v[80:95], v[152:155], v[72:75], v[80:95]
    v_mfma_f32_32x32x16_bf16 v[80:95], v[156:159], v[76:79], v[80:95]
    ds_read_b64 v[24:25], v15 offset:24576
    s_waitcnt vmcnt(12) lgkmcnt(0)
    s_barrier
    s_add_u32 m0, s48, 139264
    s_nop 0
    buffer_load_dwordx4 v10, s[20:23], s26 offen lds
    s_add_u32 s26, s26, s25
    s_add_u32 m0, s48, 147456
    s_nop 0
    buffer_load_dwordx4 v10, s[20:23], s26 offen lds
    s_add_u32 s26, s26, s25
    buffer_store_dwordx4 v[36:39], v40, s[60:63], s59 offen sc1
    ds_read_b64_tr_b16 v[168:169], v9 offset:0
    ds_read_b64_tr_b16 v[170:171], v9 offset:256
    ds_read_b128 v[72:75], v18 offset:12288
    ds_read_b64_tr_b16 v[172:173], v9 offset:8192
    ds_read_b64_tr_b16 v[174:175], v9 offset:8448
    ds_read_b128 v[76:79], v19 offset:12288
    v_dot2_f32_bf16 v5, v160, s54, v5
    v_dot2_f32_bf16 v6, v161, s54, v6
    v_dot2_f32_bf16 v5, v162, s54, v5
    v_dot2_f32_bf16 v6, v163, s54, v6
    v_dot2_f32_bf16 v5, v164, s54, v5
    v_dot2_f32_bf16 v6, v165, s54, v6
    v_dot2_f32_bf16 v5, v166, s54, v5
    v_dot2_f32_bf16 v6, v167, s54, v6
    v_dot2_f32_bf16 v20, v24, s54, v20
    v_dot2_f32_bf16 v21, v24, v24, v21
    v_dot2_f32_bf16 v22, v25, s54, v22
    v_dot2_f32_bf16 v23, v25, v25, v23
    v_mfma_f32_32x32x16_bf16 v[80:95], v[160:163], v[64:67], v[80:95]
    v_mfma_f32_32x32x16_bf16 v[80:95], v[164:167], v[68:71], v[80:95]
    ds_read_b64 v[26:27], v15 offset:28672
    s_waitcnt vmcnt(13) lgkmcnt(0)
    s_barrier
    s_add_u32 m0, s48, 40960
    s_nop 0
    buffer_load_dwordx4 v10, s[20:23], s26 offen lds
    s_add_u32 s26, s26, s25
    s_add_u32 m0, s48, 49152
    s_nop 0
    buffer_load_dwordx4 v10, s[20:23], s26 offen lds
    s_add_u32 s26, s26, s25
    ds_read_b64_tr_b16 v[176:177], v9 offset:16384
    ds_read_b64_tr_b16 v[178:179], v9 offset:16640
    ds_read_b128 v[64:67], v16 offset:16384
    ds_read_b64_tr_b16 v[180:181], v9 offset:24576
    ds_read_b64_tr_b16 v[182:183], v9 offset:24832
    ds_read_b128 v[68:71], v17 offset:16384
    v_dot2_f32_bf16 v5, v168, s54, v5
    v_dot2_f32_bf16 v6, v169, s54, v6
    v_dot2_f32_bf16 v5, v170, s54, v5
    v_dot2_f32_bf16 v6, v171, s54, v6
    v_dot2_f32_bf16 v5, v172, s54, v5
    v_dot2_f32_bf16 v6, v173, s54, v6
    v_dot2_f32_bf16 v5, v174, s54, v5
    v_dot2_f32_bf16 v6, v175, s54, v6
    v_dot2_f32_bf16 v20, v26, s54, v20
    v_dot2_f32_bf16 v21, v26, v26, v21
    v_dot2_f32_bf16 v22, v27, s54, v22
    v_dot2_f32_bf16 v23, v27, v27, v23
    v_mfma_f32_32x32x16_bf16 v[80:95], v[168:171], v[72:75], v[80:95]
    v_mfma_f32_32x32x16_bf16 v[80:95], v[172:175], v[76:79], v[80:95]
    ds_read_b64 v[28:29], v15 offset:32768
    s_waitcnt vmcnt(13) lgkmcnt(0)
    s_barrier
    s_add_u32 m0, s48, 57344
    s_nop 0
    buffer_load_dwordx4 v10, s[20:23], s26 offen lds
    s_add_u32 s26, s26, s25
    s_add_u32 m0, s48, 65536
    s_nop 0
    buffer_load_dwordx4 v10, s[20:23], s26 offen lds
    s_add_u32 s26, s26, s25
    buffer_store_dwordx4 v[36:39], v41, s[60:63], 0 offen sc1
    ds_read_b64_tr_b16 v[184:185], v9 offset:32768
    ds_read_b64_tr_b16 v[186:187], v9 offset:33024
    ds_read_b128 v[72:75], v18 offset:16384
    ds_read_b64_tr_b16 v[188:189], v9 offset:40960
    ds_read_b64_tr_b16 v[190:191], v9 offset:41216
    ds_read_b128 v[76:79], v19 offset:16384
    v_dot2_f32_bf16 v5, v176, s54, v5
    v_dot2_f32_bf16 v6, v177, s54, v6
    v_dot2_f32_bf16 v5, v178, s54, v5
    v_dot2_f32_bf16 v6, v179, s54, v6
    v_dot2_f32_bf16 v5, v180, s54, v5
    v_dot2_f32_bf16 v6, v181, s54, v6
    v_dot2_f32_bf16 v5, v182, s54, v5
    v_dot2_f32_bf16 v6, v183, s54, v6
    v_dot2_f32_bf16 v20, v28, s54, v20
    v_dot2_f32_bf16 v21, v28, v28, v21
    v_dot2_f32_bf16 v22, v29, s54, v22
    v_dot2_f32_bf16 v23, v29, v29, v23
    v_mfma_f32_32x32x16_bf16 v[80:95], v[176:179], v[64:67], v[80:95]
    v_mfma_f32_32x32x16_bf16 v[80:95], v[180:183], v[68:71], v[80:95]
    s_waitcnt vmcnt(13) lgkmcnt(0)
    s_barrier
    s_add_u32 m0, s48, 73728
    s_nop 0
    buffer_load_dwordx4 v10, s[20:23], s26 offen lds
    s_add_u32 s26, s26, s25
    s_add_u32 m0, s48, 81920
    s_nop 0
    buffer_load_dwordx4 v10, s[20:23], s26 offen lds
    s_add_u32 s26, s26, s25
    ds_read_b64_tr_b16 v[192:193], v9 offset:49152
    ds_read_b64_tr_b16 v[194:195], v9 offset:49408
    ds_read_b128 v[64:67], v16 offset:20480
    ds_read_b64_tr_b16 v[196:197], v9 offset:57344
    ds_read_b64_tr_b16 v[198:199], v9 offset:57600
    ds_read_b128 v[68:71], v17 offset:20480
    v_dot2_f32_bf16 v5, v184, s54, v5
    v_dot2_f32_bf16 v6, v185, s54, v6
    v_dot2_f32_bf16 v5, v186, s54, v5
    v_dot2_f32_bf16 v6, v187, s54, v6
    v_dot2_f32_bf16 v5, v188, s54, v5
    v_dot2_f32_bf16 v6, v189, s54, v6
    v_dot2_f32_bf16 v5, v190, s54, v5
    v_dot2_f32_bf16 v6, v191, s54, v6
    v_mfma_f32_32x32x16_bf16 v[80:95], v[184:187], v[72:75], v[80:95]
    v_mfma_f32_32x32x16_bf16 v[80:95], v[188:191], v[76:79], v[80:95]
    v_add_f32 v20, v20, v22
    v_add_f32 v21, v21, v23
    s_nop 0
    v_add_f32_dpp v20, v20, v20 row_ror:8 row_mask:0xf bank_mask:0xf
    v_add_f32_dpp v21, v21, v21 row_ror:8 row_mask:0xf bank_mask:0xf
    s_waitcnt vmcnt(13) lgkmcnt(0)
    s_barrier
    s_add_u32 m0, s48, 90112
    s_nop 0
    buffer_load_dwordx4 v10, s[20:23], s26 offen lds
    s_add_u32 s26, s26, s25
    s_add_u32 m0, s48, 98304
    s_nop 0
    buffer_load_dwordx4 v10, s[20:23], s26 offen lds
    s_add_u32 s26, s26, s25
    ds_read_b64_tr_b16 v[200:201], v8 offset:0
    ds_read_b64_tr_b16 v[202:203], v8 offset:256
    ds_read_b128 v[72:75], v18 offset:20480
    ds_read_b64_tr_b16 v[204:205], v8 offset:8192
    ds_read_b64_tr_b16 v[206:207], v8 offset:8448
    ds_read_b128 v[76:79], v19 offset:20480
    v_dot2_f32_bf16 v5, v192, s54, v5
    v_dot2_f32_bf16 v6, v193, s54, v6
    v_dot2_f32_bf16 v5, v194, s54, v5
    v_dot2_f32_bf16 v6, v195, s54, v6
    v_dot2_f32_bf16 v5, v196, s54, v5
    v_dot2_f32_bf16 v6, v197, s54, v6
    v_dot2_f32_bf16 v5, v198, s54, v5
    v_dot2_f32_bf16 v6, v199, s54, v6
    v_mfma_f32_32x32x16_bf16 v[80:95], v[192:195], v[64:67], v[80:95]
    v_mfma_f32_32x32x16_bf16 v[80:95], v[196:199], v[68:71], v[80:95]
    v_add_f32_dpp v20, v20, v20 row_ror:4 row_mask:0xf bank_mask:0xf
    v_add_f32_dpp v21, v21, v21 row_ror:4 row_mask:0xf bank_mask:0xf
    s_nop 0
    v_add_f32_dpp v20, v20, v20 row_ror:2 row_mask:0xf bank_mask:0xf
    v_add_f32_dpp v21, v21, v21 row_ror:2 row_mask:0xf bank_mask:0xf
    s_waitcnt vmcnt(12) lgkmcnt(0)
    s_barrier
    ds_read_b64_tr_b16 v[208:209], v8 offset:16384
    ds_read_b64_tr_b16 v[210:211], v8 offset:16640
    ds_read_b128 v[64:67], v16 offset:24576
    ds_read_b64_tr_b16 v[212:213], v8 offset:24576
    ds_read_b64_tr_b16 v[214:215], v8 offset:24832
    ds_read_b128 v[68:71], v17 offset:24576
    v_dot2_f32_bf16 v5, v200, s54, v5
    v_dot2_f32_bf16 v6, v201, s54, v6
    v_dot2_f32_bf16 v5, v202, s54, v5
    v_dot2_f32_bf16 v6, v203, s54, v6
    v_dot2_f32_bf16 v5, v204, s54, v5
    v_dot2_f32_bf16 v6, v205, s54, v6
    v_dot2_f32_bf16 v5, v206, s54, v5
    v_dot2_f32_bf16 v6, v207, s54, v6
    v_mfma_f32_32x32x16_bf16 v[80:95], v[200:203], v[72:75], v[80:95]
    v_mfma_f32_32x32x16_bf16 v[80:95], v[204:207], v[76:79], v[80:95]
    v_add_f32_dpp v20, v20, v20 row_ror:1 row_mask:0xf bank_mask:0xf
    v_add_f32_dpp v21, v21, v21 row_ror:1 row_mask:0xf bank_mask:0xf
    v_mul_f32 v20, 0x3ae38e39, v20
    v_mul_f32 v21, 0x3ae38e39, v21
    s_waitcnt vmcnt(10) lgkmcnt(0)
    s_barrier
    ds_read_b64_tr_b16 v[216:217], v8 offset:32768
    ds_read_b64_tr_b16 v[218:219], v8 offset:33024
    ds_read_b128 v[72:75], v18 offset:24576
    ds_read_b64_tr_b16 v[220:221], v8 offset:40960
    ds_read_b64_tr_b16 v[222:223], v8 offset:41216
    ds_read_b128 v[76:79], v19 offset:24576
    v_dot2_f32_bf16 v5, v208, s54, v5
    v_dot2_f32_bf16 v6, v209, s54, v6
    v_dot2_f32_bf16 v5, v210, s54, v5
    v_dot2_f32_bf16 v6, v211, s54, v6
    v_dot2_f32_bf16 v5, v212, s54, v5
    v_dot2_f32_bf16 v6, v213, s54, v6
    v_dot2_f32_bf16 v5, v214, s54, v5
    v_dot2_f32_bf16 v6, v215, s54, v6
    v_mfma_f32_32x32x16_bf16 v[80:95], v[208:211], v[64:67], v[80:95]
    v_mfma_f32_32x32x16_bf16 v[80:95], v[212:215], v[68:71], v[80:95]
    v_fma_f32 v21, -v20, v20, v21
    v_max_f32 v21, 0, v21
    v_add_f32 v21, 0x3727c5ac, v21
    v_rsq_f32 v26, v21
    s_waitcnt vmcnt(7) lgkmcnt(0)
    s_barrier
    s_add_u32 m0, s47, 106496
    s_nop 0
    buffer_load_dwordx4 v11, s[16:19], s49 offen offset:0 lds
    s_add_u32 m0, s47, 114432
    s_nop 0
    buffer_load_dwordx4 v11, s[16:19], s49 offen offset:256 lds
    s_add_u32 m0, s47, 122368
    s_nop 0
    buffer_load_dwordx4 v11, s[16:19], s49 offen offset:512 lds
    s_add_u32 m0, s47, 130304
    s_nop 0
    buffer_load_dwordx4 v11, s[16:19], s49 offen offset:768 lds
    s_add_u32 m0, s47, 138240
    s_nop 0
    buffer_load_dwordx4 v11, s[16:19], s49 offen offset:1024 lds
    s_add_u32 s49, s49, 36864
    ds_read_b64_tr_b16 v[224:225], v9 offset:0
    ds_read_b64_tr_b16 v[226:227], v9 offset:256
    ds_read_b128 v[64:67], v16 offset:28672
    ds_read_b64_tr_b16 v[228:229], v9 offset:8192
    ds_read_b64_tr_b16 v[230:231], v9 offset:8448
    ds_read_b128 v[68:71], v17 offset:28672
    v_dot2_f32_bf16 v5, v216, s54, v5
    v_dot2_f32_bf16 v6, v217, s54, v6
    v_dot2_f32_bf16 v5, v218, s54, v5
    v_dot2_f32_bf16 v6, v219, s54, v6
    v_dot2_f32_bf16 v5, v220, s54, v5
    v_dot2_f32_bf16 v6, v221, s54, v6
    v_dot2_f32_bf16 v5, v222, s54, v5
    v_dot2_f32_bf16 v6, v223, s54, v6
    v_mfma_f32_32x32x16_bf16 v[80:95], v[216:219], v[72:75], v[80:95]
    v_mfma_f32_32x32x16_bf16 v[80:95], v[220:223], v[76:79], v[80:95]
    v_mul_f32 v27, v21, v26
    v_cvt_pk_bf16_f32 v24, -v20, v27
    v_lshlrev_b32 v28, 16, v24
    v_and_b32 v29, 0xffff0000, v24
    s_waitcnt vmcnt(10) lgkmcnt(0)
    s_barrier
    ds_read_b64_tr_b16 v[232:233], v9 offset:16384
    ds_read_b64_tr_b16 v[234:235], v9 offset:16640
    ds_read_b128 v[72:75], v18 offset:28672
    ds_read_b64_tr_b16 v[236:237], v9 offset:24576
    ds_read_b64_tr_b16 v[238:239], v9 offset:24832
    ds_read_b128 v[76:79], v19 offset:28672
    v_dot2_f32_bf16 v5, v224, s54, v5
    v_dot2_f32_bf16 v6, v225, s54, v6
    v_dot2_f32_bf16 v5, v226, s54, v5
    v_dot2_f32_bf16 v6, v227, s54, v6
    v_dot2_f32_bf16 v5, v228, s54, v5
    v_dot2_f32_bf16 v6, v229, s54, v6
    v_dot2_f32_bf16 v5, v230, s54, v5
    v_dot2_f32_bf16 v6, v231, s54, v6
    v_mfma_f32_32x32x16_bf16 v[80:95], v[224:227], v[64:67], v[80:95]
    v_mfma_f32_32x32x16_bf16 v[80:95], v[228:231], v[68:71], v[80:95]
    v_sub_f32 v28, -v20, v28
    v_sub_f32 v29, v27, v29
    v_cvt_pk_bf16_f32 v25, v28, v29
    ds_write_b128 v14, v[24:27] offset:0
    s_waitcnt vmcnt(7) lgkmcnt(0)
    s_barrier
    ds_read_b64_tr_b16 v[240:241], v9 offset:32768
    ds_read_b64_tr_b16 v[242:243], v9 offset:33024
    ds_read_b128 v[64:67], v16 offset:32768
    ds_read_b64_tr_b16 v[244:245], v9 offset:40960
    ds_read_b64_tr_b16 v[246:247], v9 offset:41216
    ds_read_b128 v[68:71], v17 offset:32768
    v_dot2_f32_bf16 v5, v232, s54, v5
    v_dot2_f32_bf16 v6, v233, s54, v6
    v_dot2_f32_bf16 v5, v234, s54, v5
    v_dot2_f32_bf16 v6, v235, s54, v6
    v_dot2_f32_bf16 v5, v236, s54, v5
    v_dot2_f32_bf16 v6, v237, s54, v6
    v_dot2_f32_bf16 v5, v238, s54, v5
    v_dot2_f32_bf16 v6, v239, s54, v6
    v_mfma_f32_32x32x16_bf16 v[80:95], v[232:235], v[72:75], v[80:95]
    v_mfma_f32_32x32x16_bf16 v[80:95], v[236:239], v[76:79], v[80:95]
    s_waitcnt vmcnt(5) lgkmcnt(0)
    s_barrier
    ds_read_b64_tr_b16 v[248:249], v9 offset:49152
    ds_read_b64_tr_b16 v[250:251], v9 offset:49408
    ds_read_b128 v[72:75], v18 offset:32768
    ds_read_b64_tr_b16 v[252:253], v9 offset:57344
    ds_read_b64_tr_b16 v[254:255], v9 offset:57600
    ds_read_b128 v[76:79], v19 offset:32768
    v_dot2_f32_bf16 v5, v240, s54, v5
    v_dot2_f32_bf16 v6, v241, s54, v6
    v_dot2_f32_bf16 v5, v242, s54, v5
    v_dot2_f32_bf16 v6, v243, s54, v6
    v_dot2_f32_bf16 v5, v244, s54, v5
    v_dot2_f32_bf16 v6, v245, s54, v6
    v_dot2_f32_bf16 v5, v246, s54, v5
    v_dot2_f32_bf16 v6, v247, s54, v6
    v_mfma_f32_32x32x16_bf16 v[80:95], v[240:243], v[64:67], v[80:95]
    v_mfma_f32_32x32x16_bf16 v[80:95], v[244:247], v[68:71], v[80:95]
    s_waitcnt vmcnt(0) lgkmcnt(0)
    s_barrier
    s_cmp_le_u32 s44, 2
    s_cbranch_scc1 L_nox_11
    s_add_u32 m0, s47, 40960
    s_nop 0
    buffer_load_dwordx4 v11, s[16:19], s49 offen offset:0 lds
    s_add_u32 m0, s47, 48896
    s_nop 0
    buffer_load_dwordx4 v11, s[16:19], s49 offen offset:256 lds
    s_add_u32 m0, s47, 56832
    s_nop 0
    buffer_load_dwordx4 v11, s[16:19], s49 offen offset:512 lds
    s_add_u32 m0, s47, 64768
    s_nop 0
    buffer_load_dwordx4 v11, s[16:19], s49 offen offset:768 lds
    s_add_u32 m0, s47, 72704
    s_nop 0
    buffer_load_dwordx4 v11, s[16:19], s49 offen offset:1024 lds
    s_add_u32 s49, s49, 36864
L_nox_11:
    ds_read_b128 v[52:55], v13 offset:0
    v_add_u32 v16, 0x1a000, v16
    v_add_u32 v17, 0x1a000, v17
    v_add_u32 v18, 0x1a000, v18
    v_add_u32 v19, 0x1a000, v19
    v_add_u32 v15, 0x1a000, v15
    ds_read_b128 v[64:67], v16 offset:0
    ds_read_b128 v[68:71], v17 offset:0
    v_mfma_f32_32x32x16_bf16 v[80:95], v[248:251], v[72:75], v[80:95]
    v_dot2_f32_bf16 v5, v248, s54, v5
    v_dot2_f32_bf16 v6, v249, s54, v6
    v_dot2_f32_bf16 v5, v250, s54, v5
    v_dot2_f32_bf16 v6, v251, s54, v6
    ds_read_b128 v[72:75], v18 offset:0
    v_mfma_f32_32x32x16_bf16 v[80:95], v[252:255], v[76:79], v[80:95]
    v_dot2_f32_bf16 v5, v252, s54, v5
    v_dot2_f32_bf16 v6, v253, s54, v6
    v_dot2_f32_bf16 v5, v254, s54, v5
    v_dot2_f32_bf16 v6, v255, s54, v6
    s_nop 3
    v_add_f32 v5, v5, v6
    v_mov_b32 v6, v5
    s_nop 1
    v_permlane32_swap_b32 v5, v6
    s_nop 1
    v_add_f32 v5, v5, v6
    v_cvt_pk_bf16_f32 v6, v5, v5
    v_lshlrev_b32 v1, 16, v6
    v_sub_f32 v1, v5, v1
    v_cvt_pk_bf16_f32 v1, v1, v1
    v_and_b32 v1, 0xffff, v1
    v_and_b32 v6, 0xffff, v6

    v_lshl_or_b32 v6, v7, 16, v6
    v_cndmask_b32 v62, v6, v1, s[64:65]
    v_cndmask_b32 v63, v6, v1, s[64:65]

    ds_read_b128 v[76:79], v19 offset:0
    s_waitcnt lgkmcnt(3)
    v_mfma_f32_32x32x16_bf16 v[96:111], v[112:115], v[64:67], 0
    ds_read_b64 v[24:25], v15 offset:0
    ds_read_b64 v[26:27], v15 offset:4096
    ds_read_b64 v[28:29], v15 offset:8192
    ds_read_b128 v[64:67], v16 offset:4096
    s_waitcnt lgkmcnt(6)
    v_mfma_f32_32x32x16_bf16 v[96:111], v[116:119], v[68:71], v[96:111]
    v_mfma_f32_32x32x8bf16_1k v[80:95], v[62:63], v[52:53], v[80:95]
    ds_read_b64 v[30:31], v15 offset:12288
    ds_read_b64 v[32:33], v15 offset:16384
    ds_read_b64 v[34:35], v15 offset:20480
    ds_read_b128 v[68:71], v17 offset:4096
    s_waitcnt lgkmcnt(9)
    v_mfma_f32_32x32x16_bf16 v[96:111], v[120:123], v[72:75], v[96:111]
    ds_read_b64 v[2:3], v15 offset:24576
    ds_read_b64 v[4:5], v15 offset:28672
    ds_read_b64 v[6:7], v15 offset:32768
    ds_read_b128 v[72:75], v18 offset:4096
    s_waitcnt lgkmcnt(12)
    v_mfma_f32_32x32x16_bf16 v[96:111], v[124:127], v[76:79], v[96:111]
    v_mul_f32 v60, 0xc0135761, v54
    v_mul_f32 v61, v54, v54
    v_mul_f32 v61, 0x3d372713, v61
    v_mul_f32 v61, v61, v60
    v_mul_f32 v44, v80, v80
    v_mul_f32 v45, v81, v81
    s_waitcnt lgkmcnt(11)
    v_dot2_f32_bf16 v20, v24, s54, 0
    v_dot2_f32_bf16 v21, v24, v24, 0
    v_dot2_f32_bf16 v22, v25, s54, 0
    v_dot2_f32_bf16 v23, v25, v25, 0
    ds_read_b128 v[76:79], v19 offset:4096
    s_waitcnt lgkmcnt(9)
    v_mfma_f32_32x32x16_bf16 v[96:111], v[128:131], v[64:67], v[96:111]
    v_mul_f32 v46, v82, v82
    v_mul_f32 v47, v83, v83
    v_fma_f32 v44, v44, v61, v60
    v_fma_f32 v45, v45, v61, v60
    v_fma_f32 v46, v46, v61, v60
    v_fma_f32 v47, v47, v61, v60
    v_dot2_f32_bf16 v20, v26, s54, v20
    v_dot2_f32_bf16 v21, v26, v26, v21
    v_dot2_f32_bf16 v22, v27, s54, v22
    v_dot2_f32_bf16 v23, v27, v27, v23
    ds_read_b128 v[64:67], v16 offset:8192
    s_waitcnt lgkmcnt(6)
    v_mfma_f32_32x32x16_bf16 v[96:111], v[132:135], v[68:71], v[96:111]
    v_mul_f32 v44, v44, v80
    v_mul_f32 v45, v45, v81
    v_mul_f32 v46, v46, v82
    v_mul_f32 v47, v47, v83
    v_exp_f32 v44, v44
    v_dot2_f32_bf16 v20, v28, s54, v20
    v_dot2_f32_bf16 v21, v28, v28, v21
    v_dot2_f32_bf16 v22, v29, s54, v22
    v_dot2_f32_bf16 v23, v29, v29, v23
    ds_read_b128 v[68:71], v17 offset:8192
    s_waitcnt lgkmcnt(3)
    v_mfma_f32_32x32x16_bf16 v[96:111], v[136:139], v[72:75], v[96:111]
    v_exp_f32 v45, v45
    v_exp_f32 v46, v46
    v_exp_f32 v47, v47
    v_dot2_f32_bf16 v20, v30, s54, v20
    v_dot2_f32_bf16 v21, v30, v30, v21
    v_dot2_f32_bf16 v22, v31, s54, v22
    v_dot2_f32_bf16 v23, v31, v31, v23
    ds_read_b128 v[72:75], v18 offset:8192
    s_waitcnt lgkmcnt(3)
    v_mfma_f32_32x32x16_bf16 v[96:111], v[140:143], v[76:79], v[96:111]
    v_fma_f32 v44, v44, v55, v55
    v_fma_f32 v45, v45, v55, v55
    v_fma_f32 v46, v46, v55, v55
    v_fma_f32 v47, v47, v55, v55
    v_rcp_f32 v44, v44
    v_dot2_f32_bf16 v20, v32, s54, v20
    v_dot2_f32_bf16 v21, v32, v32, v21
    v_dot2_f32_bf16 v22, v33, s54, v22
    v_dot2_f32_bf16 v23, v33, v33, v23
    ds_read_b128 v[76:79], v19 offset:8192
    s_waitcnt lgkmcnt(3)
    v_mfma_f32_32x32x16_bf16 v[96:111], v[144:147], v[64:67], v[96:111]
    v_rcp_f32 v45, v45
    v_rcp_f32 v46, v46
    v_rcp_f32 v47, v47
    v_dot2_f32_bf16 v20, v34, s54, v20
    v_dot2_f32_bf16 v21, v34, v34, v21
    v_dot2_f32_bf16 v22, v35, s54, v22
    v_dot2_f32_bf16 v23, v35, v35, v23
    ds_read_b128 v[64:67], v16 offset:12288
    s_waitcnt lgkmcnt(3)
    v_mfma_f32_32x32x16_bf16 v[96:111], v[148:151], v[68:71], v[96:111]
    v_mul_f32 v44, v44, v80
    v_mul_f32 v45, v45, v81
    v_mul_f32 v46, v46, v82
    v_mul_f32 v47, v47, v83
    v_cvt_pk_bf16_f32 v36, v44, v45
    v_cvt_pk_bf16_f32 v37, v46, v47
    v_dot2_f32_bf16 v20, v2, s54, v20
    v_dot2_f32_bf16 v21, v2, v2, v21
    v_dot2_f32_bf16 v22, v3, s54, v22
    v_dot2_f32_bf16 v23, v3, v3, v23
    ds_read_b128 v[68:71], v17 offset:12288
    s_waitcnt lgkmcnt(3)
    v_mfma_f32_32x32x16_bf16 v[96:111], v[152:155], v[72:75], v[96:111]
    v_mul_f32 v48, v84, v84
    v_mul_f32 v49, v85, v85
    v_mul_f32 v50, v86, v86
    v_mul_f32 v51, v87, v87
    v_fma_f32 v48, v48, v61, v60
    v_fma_f32 v49, v49, v61, v60
    v_dot2_f32_bf16 v20, v4, s54, v20
    v_dot2_f32_bf16 v21, v4, v4, v21
    v_dot2_f32_bf16 v22, v5, s54, v22
    v_dot2_f32_bf16 v23, v5, v5, v23
    ds_read_b128 v[72:75], v18 offset:12288
    s_waitcnt lgkmcnt(3)
    v_mfma_f32_32x32x16_bf16 v[96:111], v[156:159], v[76:79], v[96:111]
    v_fma_f32 v50, v50, v61, v60
    v_fma_f32 v51, v51, v61, v60
    v_mul_f32 v48, v48, v84
    v_mul_f32 v49, v49, v85
    v_mul_f32 v50, v50, v86
    v_mul_f32 v51, v51, v87
    v_dot2_f32_bf16 v20, v6, s54, v20
    v_dot2_f32_bf16 v21, v6, v6, v21
    v_dot2_f32_bf16 v22, v7, s54, v22
    v_dot2_f32_bf16 v23, v7, v7, v23
    ds_read_b128 v[76:79], v19 offset:12288
    s_waitcnt lgkmcnt(3)
    v_mfma_f32_32x32x16_bf16 v[96:111], v[160:163], v[64:67], v[96:111]
    v_exp_f32 v48, v48
    v_add_f32 v20, v20, v22
    v_exp_f32 v49, v49
    v_exp_f32 v50, v50
    v_add_f32 v21, v21, v23
    ds_read_b128 v[64:67], v16 offset:16384
    s_waitcnt lgkmcnt(3)
    v_mfma_f32_32x32x16_bf16 v[96:111], v[164:167], v[68:71], v[96:111]
    v_add_f32_dpp v20, v20, v20 row_ror:8 row_mask:0xf bank_mask:0xf
    v_exp_f32 v51, v51
    v_fma_f32 v48, v48, v55, v55
    v_add_f32_dpp v21, v21, v21 row_ror:8 row_mask:0xf bank_mask:0xf
    ds_read_b128 v[68:71], v17 offset:16384
    s_waitcnt lgkmcnt(3)
    v_mfma_f32_32x32x16_bf16 v[96:111], v[168:171], v[72:75], v[96:111]
    v_add_f32_dpp v20, v20, v20 row_ror:4 row_mask:0xf bank_mask:0xf
    v_fma_f32 v49, v49, v55, v55
    v_fma_f32 v50, v50, v55, v55
    v_add_f32_dpp v21, v21, v21 row_ror:4 row_mask:0xf bank_mask:0xf
    v_fma_f32 v51, v51, v55, v55
    ds_read_b128 v[72:75], v18 offset:16384
    s_waitcnt lgkmcnt(3)
    v_mfma_f32_32x32x16_bf16 v[96:111], v[172:175], v[76:79], v[96:111]
    v_add_f32_dpp v20, v20, v20 row_ror:2 row_mask:0xf bank_mask:0xf
    v_rcp_f32 v48, v48
    v_rcp_f32 v49, v49
    v_add_f32_dpp v21, v21, v21 row_ror:2 row_mask:0xf bank_mask:0xf
    ds_read_b128 v[76:79], v19 offset:16384
    s_waitcnt lgkmcnt(3)
    v_mfma_f32_32x32x16_bf16 v[96:111], v[176:179], v[64:67], v[96:111]
    v_add_f32_dpp v20, v20, v20 row_ror:1 row_mask:0xf bank_mask:0xf
    v_rcp_f32 v50, v50
    v_rcp_f32 v51, v51
    v_add_f32_dpp v21, v21, v21 row_ror:1 row_mask:0xf bank_mask:0xf
    ds_read_b128 v[64:67], v16 offset:20480
    s_waitcnt lgkmcnt(3)
    v_mfma_f32_32x32x16_bf16 v[96:111], v[180:183], v[68:71], v[96:111]
    v_mul_f32 v20, 0x3ae38e39, v20
    v_mul_f32 v48, v48, v84
    v_mul_f32 v49, v49, v85
    v_mul_f32 v21, 0x3ae38e39, v21
    v_mul_f32 v50, v50, v86
    v_mul_f32 v51, v51, v87
    ds_read_b128 v[68:71], v17 offset:20480
    s_waitcnt lgkmcnt(3)
    v_mfma_f32_32x32x16_bf16 v[96:111], v[184:187], v[72:75], v[96:111]
    v_fma_f32 v21, -v20, v20, v21
    v_cvt_pk_bf16_f32 v38, v48, v49
    v_cvt_pk_bf16_f32 v39, v50, v51
    v_max_f32 v21, 0, v21
    buffer_store_dwordx4 v[36:39], v12, s[32:35], s50 offen offset:0 sc1
    ds_read_b128 v[72:75], v18 offset:20480
    s_waitcnt lgkmcnt(3)
    v_mfma_f32_32x32x16_bf16 v[96:111], v[188:191], v[76:79], v[96:111]
    v_add_f32 v21, 0x3727c5ac, v21
    v_mul_f32 v44, v88, v88
    v_mul_f32 v45, v89, v89
    v_rsq_f32 v26, v21
    v_mul_f32 v46, v90, v90
    ds_read_b128 v[76:79], v19 offset:20480
    s_waitcnt lgkmcnt(3)
    v_mfma_f32_32x32x16_bf16 v[96:111], v[192:195], v[64:67], v[96:111]
    v_mul_f32 v27, v21, v26
    v_mul_f32 v47, v91, v91
    v_fma_f32 v44, v44, v61, v60
    v_cvt_pk_bf16_f32 v24, -v20, v27
    v_fma_f32 v45, v45, v61, v60
    v_fma_f32 v46, v46, v61, v60
    ds_read_b128 v[64:67], v16 offset:24576
    s_waitcnt lgkmcnt(3)
    v_mfma_f32_32x32x16_bf16 v[96:111], v[196:199], v[68:71], v[96:111]
    v_lshlrev_b32 v28, 16, v24
    v_fma_f32 v47, v47, v61, v60
    v_mul_f32 v44, v44, v88
    v_and_b32 v29, 0xffff0000, v24
    v_mul_f32 v45, v45, v89
    v_mul_f32 v46, v46, v90
    ds_read_b128 v[68:71], v17 offset:24576
    s_waitcnt lgkmcnt(3)
    v_mfma_f32_32x32x16_bf16 v[96:111], v[200:203], v[72:75], v[96:111]
    v_sub_f32 v28, -v20, v28
    v_mul_f32 v47, v47, v91
    v_exp_f32 v44, v44
    v_sub_f32 v29, v27, v29
    v_exp_f32 v45, v45
    ds_read_b128 v[72:75], v18 offset:24576
    s_waitcnt lgkmcnt(3)
    v_mfma_f32_32x32x16_bf16 v[96:111], v[204:207], v[76:79], v[96:111]
    v_cvt_pk_bf16_f32 v25, v28, v29
    v_exp_f32 v46, v46
    v_exp_f32 v47, v47
    ds_write_b128 v14, v[24:27] offset:512
    ds_read_b128 v[76:79], v19 offset:24576
    s_waitcnt lgkmcnt(4)
    v_mfma_f32_32x32x16_bf16 v[96:111], v[208:211], v[64:67], v[96:111]
    v_fma_f32 v44, v44, v55, v55
    v_fma_f32 v45, v45, v55, v55
    v_fma_f32 v46, v46, v55, v55
    v_fma_f32 v47, v47, v55, v55
    v_rcp_f32 v44, v44
    ds_read_b128 v[64:67], v16 offset:28672
    s_waitcnt lgkmcnt(4)
    v_mfma_f32_32x32x16_bf16 v[96:111], v[212:215], v[68:71], v[96:111]
    v_rcp_f32 v45, v45
    v_rcp_f32 v46, v46
    v_rcp_f32 v47, v47
    ds_read_b128 v[68:71], v17 offset:28672
    s_waitcnt lgkmcnt(4)
    v_mfma_f32_32x32x16_bf16 v[96:111], v[216:219], v[72:75], v[96:111]
    v_mul_f32 v44, v44, v88
    v_mul_f32 v45, v45, v89
    v_mul_f32 v46, v46, v90
    v_mul_f32 v47, v47, v91
    v_cvt_pk_bf16_f32 v40, v44, v45
    ds_read_b128 v[72:75], v18 offset:28672
    s_waitcnt lgkmcnt(3)
    v_mfma_f32_32x32x16_bf16 v[96:111], v[220:223], v[76:79], v[96:111]
    v_cvt_pk_bf16_f32 v41, v46, v47
    v_mul_f32 v48, v92, v92
    v_mul_f32 v49, v93, v93
    v_mul_f32 v50, v94, v94
    v_mul_f32 v51, v95, v95
    v_fma_f32 v48, v48, v61, v60
    ds_read_b128 v[76:79], v19 offset:28672
    s_waitcnt lgkmcnt(3)
    v_mfma_f32_32x32x16_bf16 v[96:111], v[224:227], v[64:67], v[96:111]
    v_fma_f32 v49, v49, v61, v60
    v_fma_f32 v50, v50, v61, v60
    v_fma_f32 v51, v51, v61, v60
    v_mul_f32 v48, v48, v92
    v_mul_f32 v49, v49, v93
    v_mul_f32 v50, v50, v94
    ds_read_b128 v[64:67], v16 offset:32768
    s_waitcnt lgkmcnt(3)
    v_mfma_f32_32x32x16_bf16 v[96:111], v[228:231], v[68:71], v[96:111]
    v_mul_f32 v51, v51, v95
    v_exp_f32 v48, v48
    v_exp_f32 v49, v49
    v_exp_f32 v50, v50
    ds_read_b128 v[68:71], v17 offset:32768
    s_waitcnt lgkmcnt(3)
    v_mfma_f32_32x32x16_bf16 v[96:111], v[232:235], v[72:75], v[96:111]
    v_exp_f32 v51, v51
    v_fma_f32 v48, v48, v55, v55
    v_fma_f32 v49, v49, v55, v55
    v_fma_f32 v50, v50, v55, v55
    s_waitcnt vmcnt(1)
    s_barrier
    ds_read_b128 v[56:59], v13 offset:512
    ds_read_b128 v[72:75], v18 offset:32768
    s_waitcnt lgkmcnt(4)
    v_mfma_f32_32x32x16_bf16 v[96:111], v[236:239], v[76:79], v[96:111]
    s_add_u32 m0, s47, 0
    s_nop 0
    buffer_load_dwordx4 v11, s[16:19], s49 offen offset:0 lds
    v_fma_f32 v51, v51, v55, v55
    v_rcp_f32 v48, v48
    v_rcp_f32 v49, v49
    v_rcp_f32 v50, v50
    ds_read_b128 v[76:79], v19 offset:32768
    s_waitcnt lgkmcnt(4)
    v_mfma_f32_32x32x16_bf16 v[96:111], v[240:243], v[64:67], v[96:111]
    s_add_u32 m0, s47, 7936
    s_nop 0
    buffer_load_dwordx4 v11, s[16:19], s49 offen offset:256 lds
    v_rcp_f32 v51, v51
    v_mul_f32 v48, v48, v92
    v_mul_f32 v49, v49, v93
    v_mul_f32 v50, v50, v94
    v_add_u32 v16, 0xffff0000, v16
    v_add_u32 v17, 0xffff0000, v17
    v_add_u32 v18, 0xffff0000, v18
    v_add_u32 v19, 0xffff0000, v19
    v_add_u32 v15, 0xffff0000, v15
    ds_read_b128 v[64:67], v16 offset:0
    s_waitcnt lgkmcnt(4)
    v_mfma_f32_32x32x16_bf16 v[96:111], v[244:247], v[68:71], v[96:111]
    s_add_u32 m0, s47, 15872
    s_nop 0
    buffer_load_dwordx4 v11, s[16:19], s49 offen offset:512 lds
    v_mul_f32 v51, v51, v95
    v_cvt_pk_bf16_f32 v42, v48, v49
    v_cvt_pk_bf16_f32 v43, v50, v51
    buffer_store_dwordx4 v[40:43], v12, s[32:35], s51 offen offset:0 sc1
    ds_read_b128 v[68:71], v17 offset:0
    s_waitcnt lgkmcnt(3)
    v_mfma_f32_32x32x16_bf16 v[96:111], v[248:251], v[72:75], v[96:111]
    s_add_u32 m0, s47, 23808
    s_nop 0
    buffer_load_dwordx4 v11, s[16:19], s49 offen offset:768 lds
    ds_read_b128 v[72:75], v18 offset:0
    s_waitcnt lgkmcnt(3)
    v_mfma_f32_32x32x16_bf16 v[96:111], v[252:255], v[76:79], v[96:111]
    s_add_u32 m0, s47, 31744
    s_nop 0
    buffer_load_dwordx4 v11, s[16:19], s49 offen offset:1024 lds
    s_add_u32 s49, s49, 36864
    ds_read_b128 v[76:79], v19 offset:0
    s_waitcnt lgkmcnt(3)
    v_mfma_f32_32x32x16_bf16 v[80:95], v[112:115], v[64:67], 0
    ds_read_b64 v[24:25], v15 offset:0
    ds_read_b64 v[26:27], v15 offset:4096
    ds_read_b64 v[28:29], v15 offset:8192
    ds_read_b128 v[64:67], v16 offset:4096
    s_waitcnt lgkmcnt(6)
    v_mfma_f32_32x32x16_bf16 v[80:95], v[116:119], v[68:71], v[80:95]
    v_mfma_f32_32x32x8bf16_1k v[96:111], v[62:63], v[56:57], v[96:111]
    ds_read_b64 v[30:31], v15 offset:12288
    ds_read_b64 v[32:33], v15 offset:16384
    ds_read_b64 v[34:35], v15 offset:20480
    ds_read_b128 v[68:71], v17 offset:4096
    s_waitcnt lgkmcnt(9)
    v_mfma_f32_32x32x16_bf16 v[80:95], v[120:123], v[72:75], v[80:95]
    ds_read_b64 v[2:3], v15 offset:24576
    ds_read_b64 v[4:5], v15 offset:28672
    ds_read_b64 v[6:7], v15 offset:32768
    ds_read_b128 v[72:75], v18 offset:4096
    s_waitcnt lgkmcnt(12)
    v_mfma_f32_32x32x16_bf16 v[80:95], v[124:127], v[76:79], v[80:95]
    v_mul_f32 v60, 0xc0135761, v58
    v_mul_f32 v61, v58, v58
    v_mul_f32 v61, 0x3d372713, v61
    v_mul_f32 v61, v61, v60
    v_mul_f32 v44, v96, v96
    v_mul_f32 v45, v97, v97
    s_waitcnt lgkmcnt(11)
    v_dot2_f32_bf16 v20, v24, s54, 0
    v_dot2_f32_bf16 v21, v24, v24, 0
    v_dot2_f32_bf16 v22, v25, s54, 0
    v_dot2_f32_bf16 v23, v25, v25, 0
    ds_read_b128 v[76:79], v19 offset:4096
    s_waitcnt lgkmcnt(9)
    v_mfma_f32_32x32x16_bf16 v[80:95], v[128:131], v[64:67], v[80:95]
    v_mul_f32 v46, v98, v98
    v_mul_f32 v47, v99, v99
    v_fma_f32 v44, v44, v61, v60
    v_fma_f32 v45, v45, v61, v60
    v_fma_f32 v46, v46, v61, v60
    v_fma_f32 v47, v47, v61, v60
    v_dot2_f32_bf16 v20, v26, s54, v20
    v_dot2_f32_bf16 v21, v26, v26, v21
    v_dot2_f32_bf16 v22, v27, s54, v22
    v_dot2_f32_bf16 v23, v27, v27, v23
    ds_read_b128 v[64:67], v16 offset:8192
    s_waitcnt lgkmcnt(6)
    v_mfma_f32_32x32x16_bf16 v[80:95], v[132:135], v[68:71], v[80:95]
    v_mul_f32 v44, v44, v96
    v_mul_f32 v45, v45, v97
    v_mul_f32 v46, v46, v98
    v_mul_f32 v47, v47, v99
    v_exp_f32 v44, v44
    v_dot2_f32_bf16 v20, v28, s54, v20
    v_dot2_f32_bf16 v21, v28, v28, v21
    v_dot2_f32_bf16 v22, v29, s54, v22
    v_dot2_f32_bf16 v23, v29, v29, v23
    ds_read_b128 v[68:71], v17 offset:8192
    s_waitcnt lgkmcnt(3)
    v_mfma_f32_32x32x16_bf16 v[80:95], v[136:139], v[72:75], v[80:95]
    v_exp_f32 v45, v45
    v_exp_f32 v46, v46
    v_exp_f32 v47, v47
    v_dot2_f32_bf16 v20, v30, s54, v20
    v_dot2_f32_bf16 v21, v30, v30, v21
    v_dot2_f32_bf16 v22, v31, s54, v22
    v_dot2_f32_bf16 v23, v31, v31, v23
    ds_read_b128 v[72:75], v18 offset:8192
    s_waitcnt lgkmcnt(3)
    v_mfma_f32_32x32x16_bf16 v[80:95], v[140:143], v[76:79], v[80:95]
    v_fma_f32 v44, v44, v59, v59
    v_fma_f32 v45, v45, v59, v59
    v_fma_f32 v46, v46, v59, v59
    v_fma_f32 v47, v47, v59, v59
    v_rcp_f32 v44, v44
    v_dot2_f32_bf16 v20, v32, s54, v20
    v_dot2_f32_bf16 v21, v32, v32, v21
    v_dot2_f32_bf16 v22, v33, s54, v22
    v_dot2_f32_bf16 v23, v33, v33, v23
    ds_read_b128 v[76:79], v19 offset:8192
    s_waitcnt lgkmcnt(3)
    v_mfma_f32_32x32x16_bf16 v[80:95], v[144:147], v[64:67], v[80:95]
    v_rcp_f32 v45, v45
    v_rcp_f32 v46, v46
    v_rcp_f32 v47, v47
    v_dot2_f32_bf16 v20, v34, s54, v20
    v_dot2_f32_bf16 v21, v34, v34, v21
    v_dot2_f32_bf16 v22, v35, s54, v22
    v_dot2_f32_bf16 v23, v35, v35, v23
    ds_read_b128 v[64:67], v16 offset:12288
    s_waitcnt lgkmcnt(3)
    v_mfma_f32_32x32x16_bf16 v[80:95], v[148:151], v[68:71], v[80:95]
    v_mul_f32 v44, v44, v96
    v_mul_f32 v45, v45, v97
    v_mul_f32 v46, v46, v98
    v_mul_f32 v47, v47, v99
    v_cvt_pk_bf16_f32 v36, v44, v45
    v_cvt_pk_bf16_f32 v37, v46, v47
    v_dot2_f32_bf16 v20, v2, s54, v20
    v_dot2_f32_bf16 v21, v2, v2, v21
    v_dot2_f32_bf16 v22, v3, s54, v22
    v_dot2_f32_bf16 v23, v3, v3, v23
    ds_read_b128 v[68:71], v17 offset:12288
    s_waitcnt lgkmcnt(3)
    v_mfma_f32_32x32x16_bf16 v[80:95], v[152:155], v[72:75], v[80:95]
    v_mul_f32 v48, v100, v100
    v_mul_f32 v49, v101, v101
    v_mul_f32 v50, v102, v102
    v_mul_f32 v51, v103, v103
    v_fma_f32 v48, v48, v61, v60
    v_fma_f32 v49, v49, v61, v60
    v_dot2_f32_bf16 v20, v4, s54, v20
    v_dot2_f32_bf16 v21, v4, v4, v21
    v_dot2_f32_bf16 v22, v5, s54, v22
    v_dot2_f32_bf16 v23, v5, v5, v23
    ds_read_b128 v[72:75], v18 offset:12288
    s_waitcnt lgkmcnt(3)
    v_mfma_f32_32x32x16_bf16 v[80:95], v[156:159], v[76:79], v[80:95]
    v_fma_f32 v50, v50, v61, v60
    v_fma_f32 v51, v51, v61, v60
    v_mul_f32 v48, v48, v100
    v_mul_f32 v49, v49, v101
    v_mul_f32 v50, v50, v102
    v_mul_f32 v51, v51, v103
    v_dot2_f32_bf16 v20, v6, s54, v20
    v_dot2_f32_bf16 v21, v6, v6, v21
    v_dot2_f32_bf16 v22, v7, s54, v22
    v_dot2_f32_bf16 v23, v7, v7, v23
    ds_read_b128 v[76:79], v19 offset:12288
    s_waitcnt lgkmcnt(3)
    v_mfma_f32_32x32x16_bf16 v[80:95], v[160:163], v[64:67], v[80:95]
    v_exp_f32 v48, v48
    v_add_f32 v20, v20, v22
    v_exp_f32 v49, v49
    v_exp_f32 v50, v50
    v_add_f32 v21, v21, v23
    ds_read_b128 v[64:67], v16 offset:16384
    s_waitcnt lgkmcnt(3)
    v_mfma_f32_32x32x16_bf16 v[80:95], v[164:167], v[68:71], v[80:95]
    v_add_f32_dpp v20, v20, v20 row_ror:8 row_mask:0xf bank_mask:0xf
    v_exp_f32 v51, v51
    v_fma_f32 v48, v48, v59, v59
    v_add_f32_dpp v21, v21, v21 row_ror:8 row_mask:0xf bank_mask:0xf
    ds_read_b128 v[68:71], v17 offset:16384
    s_waitcnt lgkmcnt(3)
    v_mfma_f32_32x32x16_bf16 v[80:95], v[168:171], v[72:75], v[80:95]
    v_add_f32_dpp v20, v20, v20 row_ror:4 row_mask:0xf bank_mask:0xf
    v_fma_f32 v49, v49, v59, v59
    v_fma_f32 v50, v50, v59, v59
    v_add_f32_dpp v21, v21, v21 row_ror:4 row_mask:0xf bank_mask:0xf
    v_fma_f32 v51, v51, v59, v59
    ds_read_b128 v[72:75], v18 offset:16384
    s_waitcnt lgkmcnt(3)
    v_mfma_f32_32x32x16_bf16 v[80:95], v[172:175], v[76:79], v[80:95]
    v_add_f32_dpp v20, v20, v20 row_ror:2 row_mask:0xf bank_mask:0xf
    v_rcp_f32 v48, v48
    v_rcp_f32 v49, v49
    v_add_f32_dpp v21, v21, v21 row_ror:2 row_mask:0xf bank_mask:0xf
    ds_read_b128 v[76:79], v19 offset:16384
    s_waitcnt lgkmcnt(3)
    v_mfma_f32_32x32x16_bf16 v[80:95], v[176:179], v[64:67], v[80:95]
    v_add_f32_dpp v20, v20, v20 row_ror:1 row_mask:0xf bank_mask:0xf
    v_rcp_f32 v50, v50
    v_rcp_f32 v51, v51
    v_add_f32_dpp v21, v21, v21 row_ror:1 row_mask:0xf bank_mask:0xf
    ds_read_b128 v[64:67], v16 offset:20480
    s_waitcnt lgkmcnt(3)
    v_mfma_f32_32x32x16_bf16 v[80:95], v[180:183], v[68:71], v[80:95]
    v_mul_f32 v20, 0x3ae38e39, v20
    v_mul_f32 v48, v48, v100
    v_mul_f32 v49, v49, v101
    v_mul_f32 v21, 0x3ae38e39, v21
    v_mul_f32 v50, v50, v102
    v_mul_f32 v51, v51, v103
    ds_read_b128 v[68:71], v17 offset:20480
    s_waitcnt lgkmcnt(3)
    v_mfma_f32_32x32x16_bf16 v[80:95], v[184:187], v[72:75], v[80:95]
    v_fma_f32 v21, -v20, v20, v21
    v_cvt_pk_bf16_f32 v38, v48, v49
    v_cvt_pk_bf16_f32 v39, v50, v51
    v_max_f32 v21, 0, v21
    buffer_store_dwordx4 v[36:39], v12, s[32:35], s50 offen offset:512 sc1
    ds_read_b128 v[72:75], v18 offset:20480
    s_waitcnt lgkmcnt(3)
    v_mfma_f32_32x32x16_bf16 v[80:95], v[188:191], v[76:79], v[80:95]
    v_add_f32 v21, 0x3727c5ac, v21
    v_mul_f32 v44, v104, v104
    v_mul_f32 v45, v105, v105
    v_rsq_f32 v26, v21
    v_mul_f32 v46, v106, v106
    ds_read_b128 v[76:79], v19 offset:20480
    s_waitcnt lgkmcnt(3)
    v_mfma_f32_32x32x16_bf16 v[80:95], v[192:195], v[64:67], v[80:95]
    v_mul_f32 v27, v21, v26
    v_mul_f32 v47, v107, v107
    v_fma_f32 v44, v44, v61, v60
    v_cvt_pk_bf16_f32 v24, -v20, v27
    v_fma_f32 v45, v45, v61, v60
    v_fma_f32 v46, v46, v61, v60
    ds_read_b128 v[64:67], v16 offset:24576
    s_waitcnt lgkmcnt(3)
    v_mfma_f32_32x32x16_bf16 v[80:95], v[196:199], v[68:71], v[80:95]
    v_lshlrev_b32 v28, 16, v24
    v_fma_f32 v47, v47, v61, v60
    v_mul_f32 v44, v44, v104
    v_and_b32 v29, 0xffff0000, v24
    v_mul_f32 v45, v45, v105
    v_mul_f32 v46, v46, v106
    ds_read_b128 v[68:71], v17 offset:24576
    s_waitcnt lgkmcnt(3)
    v_mfma_f32_32x32x16_bf16 v[80:95], v[200:203], v[72:75], v[80:95]
    v_sub_f32 v28, -v20, v28
    v_mul_f32 v47, v47, v107
    v_exp_f32 v44, v44
    v_sub_f32 v29, v27, v29
    v_exp_f32 v45, v45
    ds_read_b128 v[72:75], v18 offset:24576
    s_waitcnt lgkmcnt(3)
    v_mfma_f32_32x32x16_bf16 v[80:95], v[204:207], v[76:79], v[80:95]
    v_cvt_pk_bf16_f32 v25, v28, v29
    v_exp_f32 v46, v46
    v_exp_f32 v47, v47
    ds_write_b128 v14, v[24:27] offset:0
    ds_read_b128 v[76:79], v19 offset:24576
    s_waitcnt lgkmcnt(4)
    v_mfma_f32_32x32x16_bf16 v[80:95], v[208:211], v[64:67], v[80:95]
    v_fma_f32 v44, v44, v59, v59
    v_fma_f32 v45, v45, v59, v59
    v_fma_f32 v46, v46, v59, v59
    v_fma_f32 v47, v47, v59, v59
    v_rcp_f32 v44, v44
    ds_read_b128 v[64:67], v16 offset:28672
    s_waitcnt lgkmcnt(4)
    v_mfma_f32_32x32x16_bf16 v[80:95], v[212:215], v[68:71], v[80:95]
    v_rcp_f32 v45, v45
    v_rcp_f32 v46, v46
    v_rcp_f32 v47, v47
    ds_read_b128 v[68:71], v17 offset:28672
    s_waitcnt lgkmcnt(4)
    v_mfma_f32_32x32x16_bf16 v[80:95], v[216:219], v[72:75], v[80:95]
    v_mul_f32 v44, v44, v104
    v_mul_f32 v45, v45, v105
    v_mul_f32 v46, v46, v106
    v_mul_f32 v47, v47, v107
    v_cvt_pk_bf16_f32 v40, v44, v45
    ds_read_b128 v[72:75], v18 offset:28672
    s_waitcnt lgkmcnt(3)
    v_mfma_f32_32x32x16_bf16 v[80:95], v[220:223], v[76:79], v[80:95]
    v_cvt_pk_bf16_f32 v41, v46, v47
    v_mul_f32 v48, v108, v108
    v_mul_f32 v49, v109, v109
    v_mul_f32 v50, v110, v110
    v_mul_f32 v51, v111, v111
    v_fma_f32 v48, v48, v61, v60
    ds_read_b128 v[76:79], v19 offset:28672
    s_waitcnt lgkmcnt(3)
    v_mfma_f32_32x32x16_bf16 v[80:95], v[224:227], v[64:67], v[80:95]
    v_fma_f32 v49, v49, v61, v60
    v_fma_f32 v50, v50, v61, v60
    v_fma_f32 v51, v51, v61, v60
    v_mul_f32 v48, v48, v108
    v_mul_f32 v49, v49, v109
    v_mul_f32 v50, v50, v110
    ds_read_b128 v[64:67], v16 offset:32768
    s_waitcnt lgkmcnt(3)
    v_mfma_f32_32x32x16_bf16 v[80:95], v[228:231], v[68:71], v[80:95]
    v_mul_f32 v51, v51, v111
    v_exp_f32 v48, v48
    v_exp_f32 v49, v49
    v_exp_f32 v50, v50
    ds_read_b128 v[68:71], v17 offset:32768
    s_waitcnt lgkmcnt(3)
    v_mfma_f32_32x32x16_bf16 v[80:95], v[232:235], v[72:75], v[80:95]
    v_exp_f32 v51, v51
    v_fma_f32 v48, v48, v59, v59
    v_fma_f32 v49, v49, v59, v59
    v_fma_f32 v50, v50, v59, v59
    s_waitcnt vmcnt(1)
    s_barrier
    ds_read_b128 v[52:55], v13 offset:0
    ds_read_b128 v[72:75], v18 offset:32768
    s_waitcnt lgkmcnt(4)
    v_mfma_f32_32x32x16_bf16 v[80:95], v[236:239], v[76:79], v[80:95]
    s_add_u32 m0, s47, 106496
    s_nop 0
    buffer_load_dwordx4 v11, s[16:19], s49 offen offset:0 lds
    v_fma_f32 v51, v51, v59, v59
    v_rcp_f32 v48, v48
    v_rcp_f32 v49, v49
    v_rcp_f32 v50, v50
    ds_read_b128 v[76:79], v19 offset:32768
    s_waitcnt lgkmcnt(4)
    v_mfma_f32_32x32x16_bf16 v[80:95], v[240:243], v[64:67], v[80:95]
    s_add_u32 m0, s47, 114432
    s_nop 0
    buffer_load_dwordx4 v11, s[16:19], s49 offen offset:256 lds
    v_rcp_f32 v51, v51
    v_mul_f32 v48, v48, v108
    v_mul_f32 v49, v49, v109
    v_mul_f32 v50, v50, v110
    v_add_u32 v16, 0xffff6000, v16
    v_add_u32 v17, 0xffff6000, v17
    v_add_u32 v18, 0xffff6000, v18
    v_add_u32 v19, 0xffff6000, v19
    v_add_u32 v15, 0xffff6000, v15
    ds_read_b128 v[64:67], v16 offset:0
    s_waitcnt lgkmcnt(4)
    v_mfma_f32_32x32x16_bf16 v[80:95], v[244:247], v[68:71], v[80:95]
    s_add_u32 m0, s47, 122368
    s_nop 0
    buffer_load_dwordx4 v11, s[16:19], s49 offen offset:512 lds
    v_mul_f32 v51, v51, v111
    v_cvt_pk_bf16_f32 v42, v48, v49
    v_cvt_pk_bf16_f32 v43, v50, v51
    buffer_store_dwordx4 v[40:43], v12, s[32:35], s51 offen offset:512 sc1
    ds_read_b128 v[68:71], v17 offset:0
    s_waitcnt lgkmcnt(3)
    v_mfma_f32_32x32x16_bf16 v[80:95], v[248:251], v[72:75], v[80:95]
    s_add_u32 m0, s47, 130304
    s_nop 0
    buffer_load_dwordx4 v11, s[16:19], s49 offen offset:768 lds
    ds_read_b128 v[72:75], v18 offset:0
    s_waitcnt lgkmcnt(3)
    v_mfma_f32_32x32x16_bf16 v[80:95], v[252:255], v[76:79], v[80:95]
    s_add_u32 m0, s47, 138240
    s_nop 0
    buffer_load_dwordx4 v11, s[16:19], s49 offen offset:1024 lds
    s_add_u32 s49, s49, 36864
    ds_read_b128 v[76:79], v19 offset:0
    s_waitcnt lgkmcnt(3)
    v_mfma_f32_32x32x16_bf16 v[96:111], v[112:115], v[64:67], 0
    ds_read_b64 v[24:25], v15 offset:0
    ds_read_b64 v[26:27], v15 offset:4096
    ds_read_b64 v[28:29], v15 offset:8192
    ds_read_b128 v[64:67], v16 offset:4096
    s_waitcnt lgkmcnt(6)
    v_mfma_f32_32x32x16_bf16 v[96:111], v[116:119], v[68:71], v[96:111]
    v_mfma_f32_32x32x8bf16_1k v[80:95], v[62:63], v[52:53], v[80:95]
    ds_read_b64 v[30:31], v15 offset:12288
    ds_read_b64 v[32:33], v15 offset:16384
    ds_read_b64 v[34:35], v15 offset:20480
    ds_read_b128 v[68:71], v17 offset:4096
    s_waitcnt lgkmcnt(9)
    v_mfma_f32_32x32x16_bf16 v[96:111], v[120:123], v[72:75], v[96:111]
    ds_read_b64 v[2:3], v15 offset:24576
    ds_read_b64 v[4:5], v15 offset:28672
    ds_read_b64 v[6:7], v15 offset:32768
    ds_read_b128 v[72:75], v18 offset:4096
    s_waitcnt lgkmcnt(12)
    v_mfma_f32_32x32x16_bf16 v[96:111], v[124:127], v[76:79], v[96:111]
    v_mul_f32 v60, 0xc0135761, v54
    v_mul_f32 v61, v54, v54
    v_mul_f32 v61, 0x3d372713, v61
    v_mul_f32 v61, v61, v60
    v_mul_f32 v44, v80, v80
    v_mul_f32 v45, v81, v81
    s_waitcnt lgkmcnt(11)
    v_dot2_f32_bf16 v20, v24, s54, 0
    v_dot2_f32_bf16 v21, v24, v24, 0
    v_dot2_f32_bf16 v22, v25, s54, 0
    v_dot2_f32_bf16 v23, v25, v25, 0
    ds_read_b128 v[76:79], v19 offset:4096
    s_waitcnt lgkmcnt(9)
    v_mfma_f32_32x32x16_bf16 v[96:111], v[128:131], v[64:67], v[96:111]
    v_mul_f32 v46, v82, v82
    v_mul_f32 v47, v83, v83
    v_fma_f32 v44, v44, v61, v60
    v_fma_f32 v45, v45, v61, v60
    v_fma_f32 v46, v46, v61, v60
    v_fma_f32 v47, v47, v61, v60
    v_dot2_f32_bf16 v20, v26, s54, v20
    v_dot2_f32_bf16 v21, v26, v26, v21
    v_dot2_f32_bf16 v22, v27, s54, v22
    v_dot2_f32_bf16 v23, v27, v27, v23
    ds_read_b128 v[64:67], v16 offset:8192
    s_waitcnt lgkmcnt(6)
    v_mfma_f32_32x32x16_bf16 v[96:111], v[132:135], v[68:71], v[96:111]
    v_mul_f32 v44, v44, v80
    v_mul_f32 v45, v45, v81
    v_mul_f32 v46, v46, v82
    v_mul_f32 v47, v47, v83
    v_exp_f32 v44, v44
    v_dot2_f32_bf16 v20, v28, s54, v20
    v_dot2_f32_bf16 v21, v28, v28, v21
    v_dot2_f32_bf16 v22, v29, s54, v22
    v_dot2_f32_bf16 v23, v29, v29, v23
    ds_read_b128 v[68:71], v17 offset:8192
    s_waitcnt lgkmcnt(3)
    v_mfma_f32_32x32x16_bf16 v[96:111], v[136:139], v[72:75], v[96:111]
    v_exp_f32 v45, v45
    v_exp_f32 v46, v46
    v_exp_f32 v47, v47
    v_dot2_f32_bf16 v20, v30, s54, v20
    v_dot2_f32_bf16 v21, v30, v30, v21
    v_dot2_f32_bf16 v22, v31, s54, v22
    v_dot2_f32_bf16 v23, v31, v31, v23
    ds_read_b128 v[72:75], v18 offset:8192
    s_waitcnt lgkmcnt(3)
    v_mfma_f32_32x32x16_bf16 v[96:111], v[140:143], v[76:79], v[96:111]
    v_fma_f32 v44, v44, v55, v55
    v_fma_f32 v45, v45, v55, v55
    v_fma_f32 v46, v46, v55, v55
    v_fma_f32 v47, v47, v55, v55
    v_rcp_f32 v44, v44
    v_dot2_f32_bf16 v20, v32, s54, v20
    v_dot2_f32_bf16 v21, v32, v32, v21
    v_dot2_f32_bf16 v22, v33, s54, v22
    v_dot2_f32_bf16 v23, v33, v33, v23
    ds_read_b128 v[76:79], v19 offset:8192
    s_waitcnt lgkmcnt(3)
    v_mfma_f32_32x32x16_bf16 v[96:111], v[144:147], v[64:67], v[96:111]
    v_rcp_f32 v45, v45
    v_rcp_f32 v46, v46
    v_rcp_f32 v47, v47
    v_dot2_f32_bf16 v20, v34, s54, v20
    v_dot2_f32_bf16 v21, v34, v34, v21
    v_dot2_f32_bf16 v22, v35, s54, v22
    v_dot2_f32_bf16 v23, v35, v35, v23
    ds_read_b128 v[64:67], v16 offset:12288
    s_waitcnt lgkmcnt(3)
    v_mfma_f32_32x32x16_bf16 v[96:111], v[148:151], v[68:71], v[96:111]
    v_mul_f32 v44, v44, v80
    v_mul_f32 v45, v45, v81
    v_mul_f32 v46, v46, v82
    v_mul_f32 v47, v47, v83
    v_cvt_pk_bf16_f32 v36, v44, v45
    v_cvt_pk_bf16_f32 v37, v46, v47
    v_dot2_f32_bf16 v20, v2, s54, v20
    v_dot2_f32_bf16 v21, v2, v2, v21
    v_dot2_f32_bf16 v22, v3, s54, v22
    v_dot2_f32_bf16 v23, v3, v3, v23
    ds_read_b128 v[68:71], v17 offset:12288
    s_waitcnt lgkmcnt(3)
    v_mfma_f32_32x32x16_bf16 v[96:111], v[152:155], v[72:75], v[96:111]
    v_mul_f32 v48, v84, v84
    v_mul_f32 v49, v85, v85
    v_mul_f32 v50, v86, v86
    v_mul_f32 v51, v87, v87
    v_fma_f32 v48, v48, v61, v60
    v_fma_f32 v49, v49, v61, v60
    v_dot2_f32_bf16 v20, v4, s54, v20
    v_dot2_f32_bf16 v21, v4, v4, v21
    v_dot2_f32_bf16 v22, v5, s54, v22
    v_dot2_f32_bf16 v23, v5, v5, v23
    ds_read_b128 v[72:75], v18 offset:12288
    s_waitcnt lgkmcnt(3)
    v_mfma_f32_32x32x16_bf16 v[96:111], v[156:159], v[76:79], v[96:111]
    v_fma_f32 v50, v50, v61, v60
    v_fma_f32 v51, v51, v61, v60
    v_mul_f32 v48, v48, v84
    v_mul_f32 v49, v49, v85
    v_mul_f32 v50, v50, v86
    v_mul_f32 v51, v51, v87
    v_dot2_f32_bf16 v20, v6, s54, v20
    v_dot2_f32_bf16 v21, v6, v6, v21
    v_dot2_f32_bf16 v22, v7, s54, v22
    v_dot2_f32_bf16 v23, v7, v7, v23
    ds_read_b128 v[76:79], v19 offset:12288
    s_waitcnt lgkmcnt(3)
    v_mfma_f32_32x32x16_bf16 v[96:111], v[160:163], v[64:67], v[96:111]
    v_exp_f32 v48, v48
    v_add_f32 v20, v20, v22
    v_exp_f32 v49, v49
    v_exp_f32 v50, v50
    v_add_f32 v21, v21, v23
    ds_read_b128 v[64:67], v16 offset:16384
    s_waitcnt lgkmcnt(3)
    v_mfma_f32_32x32x16_bf16 v[96:111], v[164:167], v[68:71], v[96:111]
    v_add_f32_dpp v20, v20, v20 row_ror:8 row_mask:0xf bank_mask:0xf
    v_exp_f32 v51, v51
    v_fma_f32 v48, v48, v55, v55
    v_add_f32_dpp v21, v21, v21 row_ror:8 row_mask:0xf bank_mask:0xf
    ds_read_b128 v[68:71], v17 offset:16384
    s_waitcnt lgkmcnt(3)
    v_mfma_f32_32x32x16_bf16 v[96:111], v[168:171], v[72:75], v[96:111]
    v_add_f32_dpp v20, v20, v20 row_ror:4 row_mask:0xf bank_mask:0xf
    v_fma_f32 v49, v49, v55, v55
    v_fma_f32 v50, v50, v55, v55
    v_add_f32_dpp v21, v21, v21 row_ror:4 row_mask:0xf bank_mask:0xf
    v_fma_f32 v51, v51, v55, v55
    ds_read_b128 v[72:75], v18 offset:16384
    s_waitcnt lgkmcnt(3)
    v_mfma_f32_32x32x16_bf16 v[96:111], v[172:175], v[76:79], v[96:111]
    v_add_f32_dpp v20, v20, v20 row_ror:2 row_mask:0xf bank_mask:0xf
    v_rcp_f32 v48, v48
    v_rcp_f32 v49, v49
    v_add_f32_dpp v21, v21, v21 row_ror:2 row_mask:0xf bank_mask:0xf
    ds_read_b128 v[76:79], v19 offset:16384
    s_waitcnt lgkmcnt(3)
    v_mfma_f32_32x32x16_bf16 v[96:111], v[176:179], v[64:67], v[96:111]
    v_add_f32_dpp v20, v20, v20 row_ror:1 row_mask:0xf bank_mask:0xf
    v_rcp_f32 v50, v50
    v_rcp_f32 v51, v51
    v_add_f32_dpp v21, v21, v21 row_ror:1 row_mask:0xf bank_mask:0xf
    ds_read_b128 v[64:67], v16 offset:20480
    s_waitcnt lgkmcnt(3)
    v_mfma_f32_32x32x16_bf16 v[96:111], v[180:183], v[68:71], v[96:111]
    v_mul_f32 v20, 0x3ae38e39, v20
    v_mul_f32 v48, v48, v84
    v_mul_f32 v49, v49, v85
    v_mul_f32 v21, 0x3ae38e39, v21
    v_mul_f32 v50, v50, v86
    v_mul_f32 v51, v51, v87
    ds_read_b128 v[68:71], v17 offset:20480
    s_waitcnt lgkmcnt(3)
    v_mfma_f32_32x32x16_bf16 v[96:111], v[184:187], v[72:75], v[96:111]
    v_fma_f32 v21, -v20, v20, v21
    v_cvt_pk_bf16_f32 v38, v48, v49
    v_cvt_pk_bf16_f32 v39, v50, v51
    v_max_f32 v21, 0, v21
    buffer_store_dwordx4 v[36:39], v12, s[32:35], s50 offen offset:1024 sc1
    ds_read_b128 v[72:75], v18 offset:20480
    s_waitcnt lgkmcnt(3)
    v_mfma_f32_32x32x16_bf16 v[96:111], v[188:191], v[76:79], v[96:111]
    v_add_f32 v21, 0x3727c5ac, v21
    v_mul_f32 v44, v88, v88
    v_mul_f32 v45, v89, v89
    v_rsq_f32 v26, v21
    v_mul_f32 v46, v90, v90
    ds_read_b128 v[76:79], v19 offset:20480
    s_waitcnt lgkmcnt(3)
    v_mfma_f32_32x32x16_bf16 v[96:111], v[192:195], v[64:67], v[96:111]
    v_mul_f32 v27, v21, v26
    v_mul_f32 v47, v91, v91
    v_fma_f32 v44, v44, v61, v60
    v_cvt_pk_bf16_f32 v24, -v20, v27
    v_fma_f32 v45, v45, v61, v60
    v_fma_f32 v46, v46, v61, v60
    ds_read_b128 v[64:67], v16 offset:24576
    s_waitcnt lgkmcnt(3)
    v_mfma_f32_32x32x16_bf16 v[96:111], v[196:199], v[68:71], v[96:111]
    v_lshlrev_b32 v28, 16, v24
    v_fma_f32 v47, v47, v61, v60
    v_mul_f32 v44, v44, v88
    v_and_b32 v29, 0xffff0000, v24
    v_mul_f32 v45, v45, v89
    v_mul_f32 v46, v46, v90
    ds_read_b128 v[68:71], v17 offset:24576
    s_waitcnt lgkmcnt(3)
    v_mfma_f32_32x32x16_bf16 v[96:111], v[200:203], v[72:75], v[96:111]
    v_sub_f32 v28, -v20, v28
    v_mul_f32 v47, v47, v91
    v_exp_f32 v44, v44
    v_sub_f32 v29, v27, v29
    v_exp_f32 v45, v45
    ds_read_b128 v[72:75], v18 offset:24576
    s_waitcnt lgkmcnt(3)
    v_mfma_f32_32x32x16_bf16 v[96:111], v[204:207], v[76:79], v[96:111]
    v_cvt_pk_bf16_f32 v25, v28, v29
    v_exp_f32 v46, v46
    v_exp_f32 v47, v47
    ds_write_b128 v14, v[24:27] offset:512
    ds_read_b128 v[76:79], v19 offset:24576
    s_waitcnt lgkmcnt(4)
    v_mfma_f32_32x32x16_bf16 v[96:111], v[208:211], v[64:67], v[96:111]
    v_fma_f32 v44, v44, v55, v55
    v_fma_f32 v45, v45, v55, v55
    v_fma_f32 v46, v46, v55, v55
    v_fma_f32 v47, v47, v55, v55
    v_rcp_f32 v44, v44
    ds_read_b128 v[64:67], v16 offset:28672
    s_waitcnt lgkmcnt(4)
    v_mfma_f32_32x32x16_bf16 v[96:111], v[212:215], v[68:71], v[96:111]
    v_rcp_f32 v45, v45
    v_rcp_f32 v46, v46
    v_rcp_f32 v47, v47
    ds_read_b128 v[68:71], v17 offset:28672
    s_waitcnt lgkmcnt(4)
    v_mfma_f32_32x32x16_bf16 v[96:111], v[216:219], v[72:75], v[96:111]
    v_mul_f32 v44, v44, v88
    v_mul_f32 v45, v45, v89
    v_mul_f32 v46, v46, v90
    v_mul_f32 v47, v47, v91
    v_cvt_pk_bf16_f32 v40, v44, v45
    ds_read_b128 v[72:75], v18 offset:28672
    s_waitcnt lgkmcnt(3)
    v_mfma_f32_32x32x16_bf16 v[96:111], v[220:223], v[76:79], v[96:111]
    v_cvt_pk_bf16_f32 v41, v46, v47
    v_mul_f32 v48, v92, v92
    v_mul_f32 v49, v93, v93
    v_mul_f32 v50, v94, v94
    v_mul_f32 v51, v95, v95
    v_fma_f32 v48, v48, v61, v60
    ds_read_b128 v[76:79], v19 offset:28672
    s_waitcnt lgkmcnt(3)
    v_mfma_f32_32x32x16_bf16 v[96:111], v[224:227], v[64:67], v[96:111]
    v_fma_f32 v49, v49, v61, v60
    v_fma_f32 v50, v50, v61, v60
    v_fma_f32 v51, v51, v61, v60
    v_mul_f32 v48, v48, v92
    v_mul_f32 v49, v49, v93
    v_mul_f32 v50, v50, v94
    ds_read_b128 v[64:67], v16 offset:32768
    s_waitcnt lgkmcnt(3)
    v_mfma_f32_32x32x16_bf16 v[96:111], v[228:231], v[68:71], v[96:111]
    v_mul_f32 v51, v51, v95
    v_exp_f32 v48, v48
    v_exp_f32 v49, v49
    v_exp_f32 v50, v50
    ds_read_b128 v[68:71], v17 offset:32768
    s_waitcnt lgkmcnt(3)
    v_mfma_f32_32x32x16_bf16 v[96:111], v[232:235], v[72:75], v[96:111]
    v_exp_f32 v51, v51
    v_fma_f32 v48, v48, v55, v55
    v_fma_f32 v49, v49, v55, v55
    v_fma_f32 v50, v50, v55, v55
    s_waitcnt vmcnt(1)
    s_barrier
    ds_read_b128 v[56:59], v13 offset:512
    ds_read_b128 v[72:75], v18 offset:32768
    s_waitcnt lgkmcnt(4)
    v_mfma_f32_32x32x16_bf16 v[96:111], v[236:239], v[76:79], v[96:111]
    s_add_u32 m0, s47, 40960
    s_nop 0
    buffer_load_dwordx4 v11, s[16:19], s49 offen offset:0 lds
    v_fma_f32 v51, v51, v55, v55
    v_rcp_f32 v48, v48
    v_rcp_f32 v49, v49
    v_rcp_f32 v50, v50
    ds_read_b128 v[76:79], v19 offset:32768
    s_waitcnt lgkmcnt(4)
    v_mfma_f32_32x32x16_bf16 v[96:111], v[240:243], v[64:67], v[96:111]
    s_add_u32 m0, s47, 48896
    s_nop 0
    buffer_load_dwordx4 v11, s[16:19], s49 offen offset:256 lds
    v_rcp_f32 v51, v51
    v_mul_f32 v48, v48, v92
    v_mul_f32 v49, v49, v93
    v_mul_f32 v50, v50, v94
    v_add_u32 v16, 0x1a000, v16
    v_add_u32 v17, 0x1a000, v17
    v_add_u32 v18, 0x1a000, v18
    v_add_u32 v19, 0x1a000, v19
    v_add_u32 v15, 0x1a000, v15
    ds_read_b128 v[64:67], v16 offset:0
    s_waitcnt lgkmcnt(4)
    v_mfma_f32_32x32x16_bf16 v[96:111], v[244:247], v[68:71], v[96:111]
    s_add_u32 m0, s47, 56832
    s_nop 0
    buffer_load_dwordx4 v11, s[16:19], s49 offen offset:512 lds
    v_mul_f32 v51, v51, v95
    v_cvt_pk_bf16_f32 v42, v48, v49
    v_cvt_pk_bf16_f32 v43, v50, v51
    buffer_store_dwordx4 v[40:43], v12, s[32:35], s51 offen offset:1024 sc1
    ds_read_b128 v[68:71], v17 offset:0
    s_waitcnt lgkmcnt(3)
    v_mfma_f32_32x32x16_bf16 v[96:111], v[248:251], v[72:75], v[96:111]
    s_add_u32 m0, s47, 64768
    s_nop 0
    buffer_load_dwordx4 v11, s[16:19], s49 offen offset:768 lds
    ds_read_b128 v[72:75], v18 offset:0
    s_waitcnt lgkmcnt(3)
    v_mfma_f32_32x32x16_bf16 v[96:111], v[252:255], v[76:79], v[96:111]
    s_add_u32 m0, s47, 72704
    s_nop 0
    buffer_load_dwordx4 v11, s[16:19], s49 offen offset:1024 lds
    s_add_u32 s49, s49, 36864
    ds_read_b128 v[76:79], v19 offset:0
    s_waitcnt lgkmcnt(3)
    v_mfma_f32_32x32x16_bf16 v[80:95], v[112:115], v[64:67], 0
    ds_read_b64 v[24:25], v15 offset:0
    ds_read_b64 v[26:27], v15 offset:4096
    ds_read_b64 v[28:29], v15 offset:8192
    ds_read_b128 v[64:67], v16 offset:4096
    s_waitcnt lgkmcnt(6)
    v_mfma_f32_32x32x16_bf16 v[80:95], v[116:119], v[68:71], v[80:95]
    v_mfma_f32_32x32x8bf16_1k v[96:111], v[62:63], v[56:57], v[96:111]
    ds_read_b64 v[30:31], v15 offset:12288
    ds_read_b64 v[32:33], v15 offset:16384
    ds_read_b64 v[34:35], v15 offset:20480
    ds_read_b128 v[68:71], v17 offset:4096
    s_waitcnt lgkmcnt(9)
    v_mfma_f32_32x32x16_bf16 v[80:95], v[120:123], v[72:75], v[80:95]
    ds_read_b64 v[2:3], v15 offset:24576
    ds_read_b64 v[4:5], v15 offset:28672
    ds_read_b64 v[6:7], v15 offset:32768
    ds_read_b128 v[72:75], v18 offset:4096
    s_waitcnt lgkmcnt(12)
    v_mfma_f32_32x32x16_bf16 v[80:95], v[124:127], v[76:79], v[80:95]
    v_mul_f32 v60, 0xc0135761, v58
    v_mul_f32 v61, v58, v58
    v_mul_f32 v61, 0x3d372713, v61
    v_mul_f32 v61, v61, v60
    v_mul_f32 v44, v96, v96
    v_mul_f32 v45, v97, v97
    s_waitcnt lgkmcnt(11)
    v_dot2_f32_bf16 v20, v24, s54, 0
    v_dot2_f32_bf16 v21, v24, v24, 0
    v_dot2_f32_bf16 v22, v25, s54, 0
    v_dot2_f32_bf16 v23, v25, v25, 0
    ds_read_b128 v[76:79], v19 offset:4096
    s_waitcnt lgkmcnt(9)
    v_mfma_f32_32x32x16_bf16 v[80:95], v[128:131], v[64:67], v[80:95]
    v_mul_f32 v46, v98, v98
    v_mul_f32 v47, v99, v99
    v_fma_f32 v44, v44, v61, v60
    v_fma_f32 v45, v45, v61, v60
    v_fma_f32 v46, v46, v61, v60
    v_fma_f32 v47, v47, v61, v60
    v_dot2_f32_bf16 v20, v26, s54, v20
    v_dot2_f32_bf16 v21, v26, v26, v21
    v_dot2_f32_bf16 v22, v27, s54, v22
    v_dot2_f32_bf16 v23, v27, v27, v23
    ds_read_b128 v[64:67], v16 offset:8192
    s_waitcnt lgkmcnt(6)
    v_mfma_f32_32x32x16_bf16 v[80:95], v[132:135], v[68:71], v[80:95]
    v_mul_f32 v44, v44, v96
    v_mul_f32 v45, v45, v97
    v_mul_f32 v46, v46, v98
    v_mul_f32 v47, v47, v99
    v_exp_f32 v44, v44
    v_dot2_f32_bf16 v20, v28, s54, v20
    v_dot2_f32_bf16 v21, v28, v28, v21
    v_dot2_f32_bf16 v22, v29, s54, v22
    v_dot2_f32_bf16 v23, v29, v29, v23
    ds_read_b128 v[68:71], v17 offset:8192
    s_waitcnt lgkmcnt(3)
    v_mfma_f32_32x32x16_bf16 v[80:95], v[136:139], v[72:75], v[80:95]
    v_exp_f32 v45, v45
    v_exp_f32 v46, v46
    v_exp_f32 v47, v47
    v_dot2_f32_bf16 v20, v30, s54, v20
    v_dot2_f32_bf16 v21, v30, v30, v21
    v_dot2_f32_bf16 v22, v31, s54, v22
    v_dot2_f32_bf16 v23, v31, v31, v23
    ds_read_b128 v[72:75], v18 offset:8192
    s_waitcnt lgkmcnt(3)
    v_mfma_f32_32x32x16_bf16 v[80:95], v[140:143], v[76:79], v[80:95]
    v_fma_f32 v44, v44, v59, v59
    v_fma_f32 v45, v45, v59, v59
    v_fma_f32 v46, v46, v59, v59
    v_fma_f32 v47, v47, v59, v59
    v_rcp_f32 v44, v44
    v_dot2_f32_bf16 v20, v32, s54, v20
    v_dot2_f32_bf16 v21, v32, v32, v21
    v_dot2_f32_bf16 v22, v33, s54, v22
    v_dot2_f32_bf16 v23, v33, v33, v23
    ds_read_b128 v[76:79], v19 offset:8192
    s_waitcnt lgkmcnt(3)
    v_mfma_f32_32x32x16_bf16 v[80:95], v[144:147], v[64:67], v[80:95]
    v_rcp_f32 v45, v45
    v_rcp_f32 v46, v46
    v_rcp_f32 v47, v47
    v_dot2_f32_bf16 v20, v34, s54, v20
    v_dot2_f32_bf16 v21, v34, v34, v21
    v_dot2_f32_bf16 v22, v35, s54, v22
    v_dot2_f32_bf16 v23, v35, v35, v23
    ds_read_b128 v[64:67], v16 offset:12288
    s_waitcnt lgkmcnt(3)
    v_mfma_f32_32x32x16_bf16 v[80:95], v[148:151], v[68:71], v[80:95]
    v_mul_f32 v44, v44, v96
    v_mul_f32 v45, v45, v97
    v_mul_f32 v46, v46, v98
    v_mul_f32 v47, v47, v99
    v_cvt_pk_bf16_f32 v36, v44, v45
    v_cvt_pk_bf16_f32 v37, v46, v47
    v_dot2_f32_bf16 v20, v2, s54, v20
    v_dot2_f32_bf16 v21, v2, v2, v21
    v_dot2_f32_bf16 v22, v3, s54, v22
    v_dot2_f32_bf16 v23, v3, v3, v23
    ds_read_b128 v[68:71], v17 offset:12288
    s_waitcnt lgkmcnt(3)
    v_mfma_f32_32x32x16_bf16 v[80:95], v[152:155], v[72:75], v[80:95]
    v_mul_f32 v48, v100, v100
    v_mul_f32 v49, v101, v101
    v_mul_f32 v50, v102, v102
    v_mul_f32 v51, v103, v103
    v_fma_f32 v48, v48, v61, v60
    v_fma_f32 v49, v49, v61, v60
    v_dot2_f32_bf16 v20, v4, s54, v20
    v_dot2_f32_bf16 v21, v4, v4, v21
    v_dot2_f32_bf16 v22, v5, s54, v22
    v_dot2_f32_bf16 v23, v5, v5, v23
    ds_read_b128 v[72:75], v18 offset:12288
    s_waitcnt lgkmcnt(3)
    v_mfma_f32_32x32x16_bf16 v[80:95], v[156:159], v[76:79], v[80:95]
    v_fma_f32 v50, v50, v61, v60
    v_fma_f32 v51, v51, v61, v60
    v_mul_f32 v48, v48, v100
    v_mul_f32 v49, v49, v101
    v_mul_f32 v50, v50, v102
    v_mul_f32 v51, v51, v103
    v_dot2_f32_bf16 v20, v6, s54, v20
    v_dot2_f32_bf16 v21, v6, v6, v21
    v_dot2_f32_bf16 v22, v7, s54, v22
    v_dot2_f32_bf16 v23, v7, v7, v23
    ds_read_b128 v[76:79], v19 offset:12288
    s_waitcnt lgkmcnt(3)
    v_mfma_f32_32x32x16_bf16 v[80:95], v[160:163], v[64:67], v[80:95]
    v_exp_f32 v48, v48
    v_add_f32 v20, v20, v22
    v_exp_f32 v49, v49
    v_exp_f32 v50, v50
    v_add_f32 v21, v21, v23
    ds_read_b128 v[64:67], v16 offset:16384
    s_waitcnt lgkmcnt(3)
    v_mfma_f32_32x32x16_bf16 v[80:95], v[164:167], v[68:71], v[80:95]
    v_add_f32_dpp v20, v20, v20 row_ror:8 row_mask:0xf bank_mask:0xf
    v_exp_f32 v51, v51
    v_fma_f32 v48, v48, v59, v59
    v_add_f32_dpp v21, v21, v21 row_ror:8 row_mask:0xf bank_mask:0xf
    ds_read_b128 v[68:71], v17 offset:16384
    s_waitcnt lgkmcnt(3)
    v_mfma_f32_32x32x16_bf16 v[80:95], v[168:171], v[72:75], v[80:95]
    v_add_f32_dpp v20, v20, v20 row_ror:4 row_mask:0xf bank_mask:0xf
    v_fma_f32 v49, v49, v59, v59
    v_fma_f32 v50, v50, v59, v59
    v_add_f32_dpp v21, v21, v21 row_ror:4 row_mask:0xf bank_mask:0xf
    v_fma_f32 v51, v51, v59, v59
    ds_read_b128 v[72:75], v18 offset:16384
    s_waitcnt lgkmcnt(3)
    v_mfma_f32_32x32x16_bf16 v[80:95], v[172:175], v[76:79], v[80:95]
    v_add_f32_dpp v20, v20, v20 row_ror:2 row_mask:0xf bank_mask:0xf
    v_rcp_f32 v48, v48
    v_rcp_f32 v49, v49
    v_add_f32_dpp v21, v21, v21 row_ror:2 row_mask:0xf bank_mask:0xf
    ds_read_b128 v[76:79], v19 offset:16384
    s_waitcnt lgkmcnt(3)
    v_mfma_f32_32x32x16_bf16 v[80:95], v[176:179], v[64:67], v[80:95]
    v_add_f32_dpp v20, v20, v20 row_ror:1 row_mask:0xf bank_mask:0xf
    v_rcp_f32 v50, v50
    v_rcp_f32 v51, v51
    v_add_f32_dpp v21, v21, v21 row_ror:1 row_mask:0xf bank_mask:0xf
    ds_read_b128 v[64:67], v16 offset:20480
    s_waitcnt lgkmcnt(3)
    v_mfma_f32_32x32x16_bf16 v[80:95], v[180:183], v[68:71], v[80:95]
    v_mul_f32 v20, 0x3ae38e39, v20
    v_mul_f32 v48, v48, v100
    v_mul_f32 v49, v49, v101
    v_mul_f32 v21, 0x3ae38e39, v21
    v_mul_f32 v50, v50, v102
    v_mul_f32 v51, v51, v103
    ds_read_b128 v[68:71], v17 offset:20480
    s_waitcnt lgkmcnt(3)
    v_mfma_f32_32x32x16_bf16 v[80:95], v[184:187], v[72:75], v[80:95]
    v_fma_f32 v21, -v20, v20, v21
    v_cvt_pk_bf16_f32 v38, v48, v49
    v_cvt_pk_bf16_f32 v39, v50, v51
    v_max_f32 v21, 0, v21
    buffer_store_dwordx4 v[36:39], v12, s[32:35], s50 offen offset:1536 sc1
    ds_read_b128 v[72:75], v18 offset:20480
    s_waitcnt lgkmcnt(3)
    v_mfma_f32_32x32x16_bf16 v[80:95], v[188:191], v[76:79], v[80:95]
    v_add_f32 v21, 0x3727c5ac, v21
    v_mul_f32 v44, v104, v104
    v_mul_f32 v45, v105, v105
    v_rsq_f32 v26, v21
    v_mul_f32 v46, v106, v106
    ds_read_b128 v[76:79], v19 offset:20480
    s_waitcnt lgkmcnt(3)
    v_mfma_f32_32x32x16_bf16 v[80:95], v[192:195], v[64:67], v[80:95]
    v_mul_f32 v27, v21, v26
    v_mul_f32 v47, v107, v107
    v_fma_f32 v44, v44, v61, v60
    v_cvt_pk_bf16_f32 v24, -v20, v27
    v_fma_f32 v45, v45, v61, v60
    v_fma_f32 v46, v46, v61, v60
    ds_read_b128 v[64:67], v16 offset:24576
    s_waitcnt lgkmcnt(3)
    v_mfma_f32_32x32x16_bf16 v[80:95], v[196:199], v[68:71], v[80:95]
    v_lshlrev_b32 v28, 16, v24
    v_fma_f32 v47, v47, v61, v60
    v_mul_f32 v44, v44, v104
    v_and_b32 v29, 0xffff0000, v24
    v_mul_f32 v45, v45, v105
    v_mul_f32 v46, v46, v106
    ds_read_b128 v[68:71], v17 offset:24576
    s_waitcnt lgkmcnt(3)
    v_mfma_f32_32x32x16_bf16 v[80:95], v[200:203], v[72:75], v[80:95]
    v_sub_f32 v28, -v20, v28
    v_mul_f32 v47, v47, v107
    v_exp_f32 v44, v44
    v_sub_f32 v29, v27, v29
    v_exp_f32 v45, v45
    ds_read_b128 v[72:75], v18 offset:24576
    s_waitcnt lgkmcnt(3)
    v_mfma_f32_32x32x16_bf16 v[80:95], v[204:207], v[76:79], v[80:95]
    v_cvt_pk_bf16_f32 v25, v28, v29
    v_exp_f32 v46, v46
    v_exp_f32 v47, v47
    ds_write_b128 v14, v[24:27] offset:0
    ds_read_b128 v[76:79], v19 offset:24576
    s_waitcnt lgkmcnt(4)
    v_mfma_f32_32x32x16_bf16 v[80:95], v[208:211], v[64:67], v[80:95]
    v_fma_f32 v44, v44, v59, v59
    v_fma_f32 v45, v45, v59, v59
    v_fma_f32 v46, v46, v59, v59
    v_fma_f32 v47, v47, v59, v59
    v_rcp_f32 v44, v44
    ds_read_b128 v[64:67], v16 offset:28672
    s_waitcnt lgkmcnt(4)
    v_mfma_f32_32x32x16_bf16 v[80:95], v[212:215], v[68:71], v[80:95]
    v_rcp_f32 v45, v45
    v_rcp_f32 v46, v46
    v_rcp_f32 v47, v47
    ds_read_b128 v[68:71], v17 offset:28672
    s_waitcnt lgkmcnt(4)
    v_mfma_f32_32x32x16_bf16 v[80:95], v[216:219], v[72:75], v[80:95]
    v_mul_f32 v44, v44, v104
    v_mul_f32 v45, v45, v105
    v_mul_f32 v46, v46, v106
    v_mul_f32 v47, v47, v107
    v_cvt_pk_bf16_f32 v40, v44, v45
    ds_read_b128 v[72:75], v18 offset:28672
    s_waitcnt lgkmcnt(3)
    v_mfma_f32_32x32x16_bf16 v[80:95], v[220:223], v[76:79], v[80:95]
    v_cvt_pk_bf16_f32 v41, v46, v47
    v_mul_f32 v48, v108, v108
    v_mul_f32 v49, v109, v109
    v_mul_f32 v50, v110, v110
    v_mul_f32 v51, v111, v111
    v_fma_f32 v48, v48, v61, v60
    ds_read_b128 v[76:79], v19 offset:28672
    s_waitcnt lgkmcnt(3)
    v_mfma_f32_32x32x16_bf16 v[80:95], v[224:227], v[64:67], v[80:95]
    v_fma_f32 v49, v49, v61, v60
    v_fma_f32 v50, v50, v61, v60
    v_fma_f32 v51, v51, v61, v60
    v_mul_f32 v48, v48, v108
    v_mul_f32 v49, v49, v109
    v_mul_f32 v50, v50, v110
    ds_read_b128 v[64:67], v16 offset:32768
    s_waitcnt lgkmcnt(3)
    v_mfma_f32_32x32x16_bf16 v[80:95], v[228:231], v[68:71], v[80:95]
    v_mul_f32 v51, v51, v111
    v_exp_f32 v48, v48
    v_exp_f32 v49, v49
    v_exp_f32 v50, v50
    ds_read_b128 v[68:71], v17 offset:32768
    s_waitcnt lgkmcnt(3)
    v_mfma_f32_32x32x16_bf16 v[80:95], v[232:235], v[72:75], v[80:95]
    v_exp_f32 v51, v51
    v_fma_f32 v48, v48, v59, v59
    v_fma_f32 v49, v49, v59, v59
    v_fma_f32 v50, v50, v59, v59
    s_waitcnt vmcnt(1)
    s_barrier
    ds_read_b128 v[52:55], v13 offset:0
    s_cmp_gt_u32 s44, 6
    s_cbranch_scc1 L_k1rl_13
    s_cmp_lt_u32 s57, 18
    s_cselect_b32 s16, s14, s28
    s_cselect_b32 s17, s15, s29
    s_and_b32 s17, s17, 0xffff
    s_mov_b32 s18, 5308416
    s_cmp_lt_u32 s57, 18
    s_cselect_b32 s18, 663552, s18
    s_cselect_b32 s49, 0, 18
    s_sub_u32 s49, s57, s49
    s_mul_i32 s49, s49, 36864

L_k1rl_13:
    ds_read_b128 v[72:75], v18 offset:32768
    s_waitcnt lgkmcnt(4)
    v_mfma_f32_32x32x16_bf16 v[80:95], v[236:239], v[76:79], v[80:95]
    s_add_u32 m0, s47, 0
    s_nop 0
    buffer_load_dwordx4 v11, s[16:19], s49 offen offset:0 lds
    v_fma_f32 v51, v51, v59, v59
    v_rcp_f32 v48, v48
    v_rcp_f32 v49, v49
    v_rcp_f32 v50, v50
    ds_read_b128 v[76:79], v19 offset:32768
    s_waitcnt lgkmcnt(4)
    v_mfma_f32_32x32x16_bf16 v[80:95], v[240:243], v[64:67], v[80:95]
    s_add_u32 m0, s47, 7936
    s_nop 0
    buffer_load_dwordx4 v11, s[16:19], s49 offen offset:256 lds
    v_rcp_f32 v51, v51
    v_mul_f32 v48, v48, v108
    v_mul_f32 v49, v49, v109
    v_mul_f32 v50, v50, v110
    v_add_u32 v16, 0xffff0000, v16
    v_add_u32 v17, 0xffff0000, v17
    v_add_u32 v18, 0xffff0000, v18
    v_add_u32 v19, 0xffff0000, v19
    v_add_u32 v15, 0xffff0000, v15
    ds_read_b128 v[64:67], v16 offset:0
    s_waitcnt lgkmcnt(4)
    v_mfma_f32_32x32x16_bf16 v[80:95], v[244:247], v[68:71], v[80:95]
    s_add_u32 m0, s47, 15872
    s_nop 0
    buffer_load_dwordx4 v11, s[16:19], s49 offen offset:512 lds
    v_mul_f32 v51, v51, v111
    v_cvt_pk_bf16_f32 v42, v48, v49
    v_cvt_pk_bf16_f32 v43, v50, v51
    buffer_store_dwordx4 v[40:43], v12, s[32:35], s51 offen offset:1536 sc1
    ds_read_b128 v[68:71], v17 offset:0
    s_waitcnt lgkmcnt(3)
    v_mfma_f32_32x32x16_bf16 v[80:95], v[248:251], v[72:75], v[80:95]
    s_add_u32 m0, s47, 23808
    s_nop 0
    buffer_load_dwordx4 v11, s[16:19], s49 offen offset:768 lds
    ds_read_b128 v[72:75], v18 offset:0
    s_waitcnt lgkmcnt(3)
    v_mfma_f32_32x32x16_bf16 v[80:95], v[252:255], v[76:79], v[80:95]
    s_add_u32 m0, s47, 31744
    s_nop 0
    buffer_load_dwordx4 v11, s[16:19], s49 offen offset:1024 lds
    s_add_u32 s49, s49, 36864
    ds_read_b128 v[76:79], v19 offset:0
    s_waitcnt lgkmcnt(3)
    v_mfma_f32_32x32x16_bf16 v[96:111], v[112:115], v[64:67], 0
    ds_read_b64 v[24:25], v15 offset:0
    ds_read_b64 v[26:27], v15 offset:4096
    ds_read_b64 v[28:29], v15 offset:8192
    ds_read_b128 v[64:67], v16 offset:4096
    s_waitcnt lgkmcnt(6)
    v_mfma_f32_32x32x16_bf16 v[96:111], v[116:119], v[68:71], v[96:111]
    v_mfma_f32_32x32x8bf16_1k v[80:95], v[62:63], v[52:53], v[80:95]
    ds_read_b64 v[30:31], v15 offset:12288
    ds_read_b64 v[32:33], v15 offset:16384
    ds_read_b64 v[34:35], v15 offset:20480
    ds_read_b128 v[68:71], v17 offset:4096
    s_waitcnt lgkmcnt(9)
    v_mfma_f32_32x32x16_bf16 v[96:111], v[120:123], v[72:75], v[96:111]
    ds_read_b64 v[2:3], v15 offset:24576
    ds_read_b64 v[4:5], v15 offset:28672
    ds_read_b64 v[6:7], v15 offset:32768
    ds_read_b128 v[72:75], v18 offset:4096
    s_waitcnt lgkmcnt(12)
    v_mfma_f32_32x32x16_bf16 v[96:111], v[124:127], v[76:79], v[96:111]
    v_mul_f32 v60, 0xc0135761, v54
    v_mul_f32 v61, v54, v54
    v_mul_f32 v61, 0x3d372713, v61
    v_mul_f32 v61, v61, v60
    v_mul_f32 v44, v80, v80
    v_mul_f32 v45, v81, v81
    s_waitcnt lgkmcnt(11)
    v_dot2_f32_bf16 v20, v24, s54, 0
    v_dot2_f32_bf16 v21, v24, v24, 0
    v_dot2_f32_bf16 v22, v25, s54, 0
    v_dot2_f32_bf16 v23, v25, v25, 0
    ds_read_b128 v[76:79], v19 offset:4096
    s_waitcnt lgkmcnt(9)
    v_mfma_f32_32x32x16_bf16 v[96:111], v[128:131], v[64:67], v[96:111]
    v_mul_f32 v46, v82, v82
    v_mul_f32 v47, v83, v83
    v_fma_f32 v44, v44, v61, v60
    v_fma_f32 v45, v45, v61, v60
    v_fma_f32 v46, v46, v61, v60
    v_fma_f32 v47, v47, v61, v60
    v_dot2_f32_bf16 v20, v26, s54, v20
    v_dot2_f32_bf16 v21, v26, v26, v21
    v_dot2_f32_bf16 v22, v27, s54, v22
    v_dot2_f32_bf16 v23, v27, v27, v23
    ds_read_b128 v[64:67], v16 offset:8192
    s_waitcnt lgkmcnt(6)
    v_mfma_f32_32x32x16_bf16 v[96:111], v[132:135], v[68:71], v[96:111]
    v_mul_f32 v44, v44, v80
    v_mul_f32 v45, v45, v81
    v_mul_f32 v46, v46, v82
    v_mul_f32 v47, v47, v83
    v_exp_f32 v44, v44
    v_dot2_f32_bf16 v20, v28, s54, v20
    v_dot2_f32_bf16 v21, v28, v28, v21
    v_dot2_f32_bf16 v22, v29, s54, v22
    v_dot2_f32_bf16 v23, v29, v29, v23
    ds_read_b128 v[68:71], v17 offset:8192
    s_waitcnt lgkmcnt(3)
    v_mfma_f32_32x32x16_bf16 v[96:111], v[136:139], v[72:75], v[96:111]
    v_exp_f32 v45, v45
    v_exp_f32 v46, v46
    v_exp_f32 v47, v47
    v_dot2_f32_bf16 v20, v30, s54, v20
    v_dot2_f32_bf16 v21, v30, v30, v21
    v_dot2_f32_bf16 v22, v31, s54, v22
    v_dot2_f32_bf16 v23, v31, v31, v23
    ds_read_b128 v[72:75], v18 offset:8192
    s_waitcnt lgkmcnt(3)
    v_mfma_f32_32x32x16_bf16 v[96:111], v[140:143], v[76:79], v[96:111]
    v_fma_f32 v44, v44, v55, v55
    v_fma_f32 v45, v45, v55, v55
    v_fma_f32 v46, v46, v55, v55
    v_fma_f32 v47, v47, v55, v55
    v_rcp_f32 v44, v44
    v_dot2_f32_bf16 v20, v32, s54, v20
    v_dot2_f32_bf16 v21, v32, v32, v21
    v_dot2_f32_bf16 v22, v33, s54, v22
    v_dot2_f32_bf16 v23, v33, v33, v23
    ds_read_b128 v[76:79], v19 offset:8192
    s_waitcnt lgkmcnt(3)
    v_mfma_f32_32x32x16_bf16 v[96:111], v[144:147], v[64:67], v[96:111]
    v_rcp_f32 v45, v45
    v_rcp_f32 v46, v46
    v_rcp_f32 v47, v47
    v_dot2_f32_bf16 v20, v34, s54, v20
    v_dot2_f32_bf16 v21, v34, v34, v21
    v_dot2_f32_bf16 v22, v35, s54, v22
    v_dot2_f32_bf16 v23, v35, v35, v23
    ds_read_b128 v[64:67], v16 offset:12288
    s_waitcnt lgkmcnt(3)
    v_mfma_f32_32x32x16_bf16 v[96:111], v[148:151], v[68:71], v[96:111]
    v_mul_f32 v44, v44, v80
    v_mul_f32 v45, v45, v81
    v_mul_f32 v46, v46, v82
    v_mul_f32 v47, v47, v83
    v_cvt_pk_bf16_f32 v36, v44, v45
    v_cvt_pk_bf16_f32 v37, v46, v47
    v_dot2_f32_bf16 v20, v2, s54, v20
    v_dot2_f32_bf16 v21, v2, v2, v21
    v_dot2_f32_bf16 v22, v3, s54, v22
    v_dot2_f32_bf16 v23, v3, v3, v23
    ds_read_b128 v[68:71], v17 offset:12288
    s_waitcnt lgkmcnt(3)
    v_mfma_f32_32x32x16_bf16 v[96:111], v[152:155], v[72:75], v[96:111]
    v_mul_f32 v48, v84, v84
    v_mul_f32 v49, v85, v85
    v_mul_f32 v50, v86, v86
    v_mul_f32 v51, v87, v87
    v_fma_f32 v48, v48, v61, v60
    v_fma_f32 v49, v49, v61, v60
    v_dot2_f32_bf16 v20, v4, s54, v20
    v_dot2_f32_bf16 v21, v4, v4, v21
    v_dot2_f32_bf16 v22, v5, s54, v22
    v_dot2_f32_bf16 v23, v5, v5, v23
    ds_read_b128 v[72:75], v18 offset:12288
    s_waitcnt lgkmcnt(3)
    v_mfma_f32_32x32x16_bf16 v[96:111], v[156:159], v[76:79], v[96:111]
    v_fma_f32 v50, v50, v61, v60
    v_fma_f32 v51, v51, v61, v60
    v_mul_f32 v48, v48, v84
    v_mul_f32 v49, v49, v85
    v_mul_f32 v50, v50, v86
    v_mul_f32 v51, v51, v87
    v_dot2_f32_bf16 v20, v6, s54, v20
    v_dot2_f32_bf16 v21, v6, v6, v21
    v_dot2_f32_bf16 v22, v7, s54, v22
    v_dot2_f32_bf16 v23, v7, v7, v23
    ds_read_b128 v[76:79], v19 offset:12288
    s_waitcnt lgkmcnt(3)
    v_mfma_f32_32x32x16_bf16 v[96:111], v[160:163], v[64:67], v[96:111]
    v_exp_f32 v48, v48
    v_add_f32 v20, v20, v22
    v_exp_f32 v49, v49
    v_exp_f32 v50, v50
    v_add_f32 v21, v21, v23
    ds_read_b128 v[64:67], v16 offset:16384
    s_waitcnt lgkmcnt(3)
    v_mfma_f32_32x32x16_bf16 v[96:111], v[164:167], v[68:71], v[96:111]
    v_add_f32_dpp v20, v20, v20 row_ror:8 row_mask:0xf bank_mask:0xf
    v_exp_f32 v51, v51
    v_fma_f32 v48, v48, v55, v55
    v_add_f32_dpp v21, v21, v21 row_ror:8 row_mask:0xf bank_mask:0xf
    ds_read_b128 v[68:71], v17 offset:16384
    s_waitcnt lgkmcnt(3)
    v_mfma_f32_32x32x16_bf16 v[96:111], v[168:171], v[72:75], v[96:111]
    v_add_f32_dpp v20, v20, v20 row_ror:4 row_mask:0xf bank_mask:0xf
    v_fma_f32 v49, v49, v55, v55
    v_fma_f32 v50, v50, v55, v55
    v_add_f32_dpp v21, v21, v21 row_ror:4 row_mask:0xf bank_mask:0xf
    v_fma_f32 v51, v51, v55, v55
    ds_read_b128 v[72:75], v18 offset:16384
    s_waitcnt lgkmcnt(3)
    v_mfma_f32_32x32x16_bf16 v[96:111], v[172:175], v[76:79], v[96:111]
    v_add_f32_dpp v20, v20, v20 row_ror:2 row_mask:0xf bank_mask:0xf
    v_rcp_f32 v48, v48
    v_rcp_f32 v49, v49
    v_add_f32_dpp v21, v21, v21 row_ror:2 row_mask:0xf bank_mask:0xf
    ds_read_b128 v[76:79], v19 offset:16384
    s_waitcnt lgkmcnt(3)
    v_mfma_f32_32x32x16_bf16 v[96:111], v[176:179], v[64:67], v[96:111]
    v_add_f32_dpp v20, v20, v20 row_ror:1 row_mask:0xf bank_mask:0xf
    v_rcp_f32 v50, v50
    v_rcp_f32 v51, v51
    v_add_f32_dpp v21, v21, v21 row_ror:1 row_mask:0xf bank_mask:0xf
    ds_read_b128 v[64:67], v16 offset:20480
    s_waitcnt lgkmcnt(3)
    v_mfma_f32_32x32x16_bf16 v[96:111], v[180:183], v[68:71], v[96:111]
    v_mul_f32 v20, 0x3ae38e39, v20
    v_mul_f32 v48, v48, v84
    v_mul_f32 v49, v49, v85
    v_mul_f32 v21, 0x3ae38e39, v21
    v_mul_f32 v50, v50, v86
    v_mul_f32 v51, v51, v87
    ds_read_b128 v[68:71], v17 offset:20480
    s_waitcnt lgkmcnt(3)
    v_mfma_f32_32x32x16_bf16 v[96:111], v[184:187], v[72:75], v[96:111]
    v_fma_f32 v21, -v20, v20, v21
    v_cvt_pk_bf16_f32 v38, v48, v49
    v_cvt_pk_bf16_f32 v39, v50, v51
    v_max_f32 v21, 0, v21
    buffer_store_dwordx4 v[36:39], v12, s[32:35], s50 offen offset:2048 sc1
    ds_read_b128 v[72:75], v18 offset:20480
    s_waitcnt lgkmcnt(3)
    v_mfma_f32_32x32x16_bf16 v[96:111], v[188:191], v[76:79], v[96:111]
    v_add_f32 v21, 0x3727c5ac, v21
    v_mul_f32 v44, v88, v88
    v_mul_f32 v45, v89, v89
    v_rsq_f32 v26, v21
    v_mul_f32 v46, v90, v90
    ds_read_b128 v[76:79], v19 offset:20480
    s_waitcnt lgkmcnt(3)
    v_mfma_f32_32x32x16_bf16 v[96:111], v[192:195], v[64:67], v[96:111]
    v_mul_f32 v27, v21, v26
    v_mul_f32 v47, v91, v91
    v_fma_f32 v44, v44, v61, v60
    v_cvt_pk_bf16_f32 v24, -v20, v27
    v_fma_f32 v45, v45, v61, v60
    v_fma_f32 v46, v46, v61, v60
    ds_read_b128 v[64:67], v16 offset:24576
    s_waitcnt lgkmcnt(3)
    v_mfma_f32_32x32x16_bf16 v[96:111], v[196:199], v[68:71], v[96:111]
    v_lshlrev_b32 v28, 16, v24
    v_fma_f32 v47, v47, v61, v60
    v_mul_f32 v44, v44, v88
    v_and_b32 v29, 0xffff0000, v24
    v_mul_f32 v45, v45, v89
    v_mul_f32 v46, v46, v90
    ds_read_b128 v[68:71], v17 offset:24576
    s_waitcnt lgkmcnt(3)
    v_mfma_f32_32x32x16_bf16 v[96:111], v[200:203], v[72:75], v[96:111]
    v_sub_f32 v28, -v20, v28
    v_mul_f32 v47, v47, v91
    v_exp_f32 v44, v44
    v_sub_f32 v29, v27, v29
    v_exp_f32 v45, v45
    ds_read_b128 v[72:75], v18 offset:24576
    s_waitcnt lgkmcnt(3)
    v_mfma_f32_32x32x16_bf16 v[96:111], v[204:207], v[76:79], v[96:111]
    v_cvt_pk_bf16_f32 v25, v28, v29
    v_exp_f32 v46, v46
    v_exp_f32 v47, v47
    ds_write_b128 v14, v[24:27] offset:512
    ds_read_b128 v[76:79], v19 offset:24576
    s_waitcnt lgkmcnt(4)
    v_mfma_f32_32x32x16_bf16 v[96:111], v[208:211], v[64:67], v[96:111]
    v_fma_f32 v44, v44, v55, v55
    v_fma_f32 v45, v45, v55, v55
    v_fma_f32 v46, v46, v55, v55
    v_fma_f32 v47, v47, v55, v55
    v_rcp_f32 v44, v44
    ds_read_b128 v[64:67], v16 offset:28672
    s_waitcnt lgkmcnt(4)
    v_mfma_f32_32x32x16_bf16 v[96:111], v[212:215], v[68:71], v[96:111]
    v_rcp_f32 v45, v45
    v_rcp_f32 v46, v46
    v_rcp_f32 v47, v47
    ds_read_b128 v[68:71], v17 offset:28672
    s_waitcnt lgkmcnt(4)
    v_mfma_f32_32x32x16_bf16 v[96:111], v[216:219], v[72:75], v[96:111]
    v_mul_f32 v44, v44, v88
    v_mul_f32 v45, v45, v89
    v_mul_f32 v46, v46, v90
    v_mul_f32 v47, v47, v91
    v_cvt_pk_bf16_f32 v40, v44, v45
    ds_read_b128 v[72:75], v18 offset:28672
    s_waitcnt lgkmcnt(3)
    v_mfma_f32_32x32x16_bf16 v[96:111], v[220:223], v[76:79], v[96:111]
    v_cvt_pk_bf16_f32 v41, v46, v47
    v_mul_f32 v48, v92, v92
    v_mul_f32 v49, v93, v93
    v_mul_f32 v50, v94, v94
    v_mul_f32 v51, v95, v95
    v_fma_f32 v48, v48, v61, v60
    ds_read_b128 v[76:79], v19 offset:28672
    s_waitcnt lgkmcnt(3)
    v_mfma_f32_32x32x16_bf16 v[96:111], v[224:227], v[64:67], v[96:111]
    v_fma_f32 v49, v49, v61, v60
    v_fma_f32 v50, v50, v61, v60
    v_fma_f32 v51, v51, v61, v60
    v_mul_f32 v48, v48, v92
    v_mul_f32 v49, v49, v93
    v_mul_f32 v50, v50, v94
    ds_read_b128 v[64:67], v16 offset:32768
    s_waitcnt lgkmcnt(3)
    v_mfma_f32_32x32x16_bf16 v[96:111], v[228:231], v[68:71], v[96:111]
    v_mul_f32 v51, v51, v95
    v_exp_f32 v48, v48
    v_exp_f32 v49, v49
    v_exp_f32 v50, v50
    ds_read_b128 v[68:71], v17 offset:32768
    s_waitcnt lgkmcnt(3)
    v_mfma_f32_32x32x16_bf16 v[96:111], v[232:235], v[72:75], v[96:111]
    v_exp_f32 v51, v51
    v_fma_f32 v48, v48, v55, v55
    v_fma_f32 v49, v49, v55, v55
    v_fma_f32 v50, v50, v55, v55
    s_waitcnt vmcnt(1)
    s_barrier
    ds_read_b128 v[56:59], v13 offset:512
    ds_read_b128 v[72:75], v18 offset:32768
    s_waitcnt lgkmcnt(4)
    v_mfma_f32_32x32x16_bf16 v[96:111], v[236:239], v[76:79], v[96:111]
    v_fma_f32 v51, v51, v55, v55
    v_rcp_f32 v48, v48
    v_rcp_f32 v49, v49
    v_rcp_f32 v50, v50
    ds_read_b128 v[76:79], v19 offset:32768
    s_waitcnt lgkmcnt(4)
    v_mfma_f32_32x32x16_bf16 v[96:111], v[240:243], v[64:67], v[96:111]
    v_rcp_f32 v51, v51
    v_mul_f32 v48, v48, v92
    v_mul_f32 v49, v49, v93
    v_mul_f32 v50, v50, v94
    v_add_u32 v16, 0xffff6000, v16
    v_add_u32 v17, 0xffff6000, v17
    v_add_u32 v18, 0xffff6000, v18
    v_add_u32 v19, 0xffff6000, v19
    v_add_u32 v15, 0xffff6000, v15
    ds_read_b128 v[64:67], v16 offset:0
    s_waitcnt lgkmcnt(4)
    v_mfma_f32_32x32x16_bf16 v[96:111], v[244:247], v[68:71], v[96:111]
    v_mul_f32 v51, v51, v95
    v_cvt_pk_bf16_f32 v42, v48, v49
    v_cvt_pk_bf16_f32 v43, v50, v51
    buffer_store_dwordx4 v[40:43], v12, s[32:35], s51 offen offset:2048 sc1
    ds_read_b128 v[68:71], v17 offset:0
    s_waitcnt lgkmcnt(3)
    v_mfma_f32_32x32x16_bf16 v[96:111], v[248:251], v[72:75], v[96:111]
    ds_read_b128 v[72:75], v18 offset:0
    s_waitcnt lgkmcnt(3)
    v_mfma_f32_32x32x16_bf16 v[96:111], v[252:255], v[76:79], v[96:111]
    s_cmp_le_u32 s44, 6
    s_cbranch_scc1 L_k1tail5_12
    ds_read_b128 v[76:79], v19 offset:0
    s_waitcnt lgkmcnt(3)
    v_mfma_f32_32x32x16_bf16 v[80:95], v[112:115], v[64:67], 0
    ds_read_b64 v[24:25], v15 offset:0
    ds_read_b64 v[26:27], v15 offset:4096
    ds_read_b64 v[28:29], v15 offset:8192
    ds_read_b128 v[64:67], v16 offset:4096
    s_waitcnt lgkmcnt(6)
    v_mfma_f32_32x32x16_bf16 v[80:95], v[116:119], v[68:71], v[80:95]
    v_mfma_f32_32x32x8bf16_1k v[96:111], v[62:63], v[56:57], v[96:111]
    ds_read_b64 v[30:31], v15 offset:12288
    ds_read_b64 v[32:33], v15 offset:16384
    ds_read_b64 v[34:35], v15 offset:20480
    ds_read_b128 v[68:71], v17 offset:4096
    s_waitcnt lgkmcnt(9)
    v_mfma_f32_32x32x16_bf16 v[80:95], v[120:123], v[72:75], v[80:95]
    ds_read_b64 v[2:3], v15 offset:24576
    ds_read_b64 v[4:5], v15 offset:28672
    ds_read_b64 v[6:7], v15 offset:32768
    ds_read_b128 v[72:75], v18 offset:4096
    s_waitcnt lgkmcnt(12)
    v_mfma_f32_32x32x16_bf16 v[80:95], v[124:127], v[76:79], v[80:95]
    v_mul_f32 v60, 0xc0135761, v58
    v_mul_f32 v61, v58, v58
    v_mul_f32 v61, 0x3d372713, v61
    v_mul_f32 v61, v61, v60
    v_mul_f32 v44, v96, v96
    v_mul_f32 v45, v97, v97
    s_waitcnt lgkmcnt(11)
    v_dot2_f32_bf16 v20, v24, s54, 0
    v_dot2_f32_bf16 v21, v24, v24, 0
    v_dot2_f32_bf16 v22, v25, s54, 0
    v_dot2_f32_bf16 v23, v25, v25, 0
    ds_read_b128 v[76:79], v19 offset:4096
    s_waitcnt lgkmcnt(9)
    v_mfma_f32_32x32x16_bf16 v[80:95], v[128:131], v[64:67], v[80:95]
    v_mul_f32 v46, v98, v98
    v_mul_f32 v47, v99, v99
    v_fma_f32 v44, v44, v61, v60
    v_fma_f32 v45, v45, v61, v60
    v_fma_f32 v46, v46, v61, v60
    v_fma_f32 v47, v47, v61, v60
    v_dot2_f32_bf16 v20, v26, s54, v20
    v_dot2_f32_bf16 v21, v26, v26, v21
    v_dot2_f32_bf16 v22, v27, s54, v22
    v_dot2_f32_bf16 v23, v27, v27, v23
    ds_read_b128 v[64:67], v16 offset:8192
    s_waitcnt lgkmcnt(6)
    v_mfma_f32_32x32x16_bf16 v[80:95], v[132:135], v[68:71], v[80:95]
    v_mul_f32 v44, v44, v96
    v_mul_f32 v45, v45, v97
    v_mul_f32 v46, v46, v98
    v_mul_f32 v47, v47, v99
    v_exp_f32 v44, v44
    v_dot2_f32_bf16 v20, v28, s54, v20
    v_dot2_f32_bf16 v21, v28, v28, v21
    v_dot2_f32_bf16 v22, v29, s54, v22
    v_dot2_f32_bf16 v23, v29, v29, v23
    ds_read_b128 v[68:71], v17 offset:8192
    s_waitcnt lgkmcnt(3)
    v_mfma_f32_32x32x16_bf16 v[80:95], v[136:139], v[72:75], v[80:95]
    v_exp_f32 v45, v45
    v_exp_f32 v46, v46
    v_exp_f32 v47, v47
    v_dot2_f32_bf16 v20, v30, s54, v20
    v_dot2_f32_bf16 v21, v30, v30, v21
    v_dot2_f32_bf16 v22, v31, s54, v22
    v_dot2_f32_bf16 v23, v31, v31, v23
    ds_read_b128 v[72:75], v18 offset:8192
    s_waitcnt lgkmcnt(3)
    v_mfma_f32_32x32x16_bf16 v[80:95], v[140:143], v[76:79], v[80:95]
    v_fma_f32 v44, v44, v59, v59
    v_fma_f32 v45, v45, v59, v59
    v_fma_f32 v46, v46, v59, v59
    v_fma_f32 v47, v47, v59, v59
    v_rcp_f32 v44, v44
    v_dot2_f32_bf16 v20, v32, s54, v20
    v_dot2_f32_bf16 v21, v32, v32, v21
    v_dot2_f32_bf16 v22, v33, s54, v22
    v_dot2_f32_bf16 v23, v33, v33, v23
    ds_read_b128 v[76:79], v19 offset:8192
    s_waitcnt lgkmcnt(3)
    v_mfma_f32_32x32x16_bf16 v[80:95], v[144:147], v[64:67], v[80:95]
    v_rcp_f32 v45, v45
    v_rcp_f32 v46, v46
    v_rcp_f32 v47, v47
    v_dot2_f32_bf16 v20, v34, s54, v20
    v_dot2_f32_bf16 v21, v34, v34, v21
    v_dot2_f32_bf16 v22, v35, s54, v22
    v_dot2_f32_bf16 v23, v35, v35, v23
    ds_read_b128 v[64:67], v16 offset:12288
    s_waitcnt lgkmcnt(3)
    v_mfma_f32_32x32x16_bf16 v[80:95], v[148:151], v[68:71], v[80:95]
    v_mul_f32 v44, v44, v96
    v_mul_f32 v45, v45, v97
    v_mul_f32 v46, v46, v98
    v_mul_f32 v47, v47, v99
    v_cvt_pk_bf16_f32 v36, v44, v45
    v_cvt_pk_bf16_f32 v37, v46, v47
    v_dot2_f32_bf16 v20, v2, s54, v20
    v_dot2_f32_bf16 v21, v2, v2, v21
    v_dot2_f32_bf16 v22, v3, s54, v22
    v_dot2_f32_bf16 v23, v3, v3, v23
    ds_read_b128 v[68:71], v17 offset:12288
    s_waitcnt lgkmcnt(3)
    v_mfma_f32_32x32x16_bf16 v[80:95], v[152:155], v[72:75], v[80:95]
    v_mul_f32 v48, v100, v100
    v_mul_f32 v49, v101, v101
    v_mul_f32 v50, v102, v102
    v_mul_f32 v51, v103, v103
    v_fma_f32 v48, v48, v61, v60
    v_fma_f32 v49, v49, v61, v60
    v_dot2_f32_bf16 v20, v4, s54, v20
    v_dot2_f32_bf16 v21, v4, v4, v21
    v_dot2_f32_bf16 v22, v5, s54, v22
    v_dot2_f32_bf16 v23, v5, v5, v23
    ds_read_b128 v[72:75], v18 offset:12288
    s_waitcnt lgkmcnt(3)
    v_mfma_f32_32x32x16_bf16 v[80:95], v[156:159], v[76:79], v[80:95]
    v_fma_f32 v50, v50, v61, v60
    v_fma_f32 v51, v51, v61, v60
    v_mul_f32 v48, v48, v100
    v_mul_f32 v49, v49, v101
    v_mul_f32 v50, v50, v102
    v_mul_f32 v51, v51, v103
    v_dot2_f32_bf16 v20, v6, s54, v20
    v_dot2_f32_bf16 v21, v6, v6, v21
    v_dot2_f32_bf16 v22, v7, s54, v22
    v_dot2_f32_bf16 v23, v7, v7, v23
    ds_read_b128 v[76:79], v19 offset:12288
    s_waitcnt lgkmcnt(3)
    v_mfma_f32_32x32x16_bf16 v[80:95], v[160:163], v[64:67], v[80:95]
    v_exp_f32 v48, v48
    v_add_f32 v20, v20, v22
    v_exp_f32 v49, v49
    v_exp_f32 v50, v50
    v_add_f32 v21, v21, v23
    ds_read_b128 v[64:67], v16 offset:16384
    s_waitcnt lgkmcnt(3)
    v_mfma_f32_32x32x16_bf16 v[80:95], v[164:167], v[68:71], v[80:95]
    v_add_f32_dpp v20, v20, v20 row_ror:8 row_mask:0xf bank_mask:0xf
    v_exp_f32 v51, v51
    v_fma_f32 v48, v48, v59, v59
    v_add_f32_dpp v21, v21, v21 row_ror:8 row_mask:0xf bank_mask:0xf
    ds_read_b128 v[68:71], v17 offset:16384
    s_waitcnt lgkmcnt(3)
    v_mfma_f32_32x32x16_bf16 v[80:95], v[168:171], v[72:75], v[80:95]
    v_add_f32_dpp v20, v20, v20 row_ror:4 row_mask:0xf bank_mask:0xf
    v_fma_f32 v49, v49, v59, v59
    v_fma_f32 v50, v50, v59, v59
    v_add_f32_dpp v21, v21, v21 row_ror:4 row_mask:0xf bank_mask:0xf
    v_fma_f32 v51, v51, v59, v59
    ds_read_b128 v[72:75], v18 offset:16384
    s_waitcnt lgkmcnt(3)
    v_mfma_f32_32x32x16_bf16 v[80:95], v[172:175], v[76:79], v[80:95]
    v_add_f32_dpp v20, v20, v20 row_ror:2 row_mask:0xf bank_mask:0xf
    v_rcp_f32 v48, v48
    v_rcp_f32 v49, v49
    v_add_f32_dpp v21, v21, v21 row_ror:2 row_mask:0xf bank_mask:0xf
    ds_read_b128 v[76:79], v19 offset:16384
    s_waitcnt lgkmcnt(3)
    v_mfma_f32_32x32x16_bf16 v[80:95], v[176:179], v[64:67], v[80:95]
    v_add_f32_dpp v20, v20, v20 row_ror:1 row_mask:0xf bank_mask:0xf
    v_rcp_f32 v50, v50
    v_rcp_f32 v51, v51
    v_add_f32_dpp v21, v21, v21 row_ror:1 row_mask:0xf bank_mask:0xf
    ds_read_b128 v[64:67], v16 offset:20480
    s_waitcnt lgkmcnt(3)
    v_mfma_f32_32x32x16_bf16 v[80:95], v[180:183], v[68:71], v[80:95]
    v_mul_f32 v20, 0x3ae38e39, v20
    v_mul_f32 v48, v48, v100
    v_mul_f32 v49, v49, v101
    v_mul_f32 v21, 0x3ae38e39, v21
    v_mul_f32 v50, v50, v102
    v_mul_f32 v51, v51, v103
    ds_read_b128 v[68:71], v17 offset:20480
    s_waitcnt lgkmcnt(3)
    v_mfma_f32_32x32x16_bf16 v[80:95], v[184:187], v[72:75], v[80:95]
    v_fma_f32 v21, -v20, v20, v21
    v_cvt_pk_bf16_f32 v38, v48, v49
    v_cvt_pk_bf16_f32 v39, v50, v51
    v_max_f32 v21, 0, v21
    buffer_store_dwordx4 v[36:39], v12, s[32:35], s50 offen offset:2560 sc1
    ds_read_b128 v[72:75], v18 offset:20480
    s_waitcnt lgkmcnt(3)
    v_mfma_f32_32x32x16_bf16 v[80:95], v[188:191], v[76:79], v[80:95]
    v_add_f32 v21, 0x3727c5ac, v21
    v_mul_f32 v44, v104, v104
    v_mul_f32 v45, v105, v105
    v_rsq_f32 v26, v21
    v_mul_f32 v46, v106, v106
    ds_read_b128 v[76:79], v19 offset:20480
    s_waitcnt lgkmcnt(3)
    v_mfma_f32_32x32x16_bf16 v[80:95], v[192:195], v[64:67], v[80:95]
    v_mul_f32 v27, v21, v26
    v_mul_f32 v47, v107, v107
    v_fma_f32 v44, v44, v61, v60
    v_cvt_pk_bf16_f32 v24, -v20, v27
    v_fma_f32 v45, v45, v61, v60
    v_fma_f32 v46, v46, v61, v60
    ds_read_b128 v[64:67], v16 offset:24576
    s_waitcnt lgkmcnt(3)
    v_mfma_f32_32x32x16_bf16 v[80:95], v[196:199], v[68:71], v[80:95]
    v_lshlrev_b32 v28, 16, v24
    v_fma_f32 v47, v47, v61, v60
    v_mul_f32 v44, v44, v104
    v_and_b32 v29, 0xffff0000, v24
    v_mul_f32 v45, v45, v105
    v_mul_f32 v46, v46, v106
    ds_read_b128 v[68:71], v17 offset:24576
    s_waitcnt lgkmcnt(3)
    v_mfma_f32_32x32x16_bf16 v[80:95], v[200:203], v[72:75], v[80:95]
    v_sub_f32 v28, -v20, v28
    v_mul_f32 v47, v47, v107
    v_exp_f32 v44, v44
    v_sub_f32 v29, v27, v29
    v_exp_f32 v45, v45
    ds_read_b128 v[72:75], v18 offset:24576
    s_waitcnt lgkmcnt(3)
    v_mfma_f32_32x32x16_bf16 v[80:95], v[204:207], v[76:79], v[80:95]
    v_cvt_pk_bf16_f32 v25, v28, v29
    v_exp_f32 v46, v46
    v_exp_f32 v47, v47
    ds_write_b128 v14, v[24:27] offset:0
    ds_read_b128 v[76:79], v19 offset:24576
    s_waitcnt lgkmcnt(4)
    v_mfma_f32_32x32x16_bf16 v[80:95], v[208:211], v[64:67], v[80:95]
    v_fma_f32 v44, v44, v59, v59
    v_fma_f32 v45, v45, v59, v59
    v_fma_f32 v46, v46, v59, v59
    v_fma_f32 v47, v47, v59, v59
    v_rcp_f32 v44, v44
    ds_read_b128 v[64:67], v16 offset:28672
    s_waitcnt lgkmcnt(4)
    v_mfma_f32_32x32x16_bf16 v[80:95], v[212:215], v[68:71], v[80:95]
    v_rcp_f32 v45, v45
    v_rcp_f32 v46, v46
    v_rcp_f32 v47, v47
    ds_read_b128 v[68:71], v17 offset:28672
    s_waitcnt lgkmcnt(4)
    v_mfma_f32_32x32x16_bf16 v[80:95], v[216:219], v[72:75], v[80:95]
    v_mul_f32 v44, v44, v104
    v_mul_f32 v45, v45, v105
    v_mul_f32 v46, v46, v106
    v_mul_f32 v47, v47, v107
    v_cvt_pk_bf16_f32 v40, v44, v45
    ds_read_b128 v[72:75], v18 offset:28672
    s_waitcnt lgkmcnt(3)
    v_mfma_f32_32x32x16_bf16 v[80:95], v[220:223], v[76:79], v[80:95]
    v_cvt_pk_bf16_f32 v41, v46, v47
    v_mul_f32 v48, v108, v108
    v_mul_f32 v49, v109, v109
    v_mul_f32 v50, v110, v110
    v_mul_f32 v51, v111, v111
    v_fma_f32 v48, v48, v61, v60
    ds_read_b128 v[76:79], v19 offset:28672
    s_waitcnt lgkmcnt(3)
    v_mfma_f32_32x32x16_bf16 v[80:95], v[224:227], v[64:67], v[80:95]
    v_fma_f32 v49, v49, v61, v60
    v_fma_f32 v50, v50, v61, v60
    v_fma_f32 v51, v51, v61, v60
    v_mul_f32 v48, v48, v108
    v_mul_f32 v49, v49, v109
    v_mul_f32 v50, v50, v110
    ds_read_b128 v[64:67], v16 offset:32768
    s_waitcnt lgkmcnt(3)
    v_mfma_f32_32x32x16_bf16 v[80:95], v[228:231], v[68:71], v[80:95]
    v_mul_f32 v51, v51, v111
    v_exp_f32 v48, v48
    v_exp_f32 v49, v49
    v_exp_f32 v50, v50
    ds_read_b128 v[68:71], v17 offset:32768
    s_waitcnt lgkmcnt(3)
    v_mfma_f32_32x32x16_bf16 v[80:95], v[232:235], v[72:75], v[80:95]
    v_exp_f32 v51, v51
    v_fma_f32 v48, v48, v59, v59
    v_fma_f32 v49, v49, v59, v59
    v_fma_f32 v50, v50, v59, v59
    s_waitcnt vmcnt(1)
    s_barrier
    ds_read_b128 v[52:55], v13 offset:0
    ds_read_b128 v[72:75], v18 offset:32768
    s_waitcnt lgkmcnt(4)
    v_mfma_f32_32x32x16_bf16 v[80:95], v[236:239], v[76:79], v[80:95]
    v_fma_f32 v51, v51, v59, v59
    v_rcp_f32 v48, v48
    v_rcp_f32 v49, v49
    v_rcp_f32 v50, v50
    ds_read_b128 v[76:79], v19 offset:32768
    s_waitcnt lgkmcnt(4)
    v_mfma_f32_32x32x16_bf16 v[80:95], v[240:243], v[64:67], v[80:95]
    v_rcp_f32 v51, v51
    v_mul_f32 v48, v48, v108
    v_mul_f32 v49, v49, v109
    v_mul_f32 v50, v50, v110
    s_waitcnt lgkmcnt(3)
    v_mfma_f32_32x32x16_bf16 v[80:95], v[244:247], v[68:71], v[80:95]
    v_mul_f32 v51, v51, v111
    v_cvt_pk_bf16_f32 v42, v48, v49
    v_cvt_pk_bf16_f32 v43, v50, v51
    buffer_store_dwordx4 v[40:43], v12, s[32:35], s51 offen offset:2560 sc1
    s_waitcnt lgkmcnt(1)
    v_mfma_f32_32x32x16_bf16 v[80:95], v[248:251], v[72:75], v[80:95]
    s_waitcnt lgkmcnt(0)
    v_mfma_f32_32x32x16_bf16 v[80:95], v[252:255], v[76:79], v[80:95]
    s_nop 7
    v_mfma_f32_32x32x8bf16_1k v[80:95], v[62:63], v[52:53], v[80:95]
    s_nop 7
    s_nop 7
    s_nop 7
    v_mul_f32 v60, 0xc0135761, v54
    v_mul_f32 v61, v54, v54
    v_mul_f32 v61, 0x3d372713, v61
    v_mul_f32 v61, v61, v60
    v_mul_f32 v44, v80, v80
    v_mul_f32 v45, v81, v81
    v_mul_f32 v46, v82, v82
    v_mul_f32 v47, v83, v83
    v_fma_f32 v44, v44, v61, v60
    v_fma_f32 v45, v45, v61, v60
    v_fma_f32 v46, v46, v61, v60
    v_fma_f32 v47, v47, v61, v60
    v_mul_f32 v44, v44, v80
    v_mul_f32 v45, v45, v81
    v_mul_f32 v46, v46, v82
    v_mul_f32 v47, v47, v83
    v_exp_f32 v44, v44
    v_exp_f32 v45, v45
    v_exp_f32 v46, v46
    v_exp_f32 v47, v47
    v_fma_f32 v44, v44, v55, v55
    v_fma_f32 v45, v45, v55, v55
    v_fma_f32 v46, v46, v55, v55
    v_fma_f32 v47, v47, v55, v55
    v_rcp_f32 v44, v44
    v_rcp_f32 v45, v45
    v_rcp_f32 v46, v46
    v_rcp_f32 v47, v47
    v_mul_f32 v44, v44, v80
    v_mul_f32 v45, v45, v81
    v_mul_f32 v46, v46, v82
    v_mul_f32 v47, v47, v83
    v_cvt_pk_bf16_f32 v36, v44, v45
    v_cvt_pk_bf16_f32 v37, v46, v47
    v_mul_f32 v48, v84, v84
    v_mul_f32 v49, v85, v85
    v_mul_f32 v50, v86, v86
    v_mul_f32 v51, v87, v87
    v_fma_f32 v48, v48, v61, v60
    v_fma_f32 v49, v49, v61, v60
    v_fma_f32 v50, v50, v61, v60
    v_fma_f32 v51, v51, v61, v60
    v_mul_f32 v48, v48, v84
    v_mul_f32 v49, v49, v85
    v_mul_f32 v50, v50, v86
    v_mul_f32 v51, v51, v87
    v_exp_f32 v48, v48
    v_exp_f32 v49, v49
    v_exp_f32 v50, v50
    v_exp_f32 v51, v51
    v_fma_f32 v48, v48, v55, v55
    v_fma_f32 v49, v49, v55, v55
    v_fma_f32 v50, v50, v55, v55
    v_fma_f32 v51, v51, v55, v55
    v_rcp_f32 v48, v48
    v_rcp_f32 v49, v49
    v_rcp_f32 v50, v50
    v_rcp_f32 v51, v51
    v_mul_f32 v48, v48, v84
    v_mul_f32 v49, v49, v85
    v_mul_f32 v50, v50, v86
    v_mul_f32 v51, v51, v87
    v_cvt_pk_bf16_f32 v38, v48, v49
    v_cvt_pk_bf16_f32 v39, v50, v51
    buffer_store_dwordx4 v[36:39], v12, s[32:35], s50 offen offset:3072 sc1
    v_mul_f32 v44, v88, v88
    v_mul_f32 v45, v89, v89
    v_mul_f32 v46, v90, v90
    v_mul_f32 v47, v91, v91
    v_fma_f32 v44, v44, v61, v60
    v_fma_f32 v45, v45, v61, v60
    v_fma_f32 v46, v46, v61, v60
    v_fma_f32 v47, v47, v61, v60
    v_mul_f32 v44, v44, v88
    v_mul_f32 v45, v45, v89
    v_mul_f32 v46, v46, v90
    v_mul_f32 v47, v47, v91
    v_exp_f32 v44, v44
    v_exp_f32 v45, v45
    v_exp_f32 v46, v46
    v_exp_f32 v47, v47
    v_fma_f32 v44, v44, v55, v55
    v_fma_f32 v45, v45, v55, v55
    v_fma_f32 v46, v46, v55, v55
    v_fma_f32 v47, v47, v55, v55
    v_rcp_f32 v44, v44
    v_rcp_f32 v45, v45
    v_rcp_f32 v46, v46
    v_rcp_f32 v47, v47
    v_mul_f32 v44, v44, v88
    v_mul_f32 v45, v45, v89
    v_mul_f32 v46, v46, v90
    v_mul_f32 v47, v47, v91
    v_cvt_pk_bf16_f32 v40, v44, v45
    v_cvt_pk_bf16_f32 v41, v46, v47
    v_mul_f32 v48, v92, v92
    v_mul_f32 v49, v93, v93
    v_mul_f32 v50, v94, v94
    v_mul_f32 v51, v95, v95
    v_fma_f32 v48, v48, v61, v60
    v_fma_f32 v49, v49, v61, v60
    v_fma_f32 v50, v50, v61, v60
    v_fma_f32 v51, v51, v61, v60
    v_mul_f32 v48, v48, v92
    v_mul_f32 v49, v49, v93
    v_mul_f32 v50, v50, v94
    v_mul_f32 v51, v51, v95
    v_exp_f32 v48, v48
    v_exp_f32 v49, v49
    v_exp_f32 v50, v50
    v_exp_f32 v51, v51
    v_fma_f32 v48, v48, v55, v55
    v_fma_f32 v49, v49, v55, v55
    v_fma_f32 v50, v50, v55, v55
    v_fma_f32 v51, v51, v55, v55
    v_rcp_f32 v48, v48
    v_rcp_f32 v49, v49
    v_rcp_f32 v50, v50
    v_rcp_f32 v51, v51
    v_mul_f32 v48, v48, v92
    v_mul_f32 v49, v49, v93
    v_mul_f32 v50, v50, v94
    v_mul_f32 v51, v51, v95
    v_cvt_pk_bf16_f32 v42, v48, v49
    v_cvt_pk_bf16_f32 v43, v50, v51
    buffer_store_dwordx4 v[40:43], v12, s[32:35], s51 offen offset:3072 sc1
    s_branch L_k1end_1
L_k1tail5_12:
    s_nop 7
    v_mfma_f32_32x32x8bf16_1k v[96:111], v[62:63], v[56:57], v[96:111]
    s_nop 7
    s_nop 7
    s_nop 7
    v_mul_f32 v60, 0xc0135761, v58
    v_mul_f32 v61, v58, v58
    v_mul_f32 v61, 0x3d372713, v61
    v_mul_f32 v61, v61, v60
    v_mul_f32 v44, v96, v96
    v_mul_f32 v45, v97, v97
    v_mul_f32 v46, v98, v98
    v_mul_f32 v47, v99, v99
    v_fma_f32 v44, v44, v61, v60
    v_fma_f32 v45, v45, v61, v60
    v_fma_f32 v46, v46, v61, v60
    v_fma_f32 v47, v47, v61, v60
    v_mul_f32 v44, v44, v96
    v_mul_f32 v45, v45, v97
    v_mul_f32 v46, v46, v98
    v_mul_f32 v47, v47, v99
    v_exp_f32 v44, v44
    v_exp_f32 v45, v45
    v_exp_f32 v46, v46
    v_exp_f32 v47, v47
    v_fma_f32 v44, v44, v59, v59
    v_fma_f32 v45, v45, v59, v59
    v_fma_f32 v46, v46, v59, v59
    v_fma_f32 v47, v47, v59, v59
    v_rcp_f32 v44, v44
    v_rcp_f32 v45, v45
    v_rcp_f32 v46, v46
    v_rcp_f32 v47, v47
    v_mul_f32 v44, v44, v96
    v_mul_f32 v45, v45, v97
    v_mul_f32 v46, v46, v98
    v_mul_f32 v47, v47, v99
    v_cvt_pk_bf16_f32 v36, v44, v45
    v_cvt_pk_bf16_f32 v37, v46, v47
    v_mul_f32 v48, v100, v100
    v_mul_f32 v49, v101, v101
    v_mul_f32 v50, v102, v102
    v_mul_f32 v51, v103, v103
    v_fma_f32 v48, v48, v61, v60
    v_fma_f32 v49, v49, v61, v60
    v_fma_f32 v50, v50, v61, v60
    v_fma_f32 v51, v51, v61, v60
    v_mul_f32 v48, v48, v100
    v_mul_f32 v49, v49, v101
    v_mul_f32 v50, v50, v102
    v_mul_f32 v51, v51, v103
    v_exp_f32 v48, v48
    v_exp_f32 v49, v49
    v_exp_f32 v50, v50
    v_exp_f32 v51, v51
    v_fma_f32 v48, v48, v59, v59
    v_fma_f32 v49, v49, v59, v59
    v_fma_f32 v50, v50, v59, v59
    v_fma_f32 v51, v51, v59, v59
    v_rcp_f32 v48, v48
    v_rcp_f32 v49, v49
    v_rcp_f32 v50, v50
    v_rcp_f32 v51, v51
    v_mul_f32 v48, v48, v100
    v_mul_f32 v49, v49, v101
    v_mul_f32 v50, v50, v102
    v_mul_f32 v51, v51, v103
    v_cvt_pk_bf16_f32 v38, v48, v49
    v_cvt_pk_bf16_f32 v39, v50, v51
    buffer_store_dwordx4 v[36:39], v12, s[32:35], s50 offen offset:2560 sc1
    v_mul_f32 v44, v104, v104
    v_mul_f32 v45, v105, v105
    v_mul_f32 v46, v106, v106
    v_mul_f32 v47, v107, v107
    v_fma_f32 v44, v44, v61, v60
    v_fma_f32 v45, v45, v61, v60
    v_fma_f32 v46, v46, v61, v60
    v_fma_f32 v47, v47, v61, v60
    v_mul_f32 v44, v44, v104
    v_mul_f32 v45, v45, v105
    v_mul_f32 v46, v46, v106
    v_mul_f32 v47, v47, v107
    v_exp_f32 v44, v44
    v_exp_f32 v45, v45
    v_exp_f32 v46, v46
    v_exp_f32 v47, v47
    v_fma_f32 v44, v44, v59, v59
    v_fma_f32 v45, v45, v59, v59
    v_fma_f32 v46, v46, v59, v59
    v_fma_f32 v47, v47, v59, v59
    v_rcp_f32 v44, v44
    v_rcp_f32 v45, v45
    v_rcp_f32 v46, v46
    v_rcp_f32 v47, v47
    v_mul_f32 v44, v44, v104
    v_mul_f32 v45, v45, v105
    v_mul_f32 v46, v46, v106
    v_mul_f32 v47, v47, v107
    v_cvt_pk_bf16_f32 v40, v44, v45
    v_cvt_pk_bf16_f32 v41, v46, v47
    v_mul_f32 v48, v108, v108
    v_mul_f32 v49, v109, v109
    v_mul_f32 v50, v110, v110
    v_mul_f32 v51, v111, v111
    v_fma_f32 v48, v48, v61, v60
    v_fma_f32 v49, v49, v61, v60
    v_fma_f32 v50, v50, v61, v60
    v_fma_f32 v51, v51, v61, v60
    v_mul_f32 v48, v48, v108
    v_mul_f32 v49, v49, v109
    v_mul_f32 v50, v50, v110
    v_mul_f32 v51, v51, v111
    v_exp_f32 v48, v48
    v_exp_f32 v49, v49
    v_exp_f32 v50, v50
    v_exp_f32 v51, v51
    v_fma_f32 v48, v48, v59, v59
    v_fma_f32 v49, v49, v59, v59
    v_fma_f32 v50, v50, v59, v59
    v_fma_f32 v51, v51, v59, v59
    v_rcp_f32 v48, v48
    v_rcp_f32 v49, v49
    v_rcp_f32 v50, v50
    v_rcp_f32 v51, v51
    v_mul_f32 v48, v48, v108
    v_mul_f32 v49, v49, v109
    v_mul_f32 v50, v50, v110
    v_mul_f32 v51, v51, v111
    v_cvt_pk_bf16_f32 v42, v48, v49
    v_cvt_pk_bf16_f32 v43, v50, v51
    buffer_store_dwordx4 v[40:43], v12, s[32:35], s51 offen offset:2560 sc1
    s_waitcnt lgkmcnt(0)
    s_add_u32 s20, s12, 41943040
    s_addc_u32 s21, s13, 0
    s_and_b32 s21, s21, 0xffff
    s_mov_b32 s22, 5971968
    s_mov_b32 s23, 0x00020000
    v_and_b32 v2, 63, v0
    v_lshrrev_b32 v3, 4, v2
    v_lshlrev_b32 v4, 3, v3
    v_lshrrev_b32 v5, 2, v2
    v_and_b32 v5, 3, v5
    v_add_u32 v4, v4, v5
    v_lshlrev_b32 v6, 7, v4
    v_and_b32 v5, 2, v5
    v_and_b32 v3, 1, v3
    v_or_b32 v3, v3, v5
    s_and_b32 s58, s3, 3
    s_lshl_b32 s58, s58, 1
    v_lshrrev_b32 v5, 1, v2
    v_and_b32 v5, 1, v5
    v_or_b32 v5, s58, v5
    v_xor_b32 v3, v3, v5
    v_lshl_add_u32 v6, v3, 4, v6
    v_and_b32 v5, 1, v2
    v_lshl_add_u32 v6, v5, 3, v6
    s_lshr_b32 s58, s3, 2
    s_lshl_b32 s58, s58, 12
    s_add_u32 s58, s58, 0
    v_add_u32 v6, s58, v6
    v_xor_b32 v7, 64, v6
    v_lshlrev_b32 v3, 4, v2
    s_mul_i32 s59, s57, 9216

    ds_read_b64_tr_b16 v[64:65], v6 offset:0
    ds_read_b64_tr_b16 v[66:67], v7 offset:512
    ds_read_b64_tr_b16 v[68:69], v6 offset:8192
    ds_read_b64_tr_b16 v[70:71], v7 offset:8704
    ds_read_b64_tr_b16 v[72:73], v6 offset:16384
    ds_read_b64_tr_b16 v[74:75], v7 offset:16896
    ds_read_b64_tr_b16 v[76:77], v6 offset:24576
    ds_read_b64_tr_b16 v[78:79], v7 offset:25088
    ds_read_b64_tr_b16 v[80:81], v6 offset:32768
    ds_read_b64_tr_b16 v[82:83], v7 offset:33280
    s_add_u32 s58, s3, 0
    s_mul_i32 s60, s58, 57
    s_lshr_b32 s60, s60, 9
    s_mul_i32 s61, s60, 1483776
    s_lshl_b32 s58, s58, 10
    s_add_u32 s58, s58, s61
    s_add_u32 s58, s58, s59
    s_waitcnt lgkmcnt(8)
    buffer_store_dwordx4 v[64:67], v3, s[20:23], s58 offen sc1

    s_add_u32 s58, s3, 8
    s_mul_i32 s60, s58, 57
    s_lshr_b32 s60, s60, 9
    s_mul_i32 s61, s60, 1483776
    s_lshl_b32 s58, s58, 10
    s_add_u32 s58, s58, s61
    s_add_u32 s58, s58, s59
    s_waitcnt lgkmcnt(6)
    buffer_store_dwordx4 v[68:71], v3, s[20:23], s58 offen sc1

    s_add_u32 s58, s3, 16
    s_mul_i32 s60, s58, 57
    s_lshr_b32 s60, s60, 9
    s_mul_i32 s61, s60, 1483776
    s_lshl_b32 s58, s58, 10
    s_add_u32 s58, s58, s61
    s_add_u32 s58, s58, s59
    s_waitcnt lgkmcnt(4)
    buffer_store_dwordx4 v[72:75], v3, s[20:23], s58 offen sc1

    s_add_u32 s58, s3, 24
    s_mul_i32 s60, s58, 57
    s_lshr_b32 s60, s60, 9
    s_mul_i32 s61, s60, 1483776
    s_lshl_b32 s58, s58, 10
    s_add_u32 s58, s58, s61
    s_add_u32 s58, s58, s59
    s_waitcnt lgkmcnt(2)
    buffer_store_dwordx4 v[76:79], v3, s[20:23], s58 offen sc1

    s_cmp_ge_u32 s3, 4
    s_cbranch_scc1 L_rlskip_14
    s_add_u32 s58, s3, 32
    s_mul_i32 s60, s58, 57
    s_lshr_b32 s60, s60, 9
    s_mul_i32 s61, s60, 1483776
    s_lshl_b32 s58, s58, 10
    s_add_u32 s58, s58, s61
    s_add_u32 s58, s58, s59
    s_waitcnt lgkmcnt(0)
    buffer_store_dwordx4 v[80:83], v3, s[20:23], s58 offen sc1

L_rlskip_14:
    s_waitcnt lgkmcnt(0)
    s_branch L_k1end_1
L_k1idle_2:
    s_sub_u32 s57, s40, 250
    s_lshl_b32 s57, s57, 1
    s_add_u32 s57, s57, 150

    s_cmp_lt_u32 s57, 18
    s_cselect_b32 s16, s14, s28
    s_cselect_b32 s17, s15, s29
    s_and_b32 s17, s17, 0xffff
    s_mov_b32 s18, 5308416
    s_cmp_lt_u32 s57, 18
    s_cselect_b32 s18, 663552, s18
    s_cselect_b32 s49, 0, 18
    s_sub_u32 s49, s57, s49
    s_mul_i32 s49, s49, 36864

    s_add_u32 m0, s47, 0
    s_nop 0
    buffer_load_dwordx4 v11, s[16:19], s49 offen offset:0 lds
    s_add_u32 m0, s47, 7936
    s_nop 0
    buffer_load_dwordx4 v11, s[16:19], s49 offen offset:256 lds
    s_add_u32 m0, s47, 15872
    s_nop 0
    buffer_load_dwordx4 v11, s[16:19], s49 offen offset:512 lds
    s_add_u32 m0, s47, 23808
    s_nop 0
    buffer_load_dwordx4 v11, s[16:19], s49 offen offset:768 lds
    s_add_u32 m0, s47, 31744
    s_nop 0
    buffer_load_dwordx4 v11, s[16:19], s49 offen offset:1024 lds
    s_add_u32 s49, s49, 36864
    s_add_u32 m0, s47, 106496
    s_nop 0
    buffer_load_dwordx4 v11, s[16:19], s49 offen offset:0 lds
    s_add_u32 m0, s47, 114432
    s_nop 0
    buffer_load_dwordx4 v11, s[16:19], s49 offen offset:256 lds
    s_add_u32 m0, s47, 122368
    s_nop 0
    buffer_load_dwordx4 v11, s[16:19], s49 offen offset:512 lds
    s_add_u32 m0, s47, 130304
    s_nop 0
    buffer_load_dwordx4 v11, s[16:19], s49 offen offset:768 lds
    s_add_u32 m0, s47, 138240
    s_nop 0
    buffer_load_dwordx4 v11, s[16:19], s49 offen offset:1024 lds
    s_add_u32 s49, s49, 36864
    s_mul_i32 s60, s2, 27648
    s_add_u32 s60, s60, 67108864
    s_add_u32 s60, s60, s12
    s_addc_u32 s61, s13, 0
    s_and_b32 s61, s61, 0xffff
    s_mov_b32 s62, 27648
    s_mov_b32 s63, 0x00020000
    v_mov_b32 v36, -1
    v_mov_b32 v37, -1
    v_mov_b32 v38, -1
    v_mov_b32 v39, -1
    v_lshlrev_b32 v40, 4, v0
    s_mov_b32 s58, 8192
    s_mov_b32 s59, 16384
    v_add_u32 v41, 24576, v40

    buffer_store_dwordx4 v[36:39], v40, s[60:63], 0 offen sc1
    buffer_store_dwordx4 v[36:39], v40, s[60:63], s58 offen sc1
    buffer_store_dwordx4 v[36:39], v40, s[60:63], s59 offen sc1
    buffer_store_dwordx4 v[36:39], v41, s[60:63], 0 offen sc1
    s_waitcnt vmcnt(0)
    s_barrier
    s_add_u32 s20, s12, 41943040
    s_addc_u32 s21, s13, 0
    s_and_b32 s21, s21, 0xffff
    s_mov_b32 s22, 5971968
    s_mov_b32 s23, 0x00020000
    v_and_b32 v2, 63, v0
    v_lshrrev_b32 v3, 4, v2
    v_lshlrev_b32 v4, 3, v3
    v_lshrrev_b32 v5, 2, v2
    v_and_b32 v5, 3, v5
    v_add_u32 v4, v4, v5
    v_lshlrev_b32 v6, 7, v4
    v_and_b32 v5, 2, v5
    v_and_b32 v3, 1, v3
    v_or_b32 v3, v3, v5
    s_and_b32 s58, s3, 3
    s_lshl_b32 s58, s58, 1
    v_lshrrev_b32 v5, 1, v2
    v_and_b32 v5, 1, v5
    v_or_b32 v5, s58, v5
    v_xor_b32 v3, v3, v5
    v_lshl_add_u32 v6, v3, 4, v6
    v_and_b32 v5, 1, v2
    v_lshl_add_u32 v6, v5, 3, v6
    s_lshr_b32 s58, s3, 2
    s_lshl_b32 s58, s58, 12
    s_add_u32 s58, s58, 0
    v_add_u32 v6, s58, v6
    v_xor_b32 v7, 64, v6
    v_lshlrev_b32 v3, 4, v2
    s_mul_i32 s59, s57, 9216

    ds_read_b64_tr_b16 v[64:65], v6 offset:0
    ds_read_b64_tr_b16 v[66:67], v7 offset:512
    ds_read_b64_tr_b16 v[68:69], v6 offset:8192
    ds_read_b64_tr_b16 v[70:71], v7 offset:8704
    ds_read_b64_tr_b16 v[72:73], v6 offset:16384
    ds_read_b64_tr_b16 v[74:75], v7 offset:16896
    ds_read_b64_tr_b16 v[76:77], v6 offset:24576
    ds_read_b64_tr_b16 v[78:79], v7 offset:25088
    ds_read_b64_tr_b16 v[80:81], v6 offset:32768
    ds_read_b64_tr_b16 v[82:83], v7 offset:33280
    s_add_u32 s58, s3, 0
    s_mul_i32 s60, s58, 57
    s_lshr_b32 s60, s60, 9
    s_mul_i32 s61, s60, 1483776
    s_lshl_b32 s58, s58, 10
    s_add_u32 s58, s58, s61
    s_add_u32 s58, s58, s59
    s_waitcnt lgkmcnt(8)
    buffer_store_dwordx4 v[64:67], v3, s[20:23], s58 offen sc1

    s_add_u32 s58, s3, 8
    s_mul_i32 s60, s58, 57
    s_lshr_b32 s60, s60, 9
    s_mul_i32 s61, s60, 1483776
    s_lshl_b32 s58, s58, 10
    s_add_u32 s58, s58, s61
    s_add_u32 s58, s58, s59
    s_waitcnt lgkmcnt(6)
    buffer_store_dwordx4 v[68:71], v3, s[20:23], s58 offen sc1

    s_add_u32 s58, s3, 16
    s_mul_i32 s60, s58, 57
    s_lshr_b32 s60, s60, 9
    s_mul_i32 s61, s60, 1483776
    s_lshl_b32 s58, s58, 10
    s_add_u32 s58, s58, s61
    s_add_u32 s58, s58, s59
    s_waitcnt lgkmcnt(4)
    buffer_store_dwordx4 v[72:75], v3, s[20:23], s58 offen sc1

    s_add_u32 s58, s3, 24
    s_mul_i32 s60, s58, 57
    s_lshr_b32 s60, s60, 9
    s_mul_i32 s61, s60, 1483776
    s_lshl_b32 s58, s58, 10
    s_add_u32 s58, s58, s61
    s_add_u32 s58, s58, s59
    s_waitcnt lgkmcnt(2)
    buffer_store_dwordx4 v[76:79], v3, s[20:23], s58 offen sc1

    s_cmp_ge_u32 s3, 4
    s_cbranch_scc1 L_rlskip_15
    s_add_u32 s58, s3, 32
    s_mul_i32 s60, s58, 57
    s_lshr_b32 s60, s60, 9
    s_mul_i32 s61, s60, 1483776
    s_lshl_b32 s58, s58, 10
    s_add_u32 s58, s58, s61
    s_add_u32 s58, s58, s59
    s_waitcnt lgkmcnt(0)
    buffer_store_dwordx4 v[80:83], v3, s[20:23], s58 offen sc1

L_rlskip_15:
    s_waitcnt lgkmcnt(0)
    s_add_u32 s57, s57, 1
    s_add_u32 s20, s12, 41943040
    s_addc_u32 s21, s13, 0
    s_and_b32 s21, s21, 0xffff
    s_mov_b32 s22, 5971968
    s_mov_b32 s23, 0x00020000
    v_and_b32 v2, 63, v0
    v_lshrrev_b32 v3, 4, v2
    v_lshlrev_b32 v4, 3, v3
    v_lshrrev_b32 v5, 2, v2
    v_and_b32 v5, 3, v5
    v_add_u32 v4, v4, v5
    v_lshlrev_b32 v6, 7, v4
    v_and_b32 v5, 2, v5
    v_and_b32 v3, 1, v3
    v_or_b32 v3, v3, v5
    s_and_b32 s58, s3, 3
    s_lshl_b32 s58, s58, 1
    v_lshrrev_b32 v5, 1, v2
    v_and_b32 v5, 1, v5
    v_or_b32 v5, s58, v5
    v_xor_b32 v3, v3, v5
    v_lshl_add_u32 v6, v3, 4, v6
    v_and_b32 v5, 1, v2
    v_lshl_add_u32 v6, v5, 3, v6
    s_lshr_b32 s58, s3, 2
    s_lshl_b32 s58, s58, 12
    s_add_u32 s58, s58, 106496
    v_add_u32 v6, s58, v6
    v_xor_b32 v7, 64, v6
    v_lshlrev_b32 v3, 4, v2
    s_mul_i32 s59, s57, 9216

    ds_read_b64_tr_b16 v[64:65], v6 offset:0
    ds_read_b64_tr_b16 v[66:67], v7 offset:512
    ds_read_b64_tr_b16 v[68:69], v6 offset:8192
    ds_read_b64_tr_b16 v[70:71], v7 offset:8704
    ds_read_b64_tr_b16 v[72:73], v6 offset:16384
    ds_read_b64_tr_b16 v[74:75], v7 offset:16896
    ds_read_b64_tr_b16 v[76:77], v6 offset:24576
    ds_read_b64_tr_b16 v[78:79], v7 offset:25088
    ds_read_b64_tr_b16 v[80:81], v6 offset:32768
    ds_read_b64_tr_b16 v[82:83], v7 offset:33280
    s_add_u32 s58, s3, 0
    s_mul_i32 s60, s58, 57
    s_lshr_b32 s60, s60, 9
    s_mul_i32 s61, s60, 1483776
    s_lshl_b32 s58, s58, 10
    s_add_u32 s58, s58, s61
    s_add_u32 s58, s58, s59
    s_waitcnt lgkmcnt(8)
    buffer_store_dwordx4 v[64:67], v3, s[20:23], s58 offen sc1

    s_add_u32 s58, s3, 8
    s_mul_i32 s60, s58, 57
    s_lshr_b32 s60, s60, 9
    s_mul_i32 s61, s60, 1483776
    s_lshl_b32 s58, s58, 10
    s_add_u32 s58, s58, s61
    s_add_u32 s58, s58, s59
    s_waitcnt lgkmcnt(6)
    buffer_store_dwordx4 v[68:71], v3, s[20:23], s58 offen sc1

    s_add_u32 s58, s3, 16
    s_mul_i32 s60, s58, 57
    s_lshr_b32 s60, s60, 9
    s_mul_i32 s61, s60, 1483776
    s_lshl_b32 s58, s58, 10
    s_add_u32 s58, s58, s61
    s_add_u32 s58, s58, s59
    s_waitcnt lgkmcnt(4)
    buffer_store_dwordx4 v[72:75], v3, s[20:23], s58 offen sc1

    s_add_u32 s58, s3, 24
    s_mul_i32 s60, s58, 57
    s_lshr_b32 s60, s60, 9
    s_mul_i32 s61, s60, 1483776
    s_lshl_b32 s58, s58, 10
    s_add_u32 s58, s58, s61
    s_add_u32 s58, s58, s59
    s_waitcnt lgkmcnt(2)
    buffer_store_dwordx4 v[76:79], v3, s[20:23], s58 offen sc1

    s_cmp_ge_u32 s3, 4
    s_cbranch_scc1 L_rlskip_16
    s_add_u32 s58, s3, 32
    s_mul_i32 s60, s58, 57
    s_lshr_b32 s60, s60, 9
    s_mul_i32 s61, s60, 1483776
    s_lshl_b32 s58, s58, 10
    s_add_u32 s58, s58, s61
    s_add_u32 s58, s58, s59
    s_waitcnt lgkmcnt(0)
    buffer_store_dwordx4 v[80:83], v3, s[20:23], s58 offen sc1

L_rlskip_16:
    s_waitcnt lgkmcnt(0)
L_k1end_1:
    s_waitcnt vmcnt(0) lgkmcnt(0)
    s_endpgm
.globl k3_kernel
.p2align 8
.type k3_kernel,@function
k3_kernel:
    s_cmp_ge_u32 s2, 256
    s_cbranch_scc1 L_k3end_17
    s_load_dwordx2 s[12:13], s[0:1], 80
    s_load_dwordx2 s[4:5], s[0:1], 0
    s_load_dwordx2 s[10:11], s[0:1], 56
    s_load_dwordx2 s[14:15], s[0:1], 64
    v_lshrrev_b32 v1, 6, v0
    v_and_b32 v2, 63, v0
    s_nop 0
    v_readfirstlane_b32 s3, v1
    s_and_b32 s40, s2, 7
    s_lshr_b32 s41, s2, 3

    s_lshr_b32 s42, s40, 1
    s_and_b32 s43, s40, 1
    s_lshl_b32 s43, s43, 3
    s_lshr_b32 s44, s41, 2
    s_add_u32 s43, s43, s44
    s_and_b32 s44, s41, 3

    s_and_b32 s41, s42, 1
    s_lshr_b32 s40, s42, 1
    s_waitcnt lgkmcnt(0)

    s_add_u32 s20, s12, 41943040
    s_addc_u32 s21, s13, 0
    s_and_b32 s21, s21, 0xffff
    s_mov_b32 s22, 5971968
    s_mov_b32 s23, 0x00020000
    s_add_u32 s28, s12, 14417920
    s_addc_u32 s29, s13, 0
    s_and_b32 s29, s29, 0xffff
    s_mov_b32 s30, 21233664
    s_mov_b32 s31, 0x00020000
    s_add_u32 s24, s12, 0
    s_addc_u32 s25, s13, 0
    s_and_b32 s25, s25, 0xffff
    s_mov_b32 s26, 7077888
    s_mov_b32 s27, 0x00020000
    v_lshlrev_b32 v6, 4, v2
    s_cmp_eq_u32 s3, 4
    s_cbranch_scc1 L_k3prod0_18
    s_cmp_eq_u32 s3, 5
    s_cbranch_scc1 L_k3prod1_19
    s_cmp_eq_u32 s3, 6
    s_cbranch_scc1 L_k3prod2_20
    s_cmp_eq_u32 s3, 7
    s_cbranch_scc1 L_k3prod3_21

    s_setprio 1
    s_lshl_b32 s45, s41, 2
    s_add_u32 s45, s45, s44
    s_mul_i32 s45, s45, 9
    s_lshl_b32 s46, s3, 1
    s_add_u32 s45, s45, s46
    s_lshl_b32 s45, s45, 15
    s_add_u32 s46, s45, 0x8000
    s_add_u32 s47, s45, 0x10000
    s_lshl_b32 s68, s43, 7
    s_lshl_b32 s69, s40, 6
    s_add_u32 s68, s68, s69
    v_add_u32 v1, s68, v2
    v_lshlrev_b32 v4, 4, v1

    buffer_load_dwordx4 v[16:19], v4, s[24:27], s45 offen
    buffer_load_dwordx4 v[20:23], v4, s[24:27], s46 offen
    buffer_load_dwordx4 v[24:27], v4, s[24:27], s47 offen
    s_mul_i32 s69, s3, 2560
    s_add_u32 s69, s69, 139520
    s_lshl_b32 s68, s68, 4
    s_sub_u32 s69, s69, s68

    v_subrev_u32 v8, 0, v1
    v_max_i32 v8, 0, v8
    v_lshl_add_u32 v8, v8, 4, s69
    v_subrev_u32 v9, 2, v1
    v_max_i32 v9, 0, v9
    v_lshl_add_u32 v9, v9, 4, s69
    v_subrev_u32 v10, 4, v1
    v_max_i32 v10, 0, v10
    v_lshl_add_u32 v10, v10, 4, s69
    v_subrev_u32 v11, 6, v1
    v_max_i32 v11, 0, v11
    v_lshl_add_u32 v11, v11, 4, s69
    v_subrev_u32 v12, 8, v1
    v_max_i32 v12, 0, v12
    v_lshl_add_u32 v12, v12, 4, s69
    v_subrev_u32 v13, 10, v1
    v_max_i32 v13, 0, v13
    v_lshl_add_u32 v13, v13, 4, s69
    v_subrev_u32 v14, 12, v1
    v_max_i32 v14, 0, v14
    v_lshl_add_u32 v14, v14, 4, s69
    v_subrev_u32 v15, 14, v1
    v_max_i32 v15, 0, v15
    v_lshl_add_u32 v15, v15, 4, s69
    v_cmp_le_u32 s[54:55], 2, v1
    v_cmp_le_u32 s[56:57], 4, v1
    v_cmp_le_u32 s[58:59], 6, v1
    v_cmp_le_u32 s[60:61], 8, v1
    v_cmp_le_u32 s[62:63], 10, v1
    v_cmp_le_u32 s[64:65], 12, v1
    v_cmp_le_u32 s[66:67], 14, v1
    s_mov_b32 s52, 0x05040100
    s_mov_b32 s53, 0x07060302
    s_cmp_eq_u32 s3, 1
    s_cbranch_scc1 L_k3v1_23
    s_cmp_eq_u32 s3, 2
    s_cbranch_scc1 L_k3v2_24
    s_cmp_eq_u32 s3, 3
    s_cbranch_scc1 L_k3v3_25

L_k3v0_22:
    v_mov_b32 v7, 0xce6e6b28
    s_barrier
    ds_read_b128 v[28:31], v8 offset:0
    ds_read_b128 v[32:35], v8 offset:1280
    ds_read_b32 v36, v8 offset:2560
    ds_read_b128 v[40:43], v9 offset:0
    ds_read_b128 v[44:47], v9 offset:1280
    ds_read_b32 v48, v9 offset:2560
    ds_read_b128 v[52:55], v10 offset:0
    ds_read_b128 v[56:59], v10 offset:1280
    ds_read_b32 v60, v10 offset:2560
    ds_read_b128 v[64:67], v11 offset:0
    ds_read_b128 v[68:71], v11 offset:1280
    ds_read_b32 v72, v11 offset:2560
    s_waitcnt vmcnt(0)
    ds_read_b128 v[76:79], v12 offset:0
    ds_read_b128 v[80:83], v12 offset:1280
    ds_read_b32 v84, v12 offset:2560
    s_waitcnt lgkmcnt(12)
    v_dot2_f32_bf16 v220, v16, v28, 0
    v_dot2_f32_bf16 v220, v17, v29, v220
    v_dot2_f32_bf16 v220, v18, v30, v220
    v_dot2_f32_bf16 v220, v19, v31, v220
    v_dot2_f32_bf16 v220, v20, v32, v220
    v_dot2_f32_bf16 v220, v21, v33, v220
    v_dot2_f32_bf16 v220, v22, v34, v220
    v_dot2_f32_bf16 v220, v23, v35, v220
    v_dot2_f32_bf16 v220, v24, v36, v220
    ds_read_b128 v[88:91], v13 offset:0
    ds_read_b128 v[92:95], v13 offset:1280
    ds_read_b32 v96, v13 offset:2560
    s_waitcnt lgkmcnt(12)
    v_dot2_f32_bf16 v221, v16, v40, 0
    v_dot2_f32_bf16 v221, v17, v41, v221
    v_dot2_f32_bf16 v221, v18, v42, v221
    v_dot2_f32_bf16 v221, v19, v43, v221
    v_dot2_f32_bf16 v221, v20, v44, v221
    v_dot2_f32_bf16 v221, v21, v45, v221
    v_dot2_f32_bf16 v221, v22, v46, v221
    v_dot2_f32_bf16 v221, v23, v47, v221
    v_dot2_f32_bf16 v221, v24, v48, v221
    ds_read_b128 v[100:103], v14 offset:0
    ds_read_b128 v[104:107], v14 offset:1280
    ds_read_b32 v108, v14 offset:2560
    s_waitcnt lgkmcnt(12)
    v_dot2_f32_bf16 v222, v16, v52, 0
    v_dot2_f32_bf16 v222, v17, v53, v222
    v_dot2_f32_bf16 v222, v18, v54, v222
    v_dot2_f32_bf16 v222, v19, v55, v222
    v_dot2_f32_bf16 v222, v20, v56, v222
    v_dot2_f32_bf16 v222, v21, v57, v222
    v_dot2_f32_bf16 v222, v22, v58, v222
    v_dot2_f32_bf16 v222, v23, v59, v222
    v_dot2_f32_bf16 v222, v24, v60, v222
    ds_read_b128 v[112:115], v15 offset:0
    ds_read_b128 v[116:119], v15 offset:1280
    ds_read_b32 v120, v15 offset:2560
    s_waitcnt lgkmcnt(12)
    v_dot2_f32_bf16 v223, v16, v64, 0
    v_dot2_f32_bf16 v223, v17, v65, v223
    v_dot2_f32_bf16 v223, v18, v66, v223
    v_dot2_f32_bf16 v223, v19, v67, v223
    v_dot2_f32_bf16 v223, v20, v68, v223
    v_dot2_f32_bf16 v223, v21, v69, v223
    v_dot2_f32_bf16 v223, v22, v70, v223
    v_dot2_f32_bf16 v223, v23, v71, v223
    v_dot2_f32_bf16 v223, v24, v72, v223
    ds_read_b128 v[124:127], v8 offset:11520
    ds_read_b128 v[128:131], v8 offset:12800
    ds_read_b32 v132, v8 offset:14080
    s_waitcnt lgkmcnt(12)
    v_dot2_f32_bf16 v224, v16, v76, 0
    v_dot2_f32_bf16 v224, v17, v77, v224
    v_dot2_f32_bf16 v224, v18, v78, v224
    v_dot2_f32_bf16 v224, v19, v79, v224
    v_dot2_f32_bf16 v224, v20, v80, v224
    v_dot2_f32_bf16 v224, v21, v81, v224
    v_dot2_f32_bf16 v224, v22, v82, v224
    v_dot2_f32_bf16 v224, v23, v83, v224
    v_dot2_f32_bf16 v224, v24, v84, v224
    ds_read_b128 v[136:139], v9 offset:11520
    ds_read_b128 v[140:143], v9 offset:12800
    ds_read_b32 v144, v9 offset:14080
    s_waitcnt lgkmcnt(12)
    v_dot2_f32_bf16 v225, v16, v88, 0
    v_dot2_f32_bf16 v225, v17, v89, v225
    v_dot2_f32_bf16 v225, v18, v90, v225
    v_dot2_f32_bf16 v225, v19, v91, v225
    v_dot2_f32_bf16 v225, v20, v92, v225
    v_dot2_f32_bf16 v225, v21, v93, v225
    v_dot2_f32_bf16 v225, v22, v94, v225
    v_dot2_f32_bf16 v225, v23, v95, v225
    v_dot2_f32_bf16 v225, v24, v96, v225
    ds_read_b128 v[148:151], v10 offset:11520
    ds_read_b128 v[152:155], v10 offset:12800
    ds_read_b32 v156, v10 offset:14080
    s_waitcnt lgkmcnt(12)
    v_dot2_f32_bf16 v226, v16, v100, 0
    v_dot2_f32_bf16 v226, v17, v101, v226
    v_dot2_f32_bf16 v226, v18, v102, v226
    v_dot2_f32_bf16 v226, v19, v103, v226
    v_dot2_f32_bf16 v226, v20, v104, v226
    v_dot2_f32_bf16 v226, v21, v105, v226
    v_dot2_f32_bf16 v226, v22, v106, v226
    v_dot2_f32_bf16 v226, v23, v107, v226
    v_dot2_f32_bf16 v226, v24, v108, v226
    ds_read_b128 v[160:163], v11 offset:11520
    ds_read_b128 v[164:167], v11 offset:12800
    ds_read_b32 v168, v11 offset:14080
    s_waitcnt lgkmcnt(12)
    v_dot2_f32_bf16 v227, v16, v112, 0
    v_dot2_f32_bf16 v227, v17, v113, v227
    v_dot2_f32_bf16 v227, v18, v114, v227
    v_dot2_f32_bf16 v227, v19, v115, v227
    v_dot2_f32_bf16 v227, v20, v116, v227
    v_dot2_f32_bf16 v227, v21, v117, v227
    v_dot2_f32_bf16 v227, v22, v118, v227
    v_dot2_f32_bf16 v227, v23, v119, v227
    v_dot2_f32_bf16 v227, v24, v120, v227
    ds_read_b128 v[172:175], v12 offset:11520
    ds_read_b128 v[176:179], v12 offset:12800
    ds_read_b32 v180, v12 offset:14080
    ds_read_b128 v[184:187], v13 offset:11520
    ds_read_b128 v[188:191], v13 offset:12800
    ds_read_b32 v192, v13 offset:14080
    ds_read_b128 v[196:199], v14 offset:11520
    ds_read_b128 v[200:203], v14 offset:12800
    ds_read_b32 v204, v14 offset:14080
    ds_read_b128 v[208:211], v15 offset:11520
    ds_read_b128 v[212:215], v15 offset:12800
    ds_read_b32 v216, v15 offset:14080
    v_cvt_pk_bf16_f32 v220, v220, v220
    v_cvt_pk_bf16_f32 v221, v221, v221
    v_cvt_pk_bf16_f32 v222, v222, v222
    v_cvt_pk_bf16_f32 v223, v223, v223
    v_cvt_pk_bf16_f32 v224, v224, v224
    v_cvt_pk_bf16_f32 v225, v225, v225
    v_cvt_pk_bf16_f32 v226, v226, v226
    v_cvt_pk_bf16_f32 v227, v227, v227
    v_lshlrev_b32 v220, 16, v220
    v_lshlrev_b32 v221, 16, v221
    v_lshlrev_b32 v222, 16, v222
    v_lshlrev_b32 v223, 16, v223
    v_lshlrev_b32 v224, 16, v224
    v_lshlrev_b32 v225, 16, v225
    v_lshlrev_b32 v226, 16, v226
    v_lshlrev_b32 v227, 16, v227
    v_mul_f32 v220, 0x3e715bef, v220
    v_mul_f32 v221, 0x3e715bef, v221
    v_mul_f32 v222, 0x3e715bef, v222
    v_mul_f32 v223, 0x3e715bef, v223
    v_mul_f32 v224, 0x3e715bef, v224
    v_mul_f32 v225, 0x3e715bef, v225
    v_mul_f32 v226, 0x3e715bef, v226
    v_mul_f32 v227, 0x3e715bef, v227
    v_cvt_pk_bf16_f32 v220, v220, v220
    v_cvt_pk_bf16_f32 v221, v221, v221
    v_cvt_pk_bf16_f32 v222, v222, v222
    v_cvt_pk_bf16_f32 v223, v223, v223
    v_cvt_pk_bf16_f32 v224, v224, v224
    v_cvt_pk_bf16_f32 v225, v225, v225
    v_cvt_pk_bf16_f32 v226, v226, v226
    v_cvt_pk_bf16_f32 v227, v227, v227
    v_lshlrev_b32 v220, 16, v220
    v_lshlrev_b32 v221, 16, v221
    v_lshlrev_b32 v222, 16, v222
    v_lshlrev_b32 v223, 16, v223
    v_lshlrev_b32 v224, 16, v224
    v_lshlrev_b32 v225, 16, v225
    v_lshlrev_b32 v226, 16, v226
    v_lshlrev_b32 v227, 16, v227
    v_cndmask_b32 v221, v7, v221, s[54:55]
    v_cndmask_b32 v222, v7, v222, s[56:57]
    v_cndmask_b32 v223, v7, v223, s[58:59]
    v_cndmask_b32 v224, v7, v224, s[60:61]
    v_cndmask_b32 v225, v7, v225, s[62:63]
    v_cndmask_b32 v226, v7, v226, s[64:65]
    v_cndmask_b32 v227, v7, v227, s[66:67]
    v_max3_f32 v5, v220, v221, v222
    v_max3_f32 v7, v223, v224, v225
    v_max3_f32 v5, v5, v226, v227
    v_max_f32 v5, v5, v7
    v_sub_f32 v220, v220, v5
    v_sub_f32 v221, v221, v5
    v_sub_f32 v222, v222, v5
    v_sub_f32 v223, v223, v5
    v_sub_f32 v224, v224, v5
    v_sub_f32 v225, v225, v5
    v_sub_f32 v226, v226, v5
    v_sub_f32 v227, v227, v5
    v_mul_f32 v220, 0x3fb8aa3b, v220
    v_mul_f32 v221, 0x3fb8aa3b, v221
    v_mul_f32 v222, 0x3fb8aa3b, v222
    v_mul_f32 v223, 0x3fb8aa3b, v223
    v_mul_f32 v224, 0x3fb8aa3b, v224
    v_mul_f32 v225, 0x3fb8aa3b, v225
    v_mul_f32 v226, 0x3fb8aa3b, v226
    v_mul_f32 v227, 0x3fb8aa3b, v227
    v_exp_f32 v220, v220
    v_exp_f32 v221, v221
    v_exp_f32 v222, v222
    v_exp_f32 v223, v223
    v_exp_f32 v224, v224
    v_exp_f32 v225, v225
    v_exp_f32 v226, v226
    v_exp_f32 v227, v227
    s_nop 0
    v_add_f32 v1, v220, v221
    v_add_f32 v7, v222, v223
    v_add_f32 v5, v224, v225
    v_add_f32 v3, v226, v227
    v_add_f32 v1, v1, v7
    v_add_f32 v5, v5, v3
    v_add_f32 v1, v1, v5
    v_rcp_f32 v1, v1
    s_nop 0

    v_mul_f32 v220, v220, v1
    v_mul_f32 v221, v221, v1
    v_mul_f32 v222, v222, v1
    v_mul_f32 v223, v223, v1
    v_mul_f32 v224, v224, v1
    v_mul_f32 v225, v225, v1
    v_mul_f32 v226, v226, v1
    v_mul_f32 v227, v227, v1
    v_cvt_pk_bf16_f32 v228, v220, v221
    v_cvt_pk_bf16_f32 v229, v222, v223
    v_cvt_pk_bf16_f32 v230, v224, v225
    v_cvt_pk_bf16_f32 v231, v226, v227
    s_waitcnt lgkmcnt(15)
    v_perm_b32 v48, v136, v124, s52
    v_perm_b32 v49, v136, v124, s53
    v_dot2_f32_bf16 v28, v48, v228, 0
    v_dot2_f32_bf16 v29, v49, v228, 0
    v_perm_b32 v50, v137, v125, s52
    v_perm_b32 v51, v137, v125, s53
    v_dot2_f32_bf16 v30, v50, v228, 0
    v_dot2_f32_bf16 v31, v51, v228, 0
    v_perm_b32 v52, v138, v126, s52
    v_perm_b32 v53, v138, v126, s53
    v_dot2_f32_bf16 v32, v52, v228, 0
    v_dot2_f32_bf16 v33, v53, v228, 0
    v_perm_b32 v54, v139, v127, s52
    v_perm_b32 v55, v139, v127, s53
    v_dot2_f32_bf16 v34, v54, v228, 0
    v_dot2_f32_bf16 v35, v55, v228, 0
    v_perm_b32 v48, v140, v128, s52
    v_perm_b32 v49, v140, v128, s53
    v_dot2_f32_bf16 v36, v48, v228, 0
    v_dot2_f32_bf16 v37, v49, v228, 0
    v_perm_b32 v50, v141, v129, s52
    v_perm_b32 v51, v141, v129, s53
    v_dot2_f32_bf16 v38, v50, v228, 0
    v_dot2_f32_bf16 v39, v51, v228, 0
    v_perm_b32 v52, v142, v130, s52
    v_perm_b32 v53, v142, v130, s53
    v_dot2_f32_bf16 v40, v52, v228, 0
    v_dot2_f32_bf16 v41, v53, v228, 0
    v_perm_b32 v54, v143, v131, s52
    v_perm_b32 v55, v143, v131, s53
    v_dot2_f32_bf16 v42, v54, v228, 0
    v_dot2_f32_bf16 v43, v55, v228, 0
    v_perm_b32 v48, v144, v132, s52
    v_perm_b32 v49, v144, v132, s53
    v_dot2_f32_bf16 v44, v48, v228, 0
    v_dot2_f32_bf16 v45, v49, v228, 0
    s_waitcnt lgkmcnt(12)
    v_perm_b32 v48, v160, v148, s52
    v_perm_b32 v49, v160, v148, s53
    v_dot2_f32_bf16 v28, v48, v229, v28
    v_dot2_f32_bf16 v29, v49, v229, v29
    v_perm_b32 v50, v161, v149, s52
    v_perm_b32 v51, v161, v149, s53
    v_dot2_f32_bf16 v30, v50, v229, v30
    v_dot2_f32_bf16 v31, v51, v229, v31
    v_perm_b32 v52, v162, v150, s52
    v_perm_b32 v53, v162, v150, s53
    v_dot2_f32_bf16 v32, v52, v229, v32
    v_dot2_f32_bf16 v33, v53, v229, v33
    v_perm_b32 v54, v163, v151, s52
    v_perm_b32 v55, v163, v151, s53
    v_dot2_f32_bf16 v34, v54, v229, v34
    v_dot2_f32_bf16 v35, v55, v229, v35
    v_perm_b32 v48, v164, v152, s52
    v_perm_b32 v49, v164, v152, s53
    v_dot2_f32_bf16 v36, v48, v229, v36
    v_dot2_f32_bf16 v37, v49, v229, v37
    v_perm_b32 v50, v165, v153, s52
    v_perm_b32 v51, v165, v153, s53
    v_dot2_f32_bf16 v38, v50, v229, v38
    v_dot2_f32_bf16 v39, v51, v229, v39
    v_perm_b32 v52, v166, v154, s52
    v_perm_b32 v53, v166, v154, s53
    v_dot2_f32_bf16 v40, v52, v229, v40
    v_dot2_f32_bf16 v41, v53, v229, v41
    v_perm_b32 v54, v167, v155, s52
    v_perm_b32 v55, v167, v155, s53
    v_dot2_f32_bf16 v42, v54, v229, v42
    v_dot2_f32_bf16 v43, v55, v229, v43
    v_perm_b32 v48, v168, v156, s52
    v_perm_b32 v49, v168, v156, s53
    v_dot2_f32_bf16 v44, v48, v229, v44
    v_dot2_f32_bf16 v45, v49, v229, v45
    s_waitcnt lgkmcnt(6)
    v_perm_b32 v48, v184, v172, s52
    v_perm_b32 v49, v184, v172, s53
    v_dot2_f32_bf16 v28, v48, v230, v28
    v_dot2_f32_bf16 v29, v49, v230, v29
    v_perm_b32 v50, v185, v173, s52
    v_perm_b32 v51, v185, v173, s53
    v_dot2_f32_bf16 v30, v50, v230, v30
    v_dot2_f32_bf16 v31, v51, v230, v31
    v_perm_b32 v52, v186, v174, s52
    v_perm_b32 v53, v186, v174, s53
    v_dot2_f32_bf16 v32, v52, v230, v32
    v_dot2_f32_bf16 v33, v53, v230, v33
    v_perm_b32 v54, v187, v175, s52
    v_perm_b32 v55, v187, v175, s53
    v_dot2_f32_bf16 v34, v54, v230, v34
    v_dot2_f32_bf16 v35, v55, v230, v35
    v_perm_b32 v48, v188, v176, s52
    v_perm_b32 v49, v188, v176, s53
    v_dot2_f32_bf16 v36, v48, v230, v36
    v_dot2_f32_bf16 v37, v49, v230, v37
    v_perm_b32 v50, v189, v177, s52
    v_perm_b32 v51, v189, v177, s53
    v_dot2_f32_bf16 v38, v50, v230, v38
    v_dot2_f32_bf16 v39, v51, v230, v39
    v_perm_b32 v52, v190, v178, s52
    v_perm_b32 v53, v190, v178, s53
    v_dot2_f32_bf16 v40, v52, v230, v40
    v_dot2_f32_bf16 v41, v53, v230, v41
    v_perm_b32 v54, v191, v179, s52
    v_perm_b32 v55, v191, v179, s53
    v_dot2_f32_bf16 v42, v54, v230, v42
    v_dot2_f32_bf16 v43, v55, v230, v43
    v_perm_b32 v48, v192, v180, s52
    v_perm_b32 v49, v192, v180, s53
    v_dot2_f32_bf16 v44, v48, v230, v44
    v_dot2_f32_bf16 v45, v49, v230, v45
    s_waitcnt lgkmcnt(0)
    v_perm_b32 v48, v208, v196, s52
    v_perm_b32 v49, v208, v196, s53
    v_dot2_f32_bf16 v28, v48, v231, v28
    v_dot2_f32_bf16 v29, v49, v231, v29
    v_perm_b32 v50, v209, v197, s52
    v_perm_b32 v51, v209, v197, s53
    v_dot2_f32_bf16 v30, v50, v231, v30
    v_dot2_f32_bf16 v31, v51, v231, v31
    v_perm_b32 v52, v210, v198, s52
    v_perm_b32 v53, v210, v198, s53
    v_dot2_f32_bf16 v32, v52, v231, v32
    v_dot2_f32_bf16 v33, v53, v231, v33
    v_perm_b32 v54, v211, v199, s52
    v_perm_b32 v55, v211, v199, s53
    v_dot2_f32_bf16 v34, v54, v231, v34
    v_dot2_f32_bf16 v35, v55, v231, v35
    v_perm_b32 v48, v212, v200, s52
    v_perm_b32 v49, v212, v200, s53
    v_dot2_f32_bf16 v36, v48, v231, v36
    v_dot2_f32_bf16 v37, v49, v231, v37
    v_perm_b32 v50, v213, v201, s52
    v_perm_b32 v51, v213, v201, s53
    v_dot2_f32_bf16 v38, v50, v231, v38
    v_dot2_f32_bf16 v39, v51, v231, v39
    v_perm_b32 v52, v214, v202, s52
    v_perm_b32 v53, v214, v202, s53
    v_dot2_f32_bf16 v40, v52, v231, v40
    v_dot2_f32_bf16 v41, v53, v231, v41
    v_perm_b32 v54, v215, v203, s52
    v_perm_b32 v55, v215, v203, s53
    v_dot2_f32_bf16 v42, v54, v231, v42
    v_dot2_f32_bf16 v43, v55, v231, v43
    v_perm_b32 v48, v216, v204, s52
    v_perm_b32 v49, v216, v204, s53
    v_dot2_f32_bf16 v44, v48, v231, v44
    v_dot2_f32_bf16 v45, v49, v231, v45
    s_nop 2
    v_cvt_pk_bf16_f32 v244, v28, v29
    v_cvt_pk_bf16_f32 v245, v30, v31
    v_cvt_pk_bf16_f32 v246, v32, v33
    v_cvt_pk_bf16_f32 v247, v34, v35
    v_cvt_pk_bf16_f32 v248, v36, v37
    v_cvt_pk_bf16_f32 v249, v38, v39
    v_cvt_pk_bf16_f32 v250, v40, v41
    v_cvt_pk_bf16_f32 v251, v42, v43
    v_cvt_pk_bf16_f32 v252, v44, v45
    buffer_store_dwordx4 v[244:247], v4, s[28:31], s45 offen offset:0 sc1
    buffer_store_dwordx4 v[248:251], v4, s[28:31], s46 offen offset:0 sc1
    buffer_store_dword v252, v4, s[28:31], s47 offen offset:0 sc1
    s_branch L_k3adone_26
L_k3v1_23:
    v_mov_b32 v7, 0xce6e6b28
    s_barrier
    ds_read_b128 v[28:31], v8 offset:0
    ds_read_b128 v[32:35], v8 offset:1280
    ds_read_b64 v[36:37], v8 offset:2560
    ds_read_b128 v[40:43], v9 offset:0
    ds_read_b128 v[44:47], v9 offset:1280
    ds_read_b64 v[48:49], v9 offset:2560
    ds_read_b128 v[52:55], v10 offset:0
    ds_read_b128 v[56:59], v10 offset:1280
    ds_read_b64 v[60:61], v10 offset:2560
    ds_read_b128 v[64:67], v11 offset:0
    ds_read_b128 v[68:71], v11 offset:1280
    ds_read_b64 v[72:73], v11 offset:2560
    s_waitcnt vmcnt(0)
    ds_read_b128 v[76:79], v12 offset:0
    ds_read_b128 v[80:83], v12 offset:1280
    ds_read_b64 v[84:85], v12 offset:2560
    s_waitcnt lgkmcnt(12)
    v_dot2_f32_bf16 v220, v17, v29, 0
    v_dot2_f32_bf16 v220, v18, v30, v220
    v_dot2_f32_bf16 v220, v19, v31, v220
    v_dot2_f32_bf16 v220, v20, v32, v220
    v_dot2_f32_bf16 v220, v21, v33, v220
    v_dot2_f32_bf16 v220, v22, v34, v220
    v_dot2_f32_bf16 v220, v23, v35, v220
    v_dot2_f32_bf16 v220, v24, v36, v220
    v_dot2_f32_bf16 v220, v25, v37, v220
    ds_read_b128 v[88:91], v13 offset:0
    ds_read_b128 v[92:95], v13 offset:1280
    ds_read_b64 v[96:97], v13 offset:2560
    s_waitcnt lgkmcnt(12)
    v_dot2_f32_bf16 v221, v17, v41, 0
    v_dot2_f32_bf16 v221, v18, v42, v221
    v_dot2_f32_bf16 v221, v19, v43, v221
    v_dot2_f32_bf16 v221, v20, v44, v221
    v_dot2_f32_bf16 v221, v21, v45, v221
    v_dot2_f32_bf16 v221, v22, v46, v221
    v_dot2_f32_bf16 v221, v23, v47, v221
    v_dot2_f32_bf16 v221, v24, v48, v221
    v_dot2_f32_bf16 v221, v25, v49, v221
    ds_read_b128 v[100:103], v14 offset:0
    ds_read_b128 v[104:107], v14 offset:1280
    ds_read_b64 v[108:109], v14 offset:2560
    s_waitcnt lgkmcnt(12)
    v_dot2_f32_bf16 v222, v17, v53, 0
    v_dot2_f32_bf16 v222, v18, v54, v222
    v_dot2_f32_bf16 v222, v19, v55, v222
    v_dot2_f32_bf16 v222, v20, v56, v222
    v_dot2_f32_bf16 v222, v21, v57, v222
    v_dot2_f32_bf16 v222, v22, v58, v222
    v_dot2_f32_bf16 v222, v23, v59, v222
    v_dot2_f32_bf16 v222, v24, v60, v222
    v_dot2_f32_bf16 v222, v25, v61, v222
    ds_read_b128 v[112:115], v15 offset:0
    ds_read_b128 v[116:119], v15 offset:1280
    ds_read_b64 v[120:121], v15 offset:2560
    s_waitcnt lgkmcnt(12)
    v_dot2_f32_bf16 v223, v17, v65, 0
    v_dot2_f32_bf16 v223, v18, v66, v223
    v_dot2_f32_bf16 v223, v19, v67, v223
    v_dot2_f32_bf16 v223, v20, v68, v223
    v_dot2_f32_bf16 v223, v21, v69, v223
    v_dot2_f32_bf16 v223, v22, v70, v223
    v_dot2_f32_bf16 v223, v23, v71, v223
    v_dot2_f32_bf16 v223, v24, v72, v223
    v_dot2_f32_bf16 v223, v25, v73, v223
    ds_read_b128 v[124:127], v8 offset:11520
    ds_read_b128 v[128:131], v8 offset:12800
    ds_read_b64 v[132:133], v8 offset:14080
    s_waitcnt lgkmcnt(12)
    v_dot2_f32_bf16 v224, v17, v77, 0
    v_dot2_f32_bf16 v224, v18, v78, v224
    v_dot2_f32_bf16 v224, v19, v79, v224
    v_dot2_f32_bf16 v224, v20, v80, v224
    v_dot2_f32_bf16 v224, v21, v81, v224
    v_dot2_f32_bf16 v224, v22, v82, v224
    v_dot2_f32_bf16 v224, v23, v83, v224
    v_dot2_f32_bf16 v224, v24, v84, v224
    v_dot2_f32_bf16 v224, v25, v85, v224
    ds_read_b128 v[136:139], v9 offset:11520
    ds_read_b128 v[140:143], v9 offset:12800
    ds_read_b64 v[144:145], v9 offset:14080
    s_waitcnt lgkmcnt(12)
    v_dot2_f32_bf16 v225, v17, v89, 0
    v_dot2_f32_bf16 v225, v18, v90, v225
    v_dot2_f32_bf16 v225, v19, v91, v225
    v_dot2_f32_bf16 v225, v20, v92, v225
    v_dot2_f32_bf16 v225, v21, v93, v225
    v_dot2_f32_bf16 v225, v22, v94, v225
    v_dot2_f32_bf16 v225, v23, v95, v225
    v_dot2_f32_bf16 v225, v24, v96, v225
    v_dot2_f32_bf16 v225, v25, v97, v225
    ds_read_b128 v[148:151], v10 offset:11520
    ds_read_b128 v[152:155], v10 offset:12800
    ds_read_b64 v[156:157], v10 offset:14080
    s_waitcnt lgkmcnt(12)
    v_dot2_f32_bf16 v226, v17, v101, 0
    v_dot2_f32_bf16 v226, v18, v102, v226
    v_dot2_f32_bf16 v226, v19, v103, v226
    v_dot2_f32_bf16 v226, v20, v104, v226
    v_dot2_f32_bf16 v226, v21, v105, v226
    v_dot2_f32_bf16 v226, v22, v106, v226
    v_dot2_f32_bf16 v226, v23, v107, v226
    v_dot2_f32_bf16 v226, v24, v108, v226
    v_dot2_f32_bf16 v226, v25, v109, v226
    ds_read_b128 v[160:163], v11 offset:11520
    ds_read_b128 v[164:167], v11 offset:12800
    ds_read_b64 v[168:169], v11 offset:14080
    s_waitcnt lgkmcnt(12)
    v_dot2_f32_bf16 v227, v17, v113, 0
    v_dot2_f32_bf16 v227, v18, v114, v227
    v_dot2_f32_bf16 v227, v19, v115, v227
    v_dot2_f32_bf16 v227, v20, v116, v227
    v_dot2_f32_bf16 v227, v21, v117, v227
    v_dot2_f32_bf16 v227, v22, v118, v227
    v_dot2_f32_bf16 v227, v23, v119, v227
    v_dot2_f32_bf16 v227, v24, v120, v227
    v_dot2_f32_bf16 v227, v25, v121, v227
    ds_read_b128 v[172:175], v12 offset:11520
    ds_read_b128 v[176:179], v12 offset:12800
    ds_read_b64 v[180:181], v12 offset:14080
    ds_read_b128 v[184:187], v13 offset:11520
    ds_read_b128 v[188:191], v13 offset:12800
    ds_read_b64 v[192:193], v13 offset:14080
    ds_read_b128 v[196:199], v14 offset:11520
    ds_read_b128 v[200:203], v14 offset:12800
    ds_read_b64 v[204:205], v14 offset:14080
    ds_read_b128 v[208:211], v15 offset:11520
    ds_read_b128 v[212:215], v15 offset:12800
    ds_read_b64 v[216:217], v15 offset:14080
    v_cvt_pk_bf16_f32 v220, v220, v220
    v_cvt_pk_bf16_f32 v221, v221, v221
    v_cvt_pk_bf16_f32 v222, v222, v222
    v_cvt_pk_bf16_f32 v223, v223, v223
    v_cvt_pk_bf16_f32 v224, v224, v224
    v_cvt_pk_bf16_f32 v225, v225, v225
    v_cvt_pk_bf16_f32 v226, v226, v226
    v_cvt_pk_bf16_f32 v227, v227, v227
    v_lshlrev_b32 v220, 16, v220
    v_lshlrev_b32 v221, 16, v221
    v_lshlrev_b32 v222, 16, v222
    v_lshlrev_b32 v223, 16, v223
    v_lshlrev_b32 v224, 16, v224
    v_lshlrev_b32 v225, 16, v225
    v_lshlrev_b32 v226, 16, v226
    v_lshlrev_b32 v227, 16, v227
    v_mul_f32 v220, 0x3e715bef, v220
    v_mul_f32 v221, 0x3e715bef, v221
    v_mul_f32 v222, 0x3e715bef, v222
    v_mul_f32 v223, 0x3e715bef, v223
    v_mul_f32 v224, 0x3e715bef, v224
    v_mul_f32 v225, 0x3e715bef, v225
    v_mul_f32 v226, 0x3e715bef, v226
    v_mul_f32 v227, 0x3e715bef, v227
    v_cvt_pk_bf16_f32 v220, v220, v220
    v_cvt_pk_bf16_f32 v221, v221, v221
    v_cvt_pk_bf16_f32 v222, v222, v222
    v_cvt_pk_bf16_f32 v223, v223, v223
    v_cvt_pk_bf16_f32 v224, v224, v224
    v_cvt_pk_bf16_f32 v225, v225, v225
    v_cvt_pk_bf16_f32 v226, v226, v226
    v_cvt_pk_bf16_f32 v227, v227, v227
    v_lshlrev_b32 v220, 16, v220
    v_lshlrev_b32 v221, 16, v221
    v_lshlrev_b32 v222, 16, v222
    v_lshlrev_b32 v223, 16, v223
    v_lshlrev_b32 v224, 16, v224
    v_lshlrev_b32 v225, 16, v225
    v_lshlrev_b32 v226, 16, v226
    v_lshlrev_b32 v227, 16, v227
    v_cndmask_b32 v221, v7, v221, s[54:55]
    v_cndmask_b32 v222, v7, v222, s[56:57]
    v_cndmask_b32 v223, v7, v223, s[58:59]
    v_cndmask_b32 v224, v7, v224, s[60:61]
    v_cndmask_b32 v225, v7, v225, s[62:63]
    v_cndmask_b32 v226, v7, v226, s[64:65]
    v_cndmask_b32 v227, v7, v227, s[66:67]
    v_max3_f32 v5, v220, v221, v222
    v_max3_f32 v7, v223, v224, v225
    v_max3_f32 v5, v5, v226, v227
    v_max_f32 v5, v5, v7
    v_sub_f32 v220, v220, v5
    v_sub_f32 v221, v221, v5
    v_sub_f32 v222, v222, v5
    v_sub_f32 v223, v223, v5
    v_sub_f32 v224, v224, v5
    v_sub_f32 v225, v225, v5
    v_sub_f32 v226, v226, v5
    v_sub_f32 v227, v227, v5
    v_mul_f32 v220, 0x3fb8aa3b, v220
    v_mul_f32 v221, 0x3fb8aa3b, v221
    v_mul_f32 v222, 0x3fb8aa3b, v222
    v_mul_f32 v223, 0x3fb8aa3b, v223
    v_mul_f32 v224, 0x3fb8aa3b, v224
    v_mul_f32 v225, 0x3fb8aa3b, v225
    v_mul_f32 v226, 0x3fb8aa3b, v226
    v_mul_f32 v227, 0x3fb8aa3b, v227
    v_exp_f32 v220, v220
    v_exp_f32 v221, v221
    v_exp_f32 v222, v222
    v_exp_f32 v223, v223
    v_exp_f32 v224, v224
    v_exp_f32 v225, v225
    v_exp_f32 v226, v226
    v_exp_f32 v227, v227
    s_nop 0
    v_add_f32 v1, v220, v221
    v_add_f32 v7, v222, v223
    v_add_f32 v5, v224, v225
    v_add_f32 v3, v226, v227
    v_add_f32 v1, v1, v7
    v_add_f32 v5, v5, v3
    v_add_f32 v1, v1, v5
    v_rcp_f32 v1, v1
    s_nop 0

    v_mul_f32 v220, v220, v1
    v_mul_f32 v221, v221, v1
    v_mul_f32 v222, v222, v1
    v_mul_f32 v223, v223, v1
    v_mul_f32 v224, v224, v1
    v_mul_f32 v225, v225, v1
    v_mul_f32 v226, v226, v1
    v_mul_f32 v227, v227, v1
    v_cvt_pk_bf16_f32 v228, v220, v221
    v_cvt_pk_bf16_f32 v229, v222, v223
    v_cvt_pk_bf16_f32 v230, v224, v225
    v_cvt_pk_bf16_f32 v231, v226, v227
    s_waitcnt lgkmcnt(15)
    v_perm_b32 v48, v137, v125, s52
    v_perm_b32 v49, v137, v125, s53
    v_dot2_f32_bf16 v28, v48, v228, 0
    v_dot2_f32_bf16 v29, v49, v228, 0
    v_perm_b32 v50, v138, v126, s52
    v_perm_b32 v51, v138, v126, s53
    v_dot2_f32_bf16 v30, v50, v228, 0
    v_dot2_f32_bf16 v31, v51, v228, 0
    v_perm_b32 v52, v139, v127, s52
    v_perm_b32 v53, v139, v127, s53
    v_dot2_f32_bf16 v32, v52, v228, 0
    v_dot2_f32_bf16 v33, v53, v228, 0
    v_perm_b32 v54, v140, v128, s52
    v_perm_b32 v55, v140, v128, s53
    v_dot2_f32_bf16 v34, v54, v228, 0
    v_dot2_f32_bf16 v35, v55, v228, 0
    v_perm_b32 v48, v141, v129, s52
    v_perm_b32 v49, v141, v129, s53
    v_dot2_f32_bf16 v36, v48, v228, 0
    v_dot2_f32_bf16 v37, v49, v228, 0
    v_perm_b32 v50, v142, v130, s52
    v_perm_b32 v51, v142, v130, s53
    v_dot2_f32_bf16 v38, v50, v228, 0
    v_dot2_f32_bf16 v39, v51, v228, 0
    v_perm_b32 v52, v143, v131, s52
    v_perm_b32 v53, v143, v131, s53
    v_dot2_f32_bf16 v40, v52, v228, 0
    v_dot2_f32_bf16 v41, v53, v228, 0
    v_perm_b32 v54, v144, v132, s52
    v_perm_b32 v55, v144, v132, s53
    v_dot2_f32_bf16 v42, v54, v228, 0
    v_dot2_f32_bf16 v43, v55, v228, 0
    v_perm_b32 v48, v145, v133, s52
    v_perm_b32 v49, v145, v133, s53
    v_dot2_f32_bf16 v44, v48, v228, 0
    v_dot2_f32_bf16 v45, v49, v228, 0
    s_waitcnt lgkmcnt(12)
    v_perm_b32 v48, v161, v149, s52
    v_perm_b32 v49, v161, v149, s53
    v_dot2_f32_bf16 v28, v48, v229, v28
    v_dot2_f32_bf16 v29, v49, v229, v29
    v_perm_b32 v50, v162, v150, s52
    v_perm_b32 v51, v162, v150, s53
    v_dot2_f32_bf16 v30, v50, v229, v30
    v_dot2_f32_bf16 v31, v51, v229, v31
    v_perm_b32 v52, v163, v151, s52
    v_perm_b32 v53, v163, v151, s53
    v_dot2_f32_bf16 v32, v52, v229, v32
    v_dot2_f32_bf16 v33, v53, v229, v33
    v_perm_b32 v54, v164, v152, s52
    v_perm_b32 v55, v164, v152, s53
    v_dot2_f32_bf16 v34, v54, v229, v34
    v_dot2_f32_bf16 v35, v55, v229, v35
    v_perm_b32 v48, v165, v153, s52
    v_perm_b32 v49, v165, v153, s53
    v_dot2_f32_bf16 v36, v48, v229, v36
    v_dot2_f32_bf16 v37, v49, v229, v37
    v_perm_b32 v50, v166, v154, s52
    v_perm_b32 v51, v166, v154, s53
    v_dot2_f32_bf16 v38, v50, v229, v38
    v_dot2_f32_bf16 v39, v51, v229, v39
    v_perm_b32 v52, v167, v155, s52
    v_perm_b32 v53, v167, v155, s53
    v_dot2_f32_bf16 v40, v52, v229, v40
    v_dot2_f32_bf16 v41, v53, v229, v41
    v_perm_b32 v54, v168, v156, s52
    v_perm_b32 v55, v168, v156, s53
    v_dot2_f32_bf16 v42, v54, v229, v42
    v_dot2_f32_bf16 v43, v55, v229, v43
    v_perm_b32 v48, v169, v157, s52
    v_perm_b32 v49, v169, v157, s53
    v_dot2_f32_bf16 v44, v48, v229, v44
    v_dot2_f32_bf16 v45, v49, v229, v45
    s_waitcnt lgkmcnt(6)
    v_perm_b32 v48, v185, v173, s52
    v_perm_b32 v49, v185, v173, s53
    v_dot2_f32_bf16 v28, v48, v230, v28
    v_dot2_f32_bf16 v29, v49, v230, v29
    v_perm_b32 v50, v186, v174, s52
    v_perm_b32 v51, v186, v174, s53
    v_dot2_f32_bf16 v30, v50, v230, v30
    v_dot2_f32_bf16 v31, v51, v230, v31
    v_perm_b32 v52, v187, v175, s52
    v_perm_b32 v53, v187, v175, s53
    v_dot2_f32_bf16 v32, v52, v230, v32
    v_dot2_f32_bf16 v33, v53, v230, v33
    v_perm_b32 v54, v188, v176, s52
    v_perm_b32 v55, v188, v176, s53
    v_dot2_f32_bf16 v34, v54, v230, v34
    v_dot2_f32_bf16 v35, v55, v230, v35
    v_perm_b32 v48, v189, v177, s52
    v_perm_b32 v49, v189, v177, s53
    v_dot2_f32_bf16 v36, v48, v230, v36
    v_dot2_f32_bf16 v37, v49, v230, v37
    v_perm_b32 v50, v190, v178, s52
    v_perm_b32 v51, v190, v178, s53
    v_dot2_f32_bf16 v38, v50, v230, v38
    v_dot2_f32_bf16 v39, v51, v230, v39
    v_perm_b32 v52, v191, v179, s52
    v_perm_b32 v53, v191, v179, s53
    v_dot2_f32_bf16 v40, v52, v230, v40
    v_dot2_f32_bf16 v41, v53, v230, v41
    v_perm_b32 v54, v192, v180, s52
    v_perm_b32 v55, v192, v180, s53
    v_dot2_f32_bf16 v42, v54, v230, v42
    v_dot2_f32_bf16 v43, v55, v230, v43
    v_perm_b32 v48, v193, v181, s52
    v_perm_b32 v49, v193, v181, s53
    v_dot2_f32_bf16 v44, v48, v230, v44
    v_dot2_f32_bf16 v45, v49, v230, v45
    s_waitcnt lgkmcnt(0)
    v_perm_b32 v48, v209, v197, s52
    v_perm_b32 v49, v209, v197, s53
    v_dot2_f32_bf16 v28, v48, v231, v28
    v_dot2_f32_bf16 v29, v49, v231, v29
    v_perm_b32 v50, v210, v198, s52
    v_perm_b32 v51, v210, v198, s53
    v_dot2_f32_bf16 v30, v50, v231, v30
    v_dot2_f32_bf16 v31, v51, v231, v31
    v_perm_b32 v52, v211, v199, s52
    v_perm_b32 v53, v211, v199, s53
    v_dot2_f32_bf16 v32, v52, v231, v32
    v_dot2_f32_bf16 v33, v53, v231, v33
    v_perm_b32 v54, v212, v200, s52
    v_perm_b32 v55, v212, v200, s53
    v_dot2_f32_bf16 v34, v54, v231, v34
    v_dot2_f32_bf16 v35, v55, v231, v35
    v_perm_b32 v48, v213, v201, s52
    v_perm_b32 v49, v213, v201, s53
    v_dot2_f32_bf16 v36, v48, v231, v36
    v_dot2_f32_bf16 v37, v49, v231, v37
    v_perm_b32 v50, v214, v202, s52
    v_perm_b32 v51, v214, v202, s53
    v_dot2_f32_bf16 v38, v50, v231, v38
    v_dot2_f32_bf16 v39, v51, v231, v39
    v_perm_b32 v52, v215, v203, s52
    v_perm_b32 v53, v215, v203, s53
    v_dot2_f32_bf16 v40, v52, v231, v40
    v_dot2_f32_bf16 v41, v53, v231, v41
    v_perm_b32 v54, v216, v204, s52
    v_perm_b32 v55, v216, v204, s53
    v_dot2_f32_bf16 v42, v54, v231, v42
    v_dot2_f32_bf16 v43, v55, v231, v43
    v_perm_b32 v48, v217, v205, s52
    v_perm_b32 v49, v217, v205, s53
    v_dot2_f32_bf16 v44, v48, v231, v44
    v_dot2_f32_bf16 v45, v49, v231, v45
    s_nop 2
    v_cvt_pk_bf16_f32 v244, v28, v29
    v_cvt_pk_bf16_f32 v245, v30, v31
    v_cvt_pk_bf16_f32 v246, v32, v33
    v_cvt_pk_bf16_f32 v248, v34, v35
    v_cvt_pk_bf16_f32 v249, v36, v37
    v_cvt_pk_bf16_f32 v250, v38, v39
    v_cvt_pk_bf16_f32 v251, v40, v41
    v_cvt_pk_bf16_f32 v252, v42, v43
    v_cvt_pk_bf16_f32 v253, v44, v45
    buffer_store_dwordx3 v[244:246], v4, s[28:31], s45 offen offset:4 sc1
    buffer_store_dwordx4 v[248:251], v4, s[28:31], s46 offen offset:0 sc1
    buffer_store_dwordx2 v[252:253], v4, s[28:31], s47 offen offset:0 sc1
    s_branch L_k3adone_26
L_k3v2_24:
    v_mov_b32 v7, 0xce6e6b28
    s_barrier
    ds_read_b64 v[30:31], v8 offset:8
    ds_read_b128 v[32:35], v8 offset:1280
    ds_read_b128 v[36:39], v8 offset:2560
    ds_read_b64 v[42:43], v9 offset:8
    ds_read_b128 v[44:47], v9 offset:1280
    ds_read_b128 v[48:51], v9 offset:2560
    ds_read_b64 v[54:55], v10 offset:8
    ds_read_b128 v[56:59], v10 offset:1280
    ds_read_b128 v[60:63], v10 offset:2560
    ds_read_b64 v[66:67], v11 offset:8
    ds_read_b128 v[68:71], v11 offset:1280
    ds_read_b128 v[72:75], v11 offset:2560
    s_waitcnt vmcnt(0)
    ds_read_b64 v[78:79], v12 offset:8
    ds_read_b128 v[80:83], v12 offset:1280
    ds_read_b128 v[84:87], v12 offset:2560
    s_waitcnt lgkmcnt(12)
    v_dot2_f32_bf16 v220, v18, v30, 0
    v_dot2_f32_bf16 v220, v19, v31, v220
    v_dot2_f32_bf16 v220, v20, v32, v220
    v_dot2_f32_bf16 v220, v21, v33, v220
    v_dot2_f32_bf16 v220, v22, v34, v220
    v_dot2_f32_bf16 v220, v23, v35, v220
    v_dot2_f32_bf16 v220, v24, v36, v220
    v_dot2_f32_bf16 v220, v25, v37, v220
    v_dot2_f32_bf16 v220, v26, v38, v220
    ds_read_b64 v[90:91], v13 offset:8
    ds_read_b128 v[92:95], v13 offset:1280
    ds_read_b128 v[96:99], v13 offset:2560
    s_waitcnt lgkmcnt(12)
    v_dot2_f32_bf16 v221, v18, v42, 0
    v_dot2_f32_bf16 v221, v19, v43, v221
    v_dot2_f32_bf16 v221, v20, v44, v221
    v_dot2_f32_bf16 v221, v21, v45, v221
    v_dot2_f32_bf16 v221, v22, v46, v221
    v_dot2_f32_bf16 v221, v23, v47, v221
    v_dot2_f32_bf16 v221, v24, v48, v221
    v_dot2_f32_bf16 v221, v25, v49, v221
    v_dot2_f32_bf16 v221, v26, v50, v221
    ds_read_b64 v[102:103], v14 offset:8
    ds_read_b128 v[104:107], v14 offset:1280
    ds_read_b128 v[108:111], v14 offset:2560
    s_waitcnt lgkmcnt(12)
    v_dot2_f32_bf16 v222, v18, v54, 0
    v_dot2_f32_bf16 v222, v19, v55, v222
    v_dot2_f32_bf16 v222, v20, v56, v222
    v_dot2_f32_bf16 v222, v21, v57, v222
    v_dot2_f32_bf16 v222, v22, v58, v222
    v_dot2_f32_bf16 v222, v23, v59, v222
    v_dot2_f32_bf16 v222, v24, v60, v222
    v_dot2_f32_bf16 v222, v25, v61, v222
    v_dot2_f32_bf16 v222, v26, v62, v222
    ds_read_b64 v[114:115], v15 offset:8
    ds_read_b128 v[116:119], v15 offset:1280
    ds_read_b128 v[120:123], v15 offset:2560
    s_waitcnt lgkmcnt(12)
    v_dot2_f32_bf16 v223, v18, v66, 0
    v_dot2_f32_bf16 v223, v19, v67, v223
    v_dot2_f32_bf16 v223, v20, v68, v223
    v_dot2_f32_bf16 v223, v21, v69, v223
    v_dot2_f32_bf16 v223, v22, v70, v223
    v_dot2_f32_bf16 v223, v23, v71, v223
    v_dot2_f32_bf16 v223, v24, v72, v223
    v_dot2_f32_bf16 v223, v25, v73, v223
    v_dot2_f32_bf16 v223, v26, v74, v223
    ds_read_b64 v[126:127], v8 offset:11528
    ds_read_b128 v[128:131], v8 offset:12800
    ds_read_b128 v[132:135], v8 offset:14080
    s_waitcnt lgkmcnt(12)
    v_dot2_f32_bf16 v224, v18, v78, 0
    v_dot2_f32_bf16 v224, v19, v79, v224
    v_dot2_f32_bf16 v224, v20, v80, v224
    v_dot2_f32_bf16 v224, v21, v81, v224
    v_dot2_f32_bf16 v224, v22, v82, v224
    v_dot2_f32_bf16 v224, v23, v83, v224
    v_dot2_f32_bf16 v224, v24, v84, v224
    v_dot2_f32_bf16 v224, v25, v85, v224
    v_dot2_f32_bf16 v224, v26, v86, v224
    ds_read_b64 v[138:139], v9 offset:11528
    ds_read_b128 v[140:143], v9 offset:12800
    ds_read_b128 v[144:147], v9 offset:14080
    s_waitcnt lgkmcnt(12)
    v_dot2_f32_bf16 v225, v18, v90, 0
    v_dot2_f32_bf16 v225, v19, v91, v225
    v_dot2_f32_bf16 v225, v20, v92, v225
    v_dot2_f32_bf16 v225, v21, v93, v225
    v_dot2_f32_bf16 v225, v22, v94, v225
    v_dot2_f32_bf16 v225, v23, v95, v225
    v_dot2_f32_bf16 v225, v24, v96, v225
    v_dot2_f32_bf16 v225, v25, v97, v225
    v_dot2_f32_bf16 v225, v26, v98, v225
    ds_read_b64 v[150:151], v10 offset:11528
    ds_read_b128 v[152:155], v10 offset:12800
    ds_read_b128 v[156:159], v10 offset:14080
    s_waitcnt lgkmcnt(12)
    v_dot2_f32_bf16 v226, v18, v102, 0
    v_dot2_f32_bf16 v226, v19, v103, v226
    v_dot2_f32_bf16 v226, v20, v104, v226
    v_dot2_f32_bf16 v226, v21, v105, v226
    v_dot2_f32_bf16 v226, v22, v106, v226
    v_dot2_f32_bf16 v226, v23, v107, v226
    v_dot2_f32_bf16 v226, v24, v108, v226
    v_dot2_f32_bf16 v226, v25, v109, v226
    v_dot2_f32_bf16 v226, v26, v110, v226
    ds_read_b64 v[162:163], v11 offset:11528
    ds_read_b128 v[164:167], v11 offset:12800
    ds_read_b128 v[168:171], v11 offset:14080
    s_waitcnt lgkmcnt(12)
    v_dot2_f32_bf16 v227, v18, v114, 0
    v_dot2_f32_bf16 v227, v19, v115, v227
    v_dot2_f32_bf16 v227, v20, v116, v227
    v_dot2_f32_bf16 v227, v21, v117, v227
    v_dot2_f32_bf16 v227, v22, v118, v227
    v_dot2_f32_bf16 v227, v23, v119, v227
    v_dot2_f32_bf16 v227, v24, v120, v227
    v_dot2_f32_bf16 v227, v25, v121, v227
    v_dot2_f32_bf16 v227, v26, v122, v227
    ds_read_b64 v[174:175], v12 offset:11528
    ds_read_b128 v[176:179], v12 offset:12800
    ds_read_b128 v[180:183], v12 offset:14080
    ds_read_b64 v[186:187], v13 offset:11528
    ds_read_b128 v[188:191], v13 offset:12800
    ds_read_b128 v[192:195], v13 offset:14080
    ds_read_b64 v[198:199], v14 offset:11528
    ds_read_b128 v[200:203], v14 offset:12800
    ds_read_b128 v[204:207], v14 offset:14080
    ds_read_b64 v[210:211], v15 offset:11528
    ds_read_b128 v[212:215], v15 offset:12800
    ds_read_b128 v[216:219], v15 offset:14080
    v_cvt_pk_bf16_f32 v220, v220, v220
    v_cvt_pk_bf16_f32 v221, v221, v221
    v_cvt_pk_bf16_f32 v222, v222, v222
    v_cvt_pk_bf16_f32 v223, v223, v223
    v_cvt_pk_bf16_f32 v224, v224, v224
    v_cvt_pk_bf16_f32 v225, v225, v225
    v_cvt_pk_bf16_f32 v226, v226, v226
    v_cvt_pk_bf16_f32 v227, v227, v227
    v_lshlrev_b32 v220, 16, v220
    v_lshlrev_b32 v221, 16, v221
    v_lshlrev_b32 v222, 16, v222
    v_lshlrev_b32 v223, 16, v223
    v_lshlrev_b32 v224, 16, v224
    v_lshlrev_b32 v225, 16, v225
    v_lshlrev_b32 v226, 16, v226
    v_lshlrev_b32 v227, 16, v227
    v_mul_f32 v220, 0x3e715bef, v220
    v_mul_f32 v221, 0x3e715bef, v221
    v_mul_f32 v222, 0x3e715bef, v222
    v_mul_f32 v223, 0x3e715bef, v223
    v_mul_f32 v224, 0x3e715bef, v224
    v_mul_f32 v225, 0x3e715bef, v225
    v_mul_f32 v226, 0x3e715bef, v226
    v_mul_f32 v227, 0x3e715bef, v227
    v_cvt_pk_bf16_f32 v220, v220, v220
    v_cvt_pk_bf16_f32 v221, v221, v221
    v_cvt_pk_bf16_f32 v222, v222, v222
    v_cvt_pk_bf16_f32 v223, v223, v223
    v_cvt_pk_bf16_f32 v224, v224, v224
    v_cvt_pk_bf16_f32 v225, v225, v225
    v_cvt_pk_bf16_f32 v226, v226, v226
    v_cvt_pk_bf16_f32 v227, v227, v227
    v_lshlrev_b32 v220, 16, v220
    v_lshlrev_b32 v221, 16, v221
    v_lshlrev_b32 v222, 16, v222
    v_lshlrev_b32 v223, 16, v223
    v_lshlrev_b32 v224, 16, v224
    v_lshlrev_b32 v225, 16, v225
    v_lshlrev_b32 v226, 16, v226
    v_lshlrev_b32 v227, 16, v227
    v_cndmask_b32 v221, v7, v221, s[54:55]
    v_cndmask_b32 v222, v7, v222, s[56:57]
    v_cndmask_b32 v223, v7, v223, s[58:59]
    v_cndmask_b32 v224, v7, v224, s[60:61]
    v_cndmask_b32 v225, v7, v225, s[62:63]
    v_cndmask_b32 v226, v7, v226, s[64:65]
    v_cndmask_b32 v227, v7, v227, s[66:67]
    v_max3_f32 v5, v220, v221, v222
    v_max3_f32 v7, v223, v224, v225
    v_max3_f32 v5, v5, v226, v227
    v_max_f32 v5, v5, v7
    v_sub_f32 v220, v220, v5
    v_sub_f32 v221, v221, v5
    v_sub_f32 v222, v222, v5
    v_sub_f32 v223, v223, v5
    v_sub_f32 v224, v224, v5
    v_sub_f32 v225, v225, v5
    v_sub_f32 v226, v226, v5
    v_sub_f32 v227, v227, v5
    v_mul_f32 v220, 0x3fb8aa3b, v220
    v_mul_f32 v221, 0x3fb8aa3b, v221
    v_mul_f32 v222, 0x3fb8aa3b, v222
    v_mul_f32 v223, 0x3fb8aa3b, v223
    v_mul_f32 v224, 0x3fb8aa3b, v224
    v_mul_f32 v225, 0x3fb8aa3b, v225
    v_mul_f32 v226, 0x3fb8aa3b, v226
    v_mul_f32 v227, 0x3fb8aa3b, v227
    v_exp_f32 v220, v220
    v_exp_f32 v221, v221
    v_exp_f32 v222, v222
    v_exp_f32 v223, v223
    v_exp_f32 v224, v224
    v_exp_f32 v225, v225
    v_exp_f32 v226, v226
    v_exp_f32 v227, v227
    s_nop 0
    v_add_f32 v1, v220, v221
    v_add_f32 v7, v222, v223
    v_add_f32 v5, v224, v225
    v_add_f32 v3, v226, v227
    v_add_f32 v1, v1, v7
    v_add_f32 v5, v5, v3
    v_add_f32 v1, v1, v5
    v_rcp_f32 v1, v1
    s_nop 0

    v_mul_f32 v220, v220, v1
    v_mul_f32 v221, v221, v1
    v_mul_f32 v222, v222, v1
    v_mul_f32 v223, v223, v1
    v_mul_f32 v224, v224, v1
    v_mul_f32 v225, v225, v1
    v_mul_f32 v226, v226, v1
    v_mul_f32 v227, v227, v1
    v_cvt_pk_bf16_f32 v228, v220, v221
    v_cvt_pk_bf16_f32 v229, v222, v223
    v_cvt_pk_bf16_f32 v230, v224, v225
    v_cvt_pk_bf16_f32 v231, v226, v227
    s_waitcnt lgkmcnt(15)
    v_perm_b32 v48, v138, v126, s52
    v_perm_b32 v49, v138, v126, s53
    v_dot2_f32_bf16 v28, v48, v228, 0
    v_dot2_f32_bf16 v29, v49, v228, 0
    v_perm_b32 v50, v139, v127, s52
    v_perm_b32 v51, v139, v127, s53
    v_dot2_f32_bf16 v30, v50, v228, 0
    v_dot2_f32_bf16 v31, v51, v228, 0
    v_perm_b32 v52, v140, v128, s52
    v_perm_b32 v53, v140, v128, s53
    v_dot2_f32_bf16 v32, v52, v228, 0
    v_dot2_f32_bf16 v33, v53, v228, 0
    v_perm_b32 v54, v141, v129, s52
    v_perm_b32 v55, v141, v129, s53
    v_dot2_f32_bf16 v34, v54, v228, 0
    v_dot2_f32_bf16 v35, v55, v228, 0
    v_perm_b32 v48, v142, v130, s52
    v_perm_b32 v49, v142, v130, s53
    v_dot2_f32_bf16 v36, v48, v228, 0
    v_dot2_f32_bf16 v37, v49, v228, 0
    v_perm_b32 v50, v143, v131, s52
    v_perm_b32 v51, v143, v131, s53
    v_dot2_f32_bf16 v38, v50, v228, 0
    v_dot2_f32_bf16 v39, v51, v228, 0
    v_perm_b32 v52, v144, v132, s52
    v_perm_b32 v53, v144, v132, s53
    v_dot2_f32_bf16 v40, v52, v228, 0
    v_dot2_f32_bf16 v41, v53, v228, 0
    v_perm_b32 v54, v145, v133, s52
    v_perm_b32 v55, v145, v133, s53
    v_dot2_f32_bf16 v42, v54, v228, 0
    v_dot2_f32_bf16 v43, v55, v228, 0
    v_perm_b32 v48, v146, v134, s52
    v_perm_b32 v49, v146, v134, s53
    v_dot2_f32_bf16 v44, v48, v228, 0
    v_dot2_f32_bf16 v45, v49, v228, 0
    s_waitcnt lgkmcnt(12)
    v_perm_b32 v48, v162, v150, s52
    v_perm_b32 v49, v162, v150, s53
    v_dot2_f32_bf16 v28, v48, v229, v28
    v_dot2_f32_bf16 v29, v49, v229, v29
    v_perm_b32 v50, v163, v151, s52
    v_perm_b32 v51, v163, v151, s53
    v_dot2_f32_bf16 v30, v50, v229, v30
    v_dot2_f32_bf16 v31, v51, v229, v31
    v_perm_b32 v52, v164, v152, s52
    v_perm_b32 v53, v164, v152, s53
    v_dot2_f32_bf16 v32, v52, v229, v32
    v_dot2_f32_bf16 v33, v53, v229, v33
    v_perm_b32 v54, v165, v153, s52
    v_perm_b32 v55, v165, v153, s53
    v_dot2_f32_bf16 v34, v54, v229, v34
    v_dot2_f32_bf16 v35, v55, v229, v35
    v_perm_b32 v48, v166, v154, s52
    v_perm_b32 v49, v166, v154, s53
    v_dot2_f32_bf16 v36, v48, v229, v36
    v_dot2_f32_bf16 v37, v49, v229, v37
    v_perm_b32 v50, v167, v155, s52
    v_perm_b32 v51, v167, v155, s53
    v_dot2_f32_bf16 v38, v50, v229, v38
    v_dot2_f32_bf16 v39, v51, v229, v39
    v_perm_b32 v52, v168, v156, s52
    v_perm_b32 v53, v168, v156, s53
    v_dot2_f32_bf16 v40, v52, v229, v40
    v_dot2_f32_bf16 v41, v53, v229, v41
    v_perm_b32 v54, v169, v157, s52
    v_perm_b32 v55, v169, v157, s53
    v_dot2_f32_bf16 v42, v54, v229, v42
    v_dot2_f32_bf16 v43, v55, v229, v43
    v_perm_b32 v48, v170, v158, s52
    v_perm_b32 v49, v170, v158, s53
    v_dot2_f32_bf16 v44, v48, v229, v44
    v_dot2_f32_bf16 v45, v49, v229, v45
    s_waitcnt lgkmcnt(6)
    v_perm_b32 v48, v186, v174, s52
    v_perm_b32 v49, v186, v174, s53
    v_dot2_f32_bf16 v28, v48, v230, v28
    v_dot2_f32_bf16 v29, v49, v230, v29
    v_perm_b32 v50, v187, v175, s52
    v_perm_b32 v51, v187, v175, s53
    v_dot2_f32_bf16 v30, v50, v230, v30
    v_dot2_f32_bf16 v31, v51, v230, v31
    v_perm_b32 v52, v188, v176, s52
    v_perm_b32 v53, v188, v176, s53
    v_dot2_f32_bf16 v32, v52, v230, v32
    v_dot2_f32_bf16 v33, v53, v230, v33
    v_perm_b32 v54, v189, v177, s52
    v_perm_b32 v55, v189, v177, s53
    v_dot2_f32_bf16 v34, v54, v230, v34
    v_dot2_f32_bf16 v35, v55, v230, v35
    v_perm_b32 v48, v190, v178, s52
    v_perm_b32 v49, v190, v178, s53
    v_dot2_f32_bf16 v36, v48, v230, v36
    v_dot2_f32_bf16 v37, v49, v230, v37
    v_perm_b32 v50, v191, v179, s52
    v_perm_b32 v51, v191, v179, s53
    v_dot2_f32_bf16 v38, v50, v230, v38
    v_dot2_f32_bf16 v39, v51, v230, v39
    v_perm_b32 v52, v192, v180, s52
    v_perm_b32 v53, v192, v180, s53
    v_dot2_f32_bf16 v40, v52, v230, v40
    v_dot2_f32_bf16 v41, v53, v230, v41
    v_perm_b32 v54, v193, v181, s52
    v_perm_b32 v55, v193, v181, s53
    v_dot2_f32_bf16 v42, v54, v230, v42
    v_dot2_f32_bf16 v43, v55, v230, v43
    v_perm_b32 v48, v194, v182, s52
    v_perm_b32 v49, v194, v182, s53
    v_dot2_f32_bf16 v44, v48, v230, v44
    v_dot2_f32_bf16 v45, v49, v230, v45
    s_waitcnt lgkmcnt(0)
    v_perm_b32 v48, v210, v198, s52
    v_perm_b32 v49, v210, v198, s53
    v_dot2_f32_bf16 v28, v48, v231, v28
    v_dot2_f32_bf16 v29, v49, v231, v29
    v_perm_b32 v50, v211, v199, s52
    v_perm_b32 v51, v211, v199, s53
    v_dot2_f32_bf16 v30, v50, v231, v30
    v_dot2_f32_bf16 v31, v51, v231, v31
    v_perm_b32 v52, v212, v200, s52
    v_perm_b32 v53, v212, v200, s53
    v_dot2_f32_bf16 v32, v52, v231, v32
    v_dot2_f32_bf16 v33, v53, v231, v33
    v_perm_b32 v54, v213, v201, s52
    v_perm_b32 v55, v213, v201, s53
    v_dot2_f32_bf16 v34, v54, v231, v34
    v_dot2_f32_bf16 v35, v55, v231, v35
    v_perm_b32 v48, v214, v202, s52
    v_perm_b32 v49, v214, v202, s53
    v_dot2_f32_bf16 v36, v48, v231, v36
    v_dot2_f32_bf16 v37, v49, v231, v37
    v_perm_b32 v50, v215, v203, s52
    v_perm_b32 v51, v215, v203, s53
    v_dot2_f32_bf16 v38, v50, v231, v38
    v_dot2_f32_bf16 v39, v51, v231, v39
    v_perm_b32 v52, v216, v204, s52
    v_perm_b32 v53, v216, v204, s53
    v_dot2_f32_bf16 v40, v52, v231, v40
    v_dot2_f32_bf16 v41, v53, v231, v41
    v_perm_b32 v54, v217, v205, s52
    v_perm_b32 v55, v217, v205, s53
    v_dot2_f32_bf16 v42, v54, v231, v42
    v_dot2_f32_bf16 v43, v55, v231, v43
    v_perm_b32 v48, v218, v206, s52
    v_perm_b32 v49, v218, v206, s53
    v_dot2_f32_bf16 v44, v48, v231, v44
    v_dot2_f32_bf16 v45, v49, v231, v45
    s_nop 2
    v_cvt_pk_bf16_f32 v244, v28, v29
    v_cvt_pk_bf16_f32 v245, v30, v31
    v_cvt_pk_bf16_f32 v248, v32, v33
    v_cvt_pk_bf16_f32 v249, v34, v35
    v_cvt_pk_bf16_f32 v250, v36, v37
    v_cvt_pk_bf16_f32 v251, v38, v39
    v_cvt_pk_bf16_f32 v252, v40, v41
    v_cvt_pk_bf16_f32 v253, v42, v43
    v_cvt_pk_bf16_f32 v254, v44, v45
    buffer_store_dwordx2 v[244:245], v4, s[28:31], s45 offen offset:8 sc1
    buffer_store_dwordx4 v[248:251], v4, s[28:31], s46 offen offset:0 sc1
    buffer_store_dwordx3 v[252:254], v4, s[28:31], s47 offen offset:0 sc1
    s_branch L_k3adone_26
L_k3v3_25:
    v_mov_b32 v7, 0xce6e6b28
    s_barrier
    ds_read_b32 v31, v8 offset:12
    ds_read_b128 v[32:35], v8 offset:1280
    ds_read_b128 v[36:39], v8 offset:2560
    ds_read_b32 v43, v9 offset:12
    ds_read_b128 v[44:47], v9 offset:1280
    ds_read_b128 v[48:51], v9 offset:2560
    ds_read_b32 v55, v10 offset:12
    ds_read_b128 v[56:59], v10 offset:1280
    ds_read_b128 v[60:63], v10 offset:2560
    ds_read_b32 v67, v11 offset:12
    ds_read_b128 v[68:71], v11 offset:1280
    ds_read_b128 v[72:75], v11 offset:2560
    s_waitcnt vmcnt(0)
    ds_read_b32 v79, v12 offset:12
    ds_read_b128 v[80:83], v12 offset:1280
    ds_read_b128 v[84:87], v12 offset:2560
    s_waitcnt lgkmcnt(12)
    v_dot2_f32_bf16 v220, v19, v31, 0
    v_dot2_f32_bf16 v220, v20, v32, v220
    v_dot2_f32_bf16 v220, v21, v33, v220
    v_dot2_f32_bf16 v220, v22, v34, v220
    v_dot2_f32_bf16 v220, v23, v35, v220
    v_dot2_f32_bf16 v220, v24, v36, v220
    v_dot2_f32_bf16 v220, v25, v37, v220
    v_dot2_f32_bf16 v220, v26, v38, v220
    v_dot2_f32_bf16 v220, v27, v39, v220
    ds_read_b32 v91, v13 offset:12
    ds_read_b128 v[92:95], v13 offset:1280
    ds_read_b128 v[96:99], v13 offset:2560
    s_waitcnt lgkmcnt(12)
    v_dot2_f32_bf16 v221, v19, v43, 0
    v_dot2_f32_bf16 v221, v20, v44, v221
    v_dot2_f32_bf16 v221, v21, v45, v221
    v_dot2_f32_bf16 v221, v22, v46, v221
    v_dot2_f32_bf16 v221, v23, v47, v221
    v_dot2_f32_bf16 v221, v24, v48, v221
    v_dot2_f32_bf16 v221, v25, v49, v221
    v_dot2_f32_bf16 v221, v26, v50, v221
    v_dot2_f32_bf16 v221, v27, v51, v221
    ds_read_b32 v103, v14 offset:12
    ds_read_b128 v[104:107], v14 offset:1280
    ds_read_b128 v[108:111], v14 offset:2560
    s_waitcnt lgkmcnt(12)
    v_dot2_f32_bf16 v222, v19, v55, 0
    v_dot2_f32_bf16 v222, v20, v56, v222
    v_dot2_f32_bf16 v222, v21, v57, v222
    v_dot2_f32_bf16 v222, v22, v58, v222
    v_dot2_f32_bf16 v222, v23, v59, v222
    v_dot2_f32_bf16 v222, v24, v60, v222
    v_dot2_f32_bf16 v222, v25, v61, v222
    v_dot2_f32_bf16 v222, v26, v62, v222
    v_dot2_f32_bf16 v222, v27, v63, v222
    ds_read_b32 v115, v15 offset:12
    ds_read_b128 v[116:119], v15 offset:1280
    ds_read_b128 v[120:123], v15 offset:2560
    s_waitcnt lgkmcnt(12)
    v_dot2_f32_bf16 v223, v19, v67, 0
    v_dot2_f32_bf16 v223, v20, v68, v223
    v_dot2_f32_bf16 v223, v21, v69, v223
    v_dot2_f32_bf16 v223, v22, v70, v223
    v_dot2_f32_bf16 v223, v23, v71, v223
    v_dot2_f32_bf16 v223, v24, v72, v223
    v_dot2_f32_bf16 v223, v25, v73, v223
    v_dot2_f32_bf16 v223, v26, v74, v223
    v_dot2_f32_bf16 v223, v27, v75, v223
    ds_read_b32 v127, v8 offset:11532
    ds_read_b128 v[128:131], v8 offset:12800
    ds_read_b128 v[132:135], v8 offset:14080
    s_waitcnt lgkmcnt(12)
    v_dot2_f32_bf16 v224, v19, v79, 0
    v_dot2_f32_bf16 v224, v20, v80, v224
    v_dot2_f32_bf16 v224, v21, v81, v224
    v_dot2_f32_bf16 v224, v22, v82, v224
    v_dot2_f32_bf16 v224, v23, v83, v224
    v_dot2_f32_bf16 v224, v24, v84, v224
    v_dot2_f32_bf16 v224, v25, v85, v224
    v_dot2_f32_bf16 v224, v26, v86, v224
    v_dot2_f32_bf16 v224, v27, v87, v224
    ds_read_b32 v139, v9 offset:11532
    ds_read_b128 v[140:143], v9 offset:12800
    ds_read_b128 v[144:147], v9 offset:14080
    s_waitcnt lgkmcnt(12)
    v_dot2_f32_bf16 v225, v19, v91, 0
    v_dot2_f32_bf16 v225, v20, v92, v225
    v_dot2_f32_bf16 v225, v21, v93, v225
    v_dot2_f32_bf16 v225, v22, v94, v225
    v_dot2_f32_bf16 v225, v23, v95, v225
    v_dot2_f32_bf16 v225, v24, v96, v225
    v_dot2_f32_bf16 v225, v25, v97, v225
    v_dot2_f32_bf16 v225, v26, v98, v225
    v_dot2_f32_bf16 v225, v27, v99, v225
    ds_read_b32 v151, v10 offset:11532
    ds_read_b128 v[152:155], v10 offset:12800
    ds_read_b128 v[156:159], v10 offset:14080
    s_waitcnt lgkmcnt(12)
    v_dot2_f32_bf16 v226, v19, v103, 0
    v_dot2_f32_bf16 v226, v20, v104, v226
    v_dot2_f32_bf16 v226, v21, v105, v226
    v_dot2_f32_bf16 v226, v22, v106, v226
    v_dot2_f32_bf16 v226, v23, v107, v226
    v_dot2_f32_bf16 v226, v24, v108, v226
    v_dot2_f32_bf16 v226, v25, v109, v226
    v_dot2_f32_bf16 v226, v26, v110, v226
    v_dot2_f32_bf16 v226, v27, v111, v226
    ds_read_b32 v163, v11 offset:11532
    ds_read_b128 v[164:167], v11 offset:12800
    ds_read_b128 v[168:171], v11 offset:14080
    s_waitcnt lgkmcnt(12)
    v_dot2_f32_bf16 v227, v19, v115, 0
    v_dot2_f32_bf16 v227, v20, v116, v227
    v_dot2_f32_bf16 v227, v21, v117, v227
    v_dot2_f32_bf16 v227, v22, v118, v227
    v_dot2_f32_bf16 v227, v23, v119, v227
    v_dot2_f32_bf16 v227, v24, v120, v227
    v_dot2_f32_bf16 v227, v25, v121, v227
    v_dot2_f32_bf16 v227, v26, v122, v227
    v_dot2_f32_bf16 v227, v27, v123, v227
    ds_read_b32 v175, v12 offset:11532
    ds_read_b128 v[176:179], v12 offset:12800
    ds_read_b128 v[180:183], v12 offset:14080
    ds_read_b32 v187, v13 offset:11532
    ds_read_b128 v[188:191], v13 offset:12800
    ds_read_b128 v[192:195], v13 offset:14080
    ds_read_b32 v199, v14 offset:11532
    ds_read_b128 v[200:203], v14 offset:12800
    ds_read_b128 v[204:207], v14 offset:14080
    ds_read_b32 v211, v15 offset:11532
    ds_read_b128 v[212:215], v15 offset:12800
    ds_read_b128 v[216:219], v15 offset:14080
    v_cvt_pk_bf16_f32 v220, v220, v220
    v_cvt_pk_bf16_f32 v221, v221, v221
    v_cvt_pk_bf16_f32 v222, v222, v222
    v_cvt_pk_bf16_f32 v223, v223, v223
    v_cvt_pk_bf16_f32 v224, v224, v224
    v_cvt_pk_bf16_f32 v225, v225, v225
    v_cvt_pk_bf16_f32 v226, v226, v226
    v_cvt_pk_bf16_f32 v227, v227, v227
    v_lshlrev_b32 v220, 16, v220
    v_lshlrev_b32 v221, 16, v221
    v_lshlrev_b32 v222, 16, v222
    v_lshlrev_b32 v223, 16, v223
    v_lshlrev_b32 v224, 16, v224
    v_lshlrev_b32 v225, 16, v225
    v_lshlrev_b32 v226, 16, v226
    v_lshlrev_b32 v227, 16, v227
    v_mul_f32 v220, 0x3e715bef, v220
    v_mul_f32 v221, 0x3e715bef, v221
    v_mul_f32 v222, 0x3e715bef, v222
    v_mul_f32 v223, 0x3e715bef, v223
    v_mul_f32 v224, 0x3e715bef, v224
    v_mul_f32 v225, 0x3e715bef, v225
    v_mul_f32 v226, 0x3e715bef, v226
    v_mul_f32 v227, 0x3e715bef, v227
    v_cvt_pk_bf16_f32 v220, v220, v220
    v_cvt_pk_bf16_f32 v221, v221, v221
    v_cvt_pk_bf16_f32 v222, v222, v222
    v_cvt_pk_bf16_f32 v223, v223, v223
    v_cvt_pk_bf16_f32 v224, v224, v224
    v_cvt_pk_bf16_f32 v225, v225, v225
    v_cvt_pk_bf16_f32 v226, v226, v226
    v_cvt_pk_bf16_f32 v227, v227, v227
    v_lshlrev_b32 v220, 16, v220
    v_lshlrev_b32 v221, 16, v221
    v_lshlrev_b32 v222, 16, v222
    v_lshlrev_b32 v223, 16, v223
    v_lshlrev_b32 v224, 16, v224
    v_lshlrev_b32 v225, 16, v225
    v_lshlrev_b32 v226, 16, v226
    v_lshlrev_b32 v227, 16, v227
    v_cndmask_b32 v221, v7, v221, s[54:55]
    v_cndmask_b32 v222, v7, v222, s[56:57]
    v_cndmask_b32 v223, v7, v223, s[58:59]
    v_cndmask_b32 v224, v7, v224, s[60:61]
    v_cndmask_b32 v225, v7, v225, s[62:63]
    v_cndmask_b32 v226, v7, v226, s[64:65]
    v_cndmask_b32 v227, v7, v227, s[66:67]
    v_max3_f32 v5, v220, v221, v222
    v_max3_f32 v7, v223, v224, v225
    v_max3_f32 v5, v5, v226, v227
    v_max_f32 v5, v5, v7
    v_sub_f32 v220, v220, v5
    v_sub_f32 v221, v221, v5
    v_sub_f32 v222, v222, v5
    v_sub_f32 v223, v223, v5
    v_sub_f32 v224, v224, v5
    v_sub_f32 v225, v225, v5
    v_sub_f32 v226, v226, v5
    v_sub_f32 v227, v227, v5
    v_mul_f32 v220, 0x3fb8aa3b, v220
    v_mul_f32 v221, 0x3fb8aa3b, v221
    v_mul_f32 v222, 0x3fb8aa3b, v222
    v_mul_f32 v223, 0x3fb8aa3b, v223
    v_mul_f32 v224, 0x3fb8aa3b, v224
    v_mul_f32 v225, 0x3fb8aa3b, v225
    v_mul_f32 v226, 0x3fb8aa3b, v226
    v_mul_f32 v227, 0x3fb8aa3b, v227
    v_exp_f32 v220, v220
    v_exp_f32 v221, v221
    v_exp_f32 v222, v222
    v_exp_f32 v223, v223
    v_exp_f32 v224, v224
    v_exp_f32 v225, v225
    v_exp_f32 v226, v226
    v_exp_f32 v227, v227
    s_nop 0
    v_add_f32 v1, v220, v221
    v_add_f32 v7, v222, v223
    v_add_f32 v5, v224, v225
    v_add_f32 v3, v226, v227
    v_add_f32 v1, v1, v7
    v_add_f32 v5, v5, v3
    v_add_f32 v1, v1, v5
    v_rcp_f32 v1, v1
    s_nop 0

    v_mul_f32 v220, v220, v1
    v_mul_f32 v221, v221, v1
    v_mul_f32 v222, v222, v1
    v_mul_f32 v223, v223, v1
    v_mul_f32 v224, v224, v1
    v_mul_f32 v225, v225, v1
    v_mul_f32 v226, v226, v1
    v_mul_f32 v227, v227, v1
    v_cvt_pk_bf16_f32 v228, v220, v221
    v_cvt_pk_bf16_f32 v229, v222, v223
    v_cvt_pk_bf16_f32 v230, v224, v225
    v_cvt_pk_bf16_f32 v231, v226, v227
    s_waitcnt lgkmcnt(15)
    v_perm_b32 v48, v139, v127, s52
    v_perm_b32 v49, v139, v127, s53
    v_dot2_f32_bf16 v28, v48, v228, 0
    v_dot2_f32_bf16 v29, v49, v228, 0
    v_perm_b32 v50, v140, v128, s52
    v_perm_b32 v51, v140, v128, s53
    v_dot2_f32_bf16 v30, v50, v228, 0
    v_dot2_f32_bf16 v31, v51, v228, 0
    v_perm_b32 v52, v141, v129, s52
    v_perm_b32 v53, v141, v129, s53
    v_dot2_f32_bf16 v32, v52, v228, 0
    v_dot2_f32_bf16 v33, v53, v228, 0
    v_perm_b32 v54, v142, v130, s52
    v_perm_b32 v55, v142, v130, s53
    v_dot2_f32_bf16 v34, v54, v228, 0
    v_dot2_f32_bf16 v35, v55, v228, 0
    v_perm_b32 v48, v143, v131, s52
    v_perm_b32 v49, v143, v131, s53
    v_dot2_f32_bf16 v36, v48, v228, 0
    v_dot2_f32_bf16 v37, v49, v228, 0
    v_perm_b32 v50, v144, v132, s52
    v_perm_b32 v51, v144, v132, s53
    v_dot2_f32_bf16 v38, v50, v228, 0
    v_dot2_f32_bf16 v39, v51, v228, 0
    v_perm_b32 v52, v145, v133, s52
    v_perm_b32 v53, v145, v133, s53
    v_dot2_f32_bf16 v40, v52, v228, 0
    v_dot2_f32_bf16 v41, v53, v228, 0
    v_perm_b32 v54, v146, v134, s52
    v_perm_b32 v55, v146, v134, s53
    v_dot2_f32_bf16 v42, v54, v228, 0
    v_dot2_f32_bf16 v43, v55, v228, 0
    v_perm_b32 v48, v147, v135, s52
    v_perm_b32 v49, v147, v135, s53
    v_dot2_f32_bf16 v44, v48, v228, 0
    v_dot2_f32_bf16 v45, v49, v228, 0
    s_waitcnt lgkmcnt(12)
    v_perm_b32 v48, v163, v151, s52
    v_perm_b32 v49, v163, v151, s53
    v_dot2_f32_bf16 v28, v48, v229, v28
    v_dot2_f32_bf16 v29, v49, v229, v29
    v_perm_b32 v50, v164, v152, s52
    v_perm_b32 v51, v164, v152, s53
    v_dot2_f32_bf16 v30, v50, v229, v30
    v_dot2_f32_bf16 v31, v51, v229, v31
    v_perm_b32 v52, v165, v153, s52
    v_perm_b32 v53, v165, v153, s53
    v_dot2_f32_bf16 v32, v52, v229, v32
    v_dot2_f32_bf16 v33, v53, v229, v33
    v_perm_b32 v54, v166, v154, s52
    v_perm_b32 v55, v166, v154, s53
    v_dot2_f32_bf16 v34, v54, v229, v34
    v_dot2_f32_bf16 v35, v55, v229, v35
    v_perm_b32 v48, v167, v155, s52
    v_perm_b32 v49, v167, v155, s53
    v_dot2_f32_bf16 v36, v48, v229, v36
    v_dot2_f32_bf16 v37, v49, v229, v37
    v_perm_b32 v50, v168, v156, s52
    v_perm_b32 v51, v168, v156, s53
    v_dot2_f32_bf16 v38, v50, v229, v38
    v_dot2_f32_bf16 v39, v51, v229, v39
    v_perm_b32 v52, v169, v157, s52
    v_perm_b32 v53, v169, v157, s53
    v_dot2_f32_bf16 v40, v52, v229, v40
    v_dot2_f32_bf16 v41, v53, v229, v41
    v_perm_b32 v54, v170, v158, s52
    v_perm_b32 v55, v170, v158, s53
    v_dot2_f32_bf16 v42, v54, v229, v42
    v_dot2_f32_bf16 v43, v55, v229, v43
    v_perm_b32 v48, v171, v159, s52
    v_perm_b32 v49, v171, v159, s53
    v_dot2_f32_bf16 v44, v48, v229, v44
    v_dot2_f32_bf16 v45, v49, v229, v45
    s_waitcnt lgkmcnt(6)
    v_perm_b32 v48, v187, v175, s52
    v_perm_b32 v49, v187, v175, s53
    v_dot2_f32_bf16 v28, v48, v230, v28
    v_dot2_f32_bf16 v29, v49, v230, v29
    v_perm_b32 v50, v188, v176, s52
    v_perm_b32 v51, v188, v176, s53
    v_dot2_f32_bf16 v30, v50, v230, v30
    v_dot2_f32_bf16 v31, v51, v230, v31
    v_perm_b32 v52, v189, v177, s52
    v_perm_b32 v53, v189, v177, s53
    v_dot2_f32_bf16 v32, v52, v230, v32
    v_dot2_f32_bf16 v33, v53, v230, v33
    v_perm_b32 v54, v190, v178, s52
    v_perm_b32 v55, v190, v178, s53
    v_dot2_f32_bf16 v34, v54, v230, v34
    v_dot2_f32_bf16 v35, v55, v230, v35
    v_perm_b32 v48, v191, v179, s52
    v_perm_b32 v49, v191, v179, s53
    v_dot2_f32_bf16 v36, v48, v230, v36
    v_dot2_f32_bf16 v37, v49, v230, v37
    v_perm_b32 v50, v192, v180, s52
    v_perm_b32 v51, v192, v180, s53
    v_dot2_f32_bf16 v38, v50, v230, v38
    v_dot2_f32_bf16 v39, v51, v230, v39
    v_perm_b32 v52, v193, v181, s52
    v_perm_b32 v53, v193, v181, s53
    v_dot2_f32_bf16 v40, v52, v230, v40
    v_dot2_f32_bf16 v41, v53, v230, v41
    v_perm_b32 v54, v194, v182, s52
    v_perm_b32 v55, v194, v182, s53
    v_dot2_f32_bf16 v42, v54, v230, v42
    v_dot2_f32_bf16 v43, v55, v230, v43
    v_perm_b32 v48, v195, v183, s52
    v_perm_b32 v49, v195, v183, s53
    v_dot2_f32_bf16 v44, v48, v230, v44
    v_dot2_f32_bf16 v45, v49, v230, v45
    s_waitcnt lgkmcnt(0)
    v_perm_b32 v48, v211, v199, s52
    v_perm_b32 v49, v211, v199, s53
    v_dot2_f32_bf16 v28, v48, v231, v28
    v_dot2_f32_bf16 v29, v49, v231, v29
    v_perm_b32 v50, v212, v200, s52
    v_perm_b32 v51, v212, v200, s53
    v_dot2_f32_bf16 v30, v50, v231, v30
    v_dot2_f32_bf16 v31, v51, v231, v31
    v_perm_b32 v52, v213, v201, s52
    v_perm_b32 v53, v213, v201, s53
    v_dot2_f32_bf16 v32, v52, v231, v32
    v_dot2_f32_bf16 v33, v53, v231, v33
    v_perm_b32 v54, v214, v202, s52
    v_perm_b32 v55, v214, v202, s53
    v_dot2_f32_bf16 v34, v54, v231, v34
    v_dot2_f32_bf16 v35, v55, v231, v35
    v_perm_b32 v48, v215, v203, s52
    v_perm_b32 v49, v215, v203, s53
    v_dot2_f32_bf16 v36, v48, v231, v36
    v_dot2_f32_bf16 v37, v49, v231, v37
    v_perm_b32 v50, v216, v204, s52
    v_perm_b32 v51, v216, v204, s53
    v_dot2_f32_bf16 v38, v50, v231, v38
    v_dot2_f32_bf16 v39, v51, v231, v39
    v_perm_b32 v52, v217, v205, s52
    v_perm_b32 v53, v217, v205, s53
    v_dot2_f32_bf16 v40, v52, v231, v40
    v_dot2_f32_bf16 v41, v53, v231, v41
    v_perm_b32 v54, v218, v206, s52
    v_perm_b32 v55, v218, v206, s53
    v_dot2_f32_bf16 v42, v54, v231, v42
    v_dot2_f32_bf16 v43, v55, v231, v43
    v_perm_b32 v48, v219, v207, s52
    v_perm_b32 v49, v219, v207, s53
    v_dot2_f32_bf16 v44, v48, v231, v44
    v_dot2_f32_bf16 v45, v49, v231, v45
    s_nop 2
    v_cvt_pk_bf16_f32 v244, v28, v29
    v_cvt_pk_bf16_f32 v248, v30, v31
    v_cvt_pk_bf16_f32 v249, v32, v33
    v_cvt_pk_bf16_f32 v250, v34, v35
    v_cvt_pk_bf16_f32 v251, v36, v37
    v_cvt_pk_bf16_f32 v252, v38, v39
    v_cvt_pk_bf16_f32 v253, v40, v41
    v_cvt_pk_bf16_f32 v254, v42, v43
    v_cvt_pk_bf16_f32 v255, v44, v45
    buffer_store_dword v244, v4, s[28:31], s45 offen offset:12 sc1
    buffer_store_dwordx4 v[248:251], v4, s[28:31], s46 offen offset:0 sc1
    buffer_store_dwordx4 v[252:255], v4, s[28:31], s47 offen offset:0 sc1
L_k3adone_26:
    s_nop 1
    s_mov_b32 s16, s4
    s_and_b32 s17, s5, 0xffff
    s_mov_b32 s18, 2359296
    s_mov_b32 s19, 0x00020000
    s_mov_b32 s36, s10
    s_and_b32 s37, s11, 0xffff
    s_mov_b32 s38, 1152
    s_mov_b32 s39, 0x00020000
    s_mov_b32 s48, s14
    s_and_b32 s49, s15, 0xffff
    s_mov_b32 s50, 2359296
    s_mov_b32 s51, 0x00020000
    s_add_u32 s32, s12, 67108864
    s_addc_u32 s33, s13, 0
    s_and_b32 s33, s33, 0xffff
    s_mov_b32 s34, 20971520
    s_mov_b32 s35, 0x00020000
    s_setprio 1
    s_lshr_b32 s45, s3, 1
    s_and_b32 s46, s3, 1
    v_lshrrev_b32 v3, 4, v2
    v_and_b32 v4, 15, v2
    v_lshlrev_b32 v4, 4, v4
    v_lshl_add_u32 v5, v3, 11, v4
    s_lshl_b32 s47, s45, 10
    v_add_u32 v5, s47, v5
    s_lshl_b32 s47, s46, 8
    v_add_u32 v232, s47, v5
    s_xor_b32 s47, s47, 256
    v_add_u32 v235, s47, v5
    s_mul_i32 s47, s46, 5120
    s_add_u32 s47, s47, 8192
    v_add_u32 v238, s47, v6
    v_add_u32 v241, 12288, v6

    v_add_u32 v233, 52224, v232
    v_add_u32 v236, 52224, v235
    v_add_u32 v239, 52224, v238
    v_add_u32 v242, 52224, v241
    v_add_u32 v234, 104448, v232
    v_add_u32 v237, 104448, v235
    v_add_u32 v240, 104448, v238
    v_add_u32 v243, 104448, v241
    s_barrier
    ds_read_b128 v[88:91], v232 offset:0
    ds_read_b128 v[104:107], v238 offset:0
    ds_read_b128 v[92:95], v232 offset:512
    ds_read_b128 v[96:99], v235 offset:0
    ds_read_b128 v[100:103], v235 offset:512
    ds_read_b128 v[108:111], v238 offset:1024
    ds_read_b128 v[112:115], v238 offset:2048
    ds_read_b128 v[116:119], v238 offset:3072
    ds_read_b128 v[120:123], v241 offset:0
    s_waitcnt lgkmcnt(0)
    v_mfma_f32_16x16x32_bf16 v[16:19], v[104:107], v[88:91], 0
    v_mfma_f32_16x16x32_bf16 v[20:23], v[104:107], v[92:95], 0
    s_barrier
    ds_read_b128 v[124:127], v232 offset:17408
    v_mfma_f32_16x16x32_bf16 v[24:27], v[104:107], v[96:99], 0
    ds_read_b128 v[140:143], v238 offset:17408
    v_mfma_f32_16x16x32_bf16 v[28:31], v[104:107], v[100:103], 0
    ds_read_b128 v[128:131], v232 offset:17920
    v_mfma_f32_16x16x32_bf16 v[32:35], v[108:111], v[88:91], 0
    ds_read_b128 v[132:135], v235 offset:17408
    v_mfma_f32_16x16x32_bf16 v[36:39], v[108:111], v[92:95], 0
    ds_read_b128 v[136:139], v235 offset:17920
    v_mfma_f32_16x16x32_bf16 v[40:43], v[108:111], v[96:99], 0
    ds_read_b128 v[144:147], v238 offset:18432
    v_mfma_f32_16x16x32_bf16 v[44:47], v[108:111], v[100:103], 0
    ds_read_b128 v[148:151], v238 offset:19456
    v_mfma_f32_16x16x32_bf16 v[48:51], v[112:115], v[88:91], 0
    ds_read_b128 v[152:155], v238 offset:20480
    v_mfma_f32_16x16x32_bf16 v[52:55], v[112:115], v[92:95], 0
    ds_read_b128 v[156:159], v241 offset:17408
    v_mfma_f32_16x16x32_bf16 v[56:59], v[112:115], v[96:99], 0
    v_mfma_f32_16x16x32_bf16 v[60:63], v[112:115], v[100:103], 0
    v_mfma_f32_16x16x32_bf16 v[64:67], v[116:119], v[88:91], 0
    v_mfma_f32_16x16x32_bf16 v[68:71], v[116:119], v[92:95], 0
    v_mfma_f32_16x16x32_bf16 v[72:75], v[116:119], v[96:99], 0
    v_mfma_f32_16x16x32_bf16 v[76:79], v[116:119], v[100:103], 0
    v_mfma_f32_16x16x32_bf16 v[80:83], v[120:123], v[88:91], 0
    v_mfma_f32_16x16x32_bf16 v[84:87], v[120:123], v[92:95], 0
    s_waitcnt lgkmcnt(0)
    v_mfma_f32_16x16x32_bf16 v[16:19], v[140:143], v[124:127], v[16:19]
    v_mfma_f32_16x16x32_bf16 v[20:23], v[140:143], v[128:131], v[20:23]
    s_barrier
    ds_read_b128 v[88:91], v232 offset:34816
    v_mfma_f32_16x16x32_bf16 v[24:27], v[140:143], v[132:135], v[24:27]
    ds_read_b128 v[104:107], v238 offset:34816
    v_mfma_f32_16x16x32_bf16 v[28:31], v[140:143], v[136:139], v[28:31]
    ds_read_b128 v[92:95], v232 offset:35328
    v_mfma_f32_16x16x32_bf16 v[32:35], v[144:147], v[124:127], v[32:35]
    ds_read_b128 v[96:99], v235 offset:34816
    v_mfma_f32_16x16x32_bf16 v[36:39], v[144:147], v[128:131], v[36:39]
    ds_read_b128 v[100:103], v235 offset:35328
    v_mfma_f32_16x16x32_bf16 v[40:43], v[144:147], v[132:135], v[40:43]
    ds_read_b128 v[108:111], v238 offset:35840
    v_mfma_f32_16x16x32_bf16 v[44:47], v[144:147], v[136:139], v[44:47]
    ds_read_b128 v[112:115], v238 offset:36864
    v_mfma_f32_16x16x32_bf16 v[48:51], v[148:151], v[124:127], v[48:51]
    ds_read_b128 v[116:119], v238 offset:37888
    v_mfma_f32_16x16x32_bf16 v[52:55], v[148:151], v[128:131], v[52:55]
    ds_read_b128 v[120:123], v241 offset:34816
    v_mfma_f32_16x16x32_bf16 v[56:59], v[148:151], v[132:135], v[56:59]
    v_mfma_f32_16x16x32_bf16 v[60:63], v[148:151], v[136:139], v[60:63]
    v_mfma_f32_16x16x32_bf16 v[64:67], v[152:155], v[124:127], v[64:67]
    v_mfma_f32_16x16x32_bf16 v[68:71], v[152:155], v[128:131], v[68:71]
    v_mfma_f32_16x16x32_bf16 v[72:75], v[152:155], v[132:135], v[72:75]
    v_mfma_f32_16x16x32_bf16 v[76:79], v[152:155], v[136:139], v[76:79]
    v_mfma_f32_16x16x32_bf16 v[80:83], v[156:159], v[124:127], v[80:83]
    v_mfma_f32_16x16x32_bf16 v[84:87], v[156:159], v[128:131], v[84:87]
    s_waitcnt lgkmcnt(0)
    v_mfma_f32_16x16x32_bf16 v[16:19], v[104:107], v[88:91], v[16:19]
    v_mfma_f32_16x16x32_bf16 v[20:23], v[104:107], v[92:95], v[20:23]
    ds_read_b128 v[124:127], v233 offset:0
    v_mfma_f32_16x16x32_bf16 v[24:27], v[104:107], v[96:99], v[24:27]
    ds_read_b128 v[140:143], v239 offset:0
    v_mfma_f32_16x16x32_bf16 v[28:31], v[104:107], v[100:103], v[28:31]
    ds_read_b128 v[128:131], v233 offset:512
    v_mfma_f32_16x16x32_bf16 v[32:35], v[108:111], v[88:91], v[32:35]
    ds_read_b128 v[132:135], v236 offset:0
    v_mfma_f32_16x16x32_bf16 v[36:39], v[108:111], v[92:95], v[36:39]
    ds_read_b128 v[136:139], v236 offset:512
    v_mfma_f32_16x16x32_bf16 v[40:43], v[108:111], v[96:99], v[40:43]
    ds_read_b128 v[144:147], v239 offset:1024
    v_mfma_f32_16x16x32_bf16 v[44:47], v[108:111], v[100:103], v[44:47]
    ds_read_b128 v[148:151], v239 offset:2048
    v_mfma_f32_16x16x32_bf16 v[48:51], v[112:115], v[88:91], v[48:51]
    ds_read_b128 v[152:155], v239 offset:3072
    v_mfma_f32_16x16x32_bf16 v[52:55], v[112:115], v[92:95], v[52:55]
    ds_read_b128 v[156:159], v242 offset:0
    v_mfma_f32_16x16x32_bf16 v[56:59], v[112:115], v[96:99], v[56:59]
    v_mfma_f32_16x16x32_bf16 v[60:63], v[112:115], v[100:103], v[60:63]
    v_mfma_f32_16x16x32_bf16 v[64:67], v[116:119], v[88:91], v[64:67]
    v_mfma_f32_16x16x32_bf16 v[68:71], v[116:119], v[92:95], v[68:71]
    v_mfma_f32_16x16x32_bf16 v[72:75], v[116:119], v[96:99], v[72:75]
    v_mfma_f32_16x16x32_bf16 v[76:79], v[116:119], v[100:103], v[76:79]
    v_mfma_f32_16x16x32_bf16 v[80:83], v[120:123], v[88:91], v[80:83]
    v_mfma_f32_16x16x32_bf16 v[84:87], v[120:123], v[92:95], v[84:87]
    s_waitcnt lgkmcnt(0)
    v_mfma_f32_16x16x32_bf16 v[16:19], v[140:143], v[124:127], v[16:19]
    v_mfma_f32_16x16x32_bf16 v[20:23], v[140:143], v[128:131], v[20:23]
    s_barrier
    ds_read_b128 v[88:91], v233 offset:17408
    v_mfma_f32_16x16x32_bf16 v[24:27], v[140:143], v[132:135], v[24:27]
    ds_read_b128 v[104:107], v239 offset:17408
    v_mfma_f32_16x16x32_bf16 v[28:31], v[140:143], v[136:139], v[28:31]
    ds_read_b128 v[92:95], v233 offset:17920
    v_mfma_f32_16x16x32_bf16 v[32:35], v[144:147], v[124:127], v[32:35]
    ds_read_b128 v[96:99], v236 offset:17408
    v_mfma_f32_16x16x32_bf16 v[36:39], v[144:147], v[128:131], v[36:39]
    ds_read_b128 v[100:103], v236 offset:17920
    v_mfma_f32_16x16x32_bf16 v[40:43], v[144:147], v[132:135], v[40:43]
    ds_read_b128 v[108:111], v239 offset:18432
    v_mfma_f32_16x16x32_bf16 v[44:47], v[144:147], v[136:139], v[44:47]
    ds_read_b128 v[112:115], v239 offset:19456
    v_mfma_f32_16x16x32_bf16 v[48:51], v[148:151], v[124:127], v[48:51]
    ds_read_b128 v[116:119], v239 offset:20480
    v_mfma_f32_16x16x32_bf16 v[52:55], v[148:151], v[128:131], v[52:55]
    ds_read_b128 v[120:123], v242 offset:17408
    v_mfma_f32_16x16x32_bf16 v[56:59], v[148:151], v[132:135], v[56:59]
    v_mfma_f32_16x16x32_bf16 v[60:63], v[148:151], v[136:139], v[60:63]
    v_mfma_f32_16x16x32_bf16 v[64:67], v[152:155], v[124:127], v[64:67]
    v_mfma_f32_16x16x32_bf16 v[68:71], v[152:155], v[128:131], v[68:71]
    v_mfma_f32_16x16x32_bf16 v[72:75], v[152:155], v[132:135], v[72:75]
    v_mfma_f32_16x16x32_bf16 v[76:79], v[152:155], v[136:139], v[76:79]
    v_mfma_f32_16x16x32_bf16 v[80:83], v[156:159], v[124:127], v[80:83]
    v_mfma_f32_16x16x32_bf16 v[84:87], v[156:159], v[128:131], v[84:87]
    v_lshl_add_u32 v14, v3, 15, v4
    s_lshl_b32 s47, s43, 11
    s_lshl_b32 s54, s40, 10
    s_add_u32 s47, s47, s54
    s_lshl_b32 s54, s45, 9
    s_add_u32 s47, s47, s54
    s_mul_i32 s54, s46, 393216
    s_add_u32 s47, s47, s54
    v_add_u32 v14, s47, v14
    s_lshl_b32 s47, s41, 8
    s_xor_b32 s54, s47, 256
    v_add_u32 v15, s54, v14
    v_add_u32 v14, s47, v14
    s_mul_i32 s54, s46, 17408
    s_lshl_b32 s47, s41, 10
    s_add_u32 s47, s47, s54
    v_add_u32 v10, s47, v6
    s_xor_b32 s47, s41, 1
    s_lshl_b32 s47, s47, 12
    s_add_u32 s47, s47, s54
    v_add_u32 v11, s47, v6
    v_add_u32 v12, 69632, v10
    v_add_u32 v13, 69632, v11

    s_waitcnt lgkmcnt(0)
    v_mfma_f32_16x16x32_bf16 v[16:19], v[104:107], v[88:91], v[16:19]
    v_mfma_f32_16x16x32_bf16 v[20:23], v[104:107], v[92:95], v[20:23]
    ds_read_b128 v[124:127], v233 offset:34816
    v_mfma_f32_16x16x32_bf16 v[24:27], v[104:107], v[96:99], v[24:27]
    ds_read_b128 v[140:143], v239 offset:34816
    v_mfma_f32_16x16x32_bf16 v[28:31], v[104:107], v[100:103], v[28:31]
    ds_read_b128 v[128:131], v233 offset:35328
    v_mfma_f32_16x16x32_bf16 v[32:35], v[108:111], v[88:91], v[32:35]
    ds_read_b128 v[132:135], v236 offset:34816
    v_mfma_f32_16x16x32_bf16 v[36:39], v[108:111], v[92:95], v[36:39]
    ds_read_b128 v[136:139], v236 offset:35328
    v_mfma_f32_16x16x32_bf16 v[40:43], v[108:111], v[96:99], v[40:43]
    ds_read_b128 v[144:147], v239 offset:35840
    v_mfma_f32_16x16x32_bf16 v[44:47], v[108:111], v[100:103], v[44:47]
    ds_read_b128 v[148:151], v239 offset:36864
    v_mfma_f32_16x16x32_bf16 v[48:51], v[112:115], v[88:91], v[48:51]
    ds_read_b128 v[152:155], v239 offset:37888
    v_mfma_f32_16x16x32_bf16 v[52:55], v[112:115], v[92:95], v[52:55]
    ds_read_b128 v[156:159], v242 offset:34816
    v_mfma_f32_16x16x32_bf16 v[56:59], v[112:115], v[96:99], v[56:59]
    v_mfma_f32_16x16x32_bf16 v[60:63], v[112:115], v[100:103], v[60:63]
    v_mfma_f32_16x16x32_bf16 v[64:67], v[116:119], v[88:91], v[64:67]
    v_mfma_f32_16x16x32_bf16 v[68:71], v[116:119], v[92:95], v[68:71]
    v_mfma_f32_16x16x32_bf16 v[72:75], v[116:119], v[96:99], v[72:75]
    v_mfma_f32_16x16x32_bf16 v[76:79], v[116:119], v[100:103], v[76:79]
    v_mfma_f32_16x16x32_bf16 v[80:83], v[120:123], v[88:91], v[80:83]
    v_mfma_f32_16x16x32_bf16 v[84:87], v[120:123], v[92:95], v[84:87]
    s_waitcnt lgkmcnt(0)
    v_mfma_f32_16x16x32_bf16 v[16:19], v[140:143], v[124:127], v[16:19]
    v_mfma_f32_16x16x32_bf16 v[20:23], v[140:143], v[128:131], v[20:23]
    s_barrier
    ds_read_b128 v[88:91], v234 offset:0
    v_mfma_f32_16x16x32_bf16 v[24:27], v[140:143], v[132:135], v[24:27]
    ds_read_b128 v[104:107], v240 offset:0
    v_mfma_f32_16x16x32_bf16 v[28:31], v[140:143], v[136:139], v[28:31]
    ds_read_b128 v[92:95], v234 offset:512
    v_mfma_f32_16x16x32_bf16 v[32:35], v[144:147], v[124:127], v[32:35]
    ds_read_b128 v[96:99], v237 offset:0
    v_mfma_f32_16x16x32_bf16 v[36:39], v[144:147], v[128:131], v[36:39]
    ds_read_b128 v[100:103], v237 offset:512
    v_mfma_f32_16x16x32_bf16 v[40:43], v[144:147], v[132:135], v[40:43]
    ds_read_b128 v[108:111], v240 offset:1024
    v_mfma_f32_16x16x32_bf16 v[44:47], v[144:147], v[136:139], v[44:47]
    ds_read_b128 v[112:115], v240 offset:2048
    v_mfma_f32_16x16x32_bf16 v[48:51], v[148:151], v[124:127], v[48:51]
    ds_read_b128 v[116:119], v240 offset:3072
    v_mfma_f32_16x16x32_bf16 v[52:55], v[148:151], v[128:131], v[52:55]
    ds_read_b128 v[120:123], v243 offset:0
    v_mfma_f32_16x16x32_bf16 v[56:59], v[148:151], v[132:135], v[56:59]
    v_mfma_f32_16x16x32_bf16 v[60:63], v[148:151], v[136:139], v[60:63]
    v_mfma_f32_16x16x32_bf16 v[64:67], v[152:155], v[124:127], v[64:67]
    v_mfma_f32_16x16x32_bf16 v[68:71], v[152:155], v[128:131], v[68:71]
    v_mfma_f32_16x16x32_bf16 v[72:75], v[152:155], v[132:135], v[72:75]
    v_mfma_f32_16x16x32_bf16 v[76:79], v[152:155], v[136:139], v[76:79]
    v_mfma_f32_16x16x32_bf16 v[80:83], v[156:159], v[124:127], v[80:83]
    v_mfma_f32_16x16x32_bf16 v[84:87], v[156:159], v[128:131], v[84:87]
    v_and_b32 v7, 15, v2
    s_lshl_b32 s47, s43, 7
    s_lshl_b32 s54, s40, 6
    s_add_u32 s47, s47, s54
    s_lshl_b32 s54, s45, 5
    s_add_u32 s47, s47, s54
    s_xor_b32 s54, s41, s46
    s_lshl_b32 s54, s54, 4
    s_add_u32 s47, s47, s54
    v_add_u32 v7, s47, v7
    v_mul_u32_u24 v7, 1152, v7
    v_lshlrev_b32 v8, 3, v3
    s_mul_i32 s47, s44, 288
    v_add_u32 v8, s47, v8
    v_add_u32 v7, v7, v8
    s_mul_i32 s63, s41, 160
    s_mul_i32 s47, s45, 9216
    s_add_u32 s47, s47, 69632
    v_add_u32 v9, s47, v6
    s_lshl_b32 s47, s43, 2
    s_add_u32 s47, s47, s44
    s_lshl_b32 s47, s47, 2
    s_add_u32 s54, s47, s3
    s_mul_i32 s56, s54, 27648
    s_sub_u32 s54, s42, s3
    s_sub_u32 s54, s54, 1
    s_and_b32 s54, s54, 3
    s_mul_i32 s54, s54, 9216
    s_add_u32 s56, s56, s54
    s_add_u32 s54, s47, s42
    s_mul_i32 s57, s54, 27648
    s_lshl_b32 s54, s46, 1
    s_add_u32 s54, s54, s45
    s_min_u32 s47, s54, 2
    s_lshl_b32 s47, s47, 9
    s_add_u32 s57, s57, s47
    s_lshl_b32 s47, s54, 11
    s_mul_i32 s54, s54, 5120
    s_add_u32 s57, s57, s47
    s_add_u32 s54, s54, 34816
    v_add_u32 v5, s54, v6
    v_lshrrev_b32 v1, 1, v6

    s_waitcnt lgkmcnt(0)
    v_mfma_f32_16x16x32_bf16 v[16:19], v[104:107], v[88:91], v[16:19]
    v_mfma_f32_16x16x32_bf16 v[20:23], v[104:107], v[92:95], v[20:23]
    ds_read_b128 v[124:127], v234 offset:17408
    v_mfma_f32_16x16x32_bf16 v[24:27], v[104:107], v[96:99], v[24:27]
    ds_read_b128 v[140:143], v240 offset:17408
    v_mfma_f32_16x16x32_bf16 v[28:31], v[104:107], v[100:103], v[28:31]
    ds_read_b128 v[128:131], v234 offset:17920
    v_mfma_f32_16x16x32_bf16 v[32:35], v[108:111], v[88:91], v[32:35]
    ds_read_b128 v[132:135], v237 offset:17408
    v_mfma_f32_16x16x32_bf16 v[36:39], v[108:111], v[92:95], v[36:39]
    ds_read_b128 v[136:139], v237 offset:17920
    v_mfma_f32_16x16x32_bf16 v[40:43], v[108:111], v[96:99], v[40:43]
    ds_read_b128 v[144:147], v240 offset:18432
    v_mfma_f32_16x16x32_bf16 v[44:47], v[108:111], v[100:103], v[44:47]
    ds_read_b128 v[148:151], v240 offset:19456
    v_mfma_f32_16x16x32_bf16 v[48:51], v[112:115], v[88:91], v[48:51]
    ds_read_b128 v[152:155], v240 offset:20480
    v_mfma_f32_16x16x32_bf16 v[52:55], v[112:115], v[92:95], v[52:55]
    ds_read_b128 v[156:159], v243 offset:17408
    v_mfma_f32_16x16x32_bf16 v[56:59], v[112:115], v[96:99], v[56:59]
    v_mfma_f32_16x16x32_bf16 v[60:63], v[112:115], v[100:103], v[60:63]
    v_mfma_f32_16x16x32_bf16 v[64:67], v[116:119], v[88:91], v[64:67]
    v_mfma_f32_16x16x32_bf16 v[68:71], v[116:119], v[92:95], v[68:71]
    v_mfma_f32_16x16x32_bf16 v[72:75], v[116:119], v[96:99], v[72:75]
    v_mfma_f32_16x16x32_bf16 v[76:79], v[116:119], v[100:103], v[76:79]
    v_mfma_f32_16x16x32_bf16 v[80:83], v[120:123], v[88:91], v[80:83]
    v_mfma_f32_16x16x32_bf16 v[84:87], v[120:123], v[92:95], v[84:87]
    s_waitcnt lgkmcnt(0)
    v_mfma_f32_16x16x32_bf16 v[16:19], v[140:143], v[124:127], v[16:19]
    v_mfma_f32_16x16x32_bf16 v[20:23], v[140:143], v[128:131], v[20:23]
    s_barrier
    ds_read_b128 v[88:91], v232 offset:0
    v_mfma_f32_16x16x32_bf16 v[24:27], v[140:143], v[132:135], v[24:27]
    ds_read_b128 v[104:107], v238 offset:0
    v_mfma_f32_16x16x32_bf16 v[28:31], v[140:143], v[136:139], v[28:31]
    ds_read_b128 v[92:95], v232 offset:512
    v_mfma_f32_16x16x32_bf16 v[32:35], v[144:147], v[124:127], v[32:35]
    ds_read_b128 v[96:99], v235 offset:0
    v_mfma_f32_16x16x32_bf16 v[36:39], v[144:147], v[128:131], v[36:39]
    ds_read_b128 v[100:103], v235 offset:512
    v_mfma_f32_16x16x32_bf16 v[40:43], v[144:147], v[132:135], v[40:43]
    ds_read_b128 v[108:111], v238 offset:1024
    v_mfma_f32_16x16x32_bf16 v[44:47], v[144:147], v[136:139], v[44:47]
    ds_read_b128 v[112:115], v238 offset:2048
    v_mfma_f32_16x16x32_bf16 v[48:51], v[148:151], v[124:127], v[48:51]
    ds_read_b128 v[116:119], v238 offset:3072
    v_mfma_f32_16x16x32_bf16 v[52:55], v[148:151], v[128:131], v[52:55]
    ds_read_b128 v[120:123], v241 offset:0
    v_mfma_f32_16x16x32_bf16 v[56:59], v[148:151], v[132:135], v[56:59]
    v_mfma_f32_16x16x32_bf16 v[60:63], v[148:151], v[136:139], v[60:63]
    v_mfma_f32_16x16x32_bf16 v[64:67], v[152:155], v[124:127], v[64:67]
    v_mfma_f32_16x16x32_bf16 v[68:71], v[152:155], v[128:131], v[68:71]
    v_mfma_f32_16x16x32_bf16 v[72:75], v[152:155], v[132:135], v[72:75]
    v_mfma_f32_16x16x32_bf16 v[76:79], v[152:155], v[136:139], v[76:79]
    v_mfma_f32_16x16x32_bf16 v[80:83], v[156:159], v[124:127], v[80:83]
    v_mfma_f32_16x16x32_bf16 v[84:87], v[156:159], v[128:131], v[84:87]
    s_lshl_b32 s47, s43, 1
    s_add_u32 s47, s47, s40
    s_lshl_b32 s47, s47, 7
    s_add_u32 s52, s12, 104861696
    s_addc_u32 s53, s13, 0
    s_add_u32 s52, s52, s47
    s_addc_u32 s53, s53, 0
    s_lshl_b32 s47, s41, 2
    s_add_u32 s47, s47, s44
    s_lshl_b32 s47, s47, 2
    s_add_u32 s47, s47, s3
    s_lshl_b32 s47, s47, 2
    s_waitcnt vmcnt(0)
    v_mov_b32 v244, s47
    v_mov_b32 v245, 1
    v_and_b32 v246, 31, v2
    v_lshlrev_b32 v246, 2, v246
    global_store_dword v244, v245, s[52:53] sc1

    s_waitcnt lgkmcnt(0)
    v_mfma_f32_16x16x32_bf16 v[16:19], v[104:107], v[88:91], v[16:19]
    v_mfma_f32_16x16x32_bf16 v[20:23], v[104:107], v[92:95], v[20:23]
    ds_read_b128 v[124:127], v232 offset:17408
    v_mfma_f32_16x16x32_bf16 v[24:27], v[104:107], v[96:99], v[24:27]
    ds_read_b128 v[140:143], v238 offset:17408
    v_mfma_f32_16x16x32_bf16 v[28:31], v[104:107], v[100:103], v[28:31]
    ds_read_b128 v[128:131], v232 offset:17920
    v_mfma_f32_16x16x32_bf16 v[32:35], v[108:111], v[88:91], v[32:35]
    ds_read_b128 v[132:135], v235 offset:17408
    v_mfma_f32_16x16x32_bf16 v[36:39], v[108:111], v[92:95], v[36:39]
    ds_read_b128 v[136:139], v235 offset:17920
    v_mfma_f32_16x16x32_bf16 v[40:43], v[108:111], v[96:99], v[40:43]
    ds_read_b128 v[144:147], v238 offset:18432
    v_mfma_f32_16x16x32_bf16 v[44:47], v[108:111], v[100:103], v[44:47]
    ds_read_b128 v[148:151], v238 offset:19456
    v_mfma_f32_16x16x32_bf16 v[48:51], v[112:115], v[88:91], v[48:51]
    ds_read_b128 v[152:155], v238 offset:20480
    v_mfma_f32_16x16x32_bf16 v[52:55], v[112:115], v[92:95], v[52:55]
    ds_read_b128 v[156:159], v241 offset:17408
    v_mfma_f32_16x16x32_bf16 v[56:59], v[112:115], v[96:99], v[56:59]
    v_mfma_f32_16x16x32_bf16 v[60:63], v[112:115], v[100:103], v[60:63]
    v_mfma_f32_16x16x32_bf16 v[64:67], v[116:119], v[88:91], v[64:67]
    v_mfma_f32_16x16x32_bf16 v[68:71], v[116:119], v[92:95], v[68:71]
    v_mfma_f32_16x16x32_bf16 v[72:75], v[116:119], v[96:99], v[72:75]
    v_mfma_f32_16x16x32_bf16 v[76:79], v[116:119], v[100:103], v[76:79]
    v_mfma_f32_16x16x32_bf16 v[80:83], v[120:123], v[88:91], v[80:83]
    v_mfma_f32_16x16x32_bf16 v[84:87], v[120:123], v[92:95], v[84:87]
    s_waitcnt lgkmcnt(0)
    v_mfma_f32_16x16x32_bf16 v[16:19], v[140:143], v[124:127], v[16:19]
    v_mfma_f32_16x16x32_bf16 v[20:23], v[140:143], v[128:131], v[20:23]
    s_barrier
    ds_read_b128 v[88:91], v232 offset:34816
    v_mfma_f32_16x16x32_bf16 v[24:27], v[140:143], v[132:135], v[24:27]
    ds_read_b128 v[104:107], v238 offset:34816
    v_mfma_f32_16x16x32_bf16 v[28:31], v[140:143], v[136:139], v[28:31]
    ds_read_b128 v[92:95], v232 offset:35328
    v_mfma_f32_16x16x32_bf16 v[32:35], v[144:147], v[124:127], v[32:35]
    ds_read_b128 v[96:99], v235 offset:34816
    v_mfma_f32_16x16x32_bf16 v[36:39], v[144:147], v[128:131], v[36:39]
    ds_read_b128 v[100:103], v235 offset:35328
    v_mfma_f32_16x16x32_bf16 v[40:43], v[144:147], v[132:135], v[40:43]
    ds_read_b128 v[108:111], v238 offset:35840
    v_mfma_f32_16x16x32_bf16 v[44:47], v[144:147], v[136:139], v[44:47]
    ds_read_b128 v[112:115], v238 offset:36864
    v_mfma_f32_16x16x32_bf16 v[48:51], v[148:151], v[124:127], v[48:51]
    ds_read_b128 v[116:119], v238 offset:37888
    v_mfma_f32_16x16x32_bf16 v[52:55], v[148:151], v[128:131], v[52:55]
    ds_read_b128 v[120:123], v241 offset:34816
    v_mfma_f32_16x16x32_bf16 v[56:59], v[148:151], v[132:135], v[56:59]
    v_mfma_f32_16x16x32_bf16 v[60:63], v[148:151], v[136:139], v[60:63]
    v_mfma_f32_16x16x32_bf16 v[64:67], v[152:155], v[124:127], v[64:67]
    v_mfma_f32_16x16x32_bf16 v[68:71], v[152:155], v[128:131], v[68:71]
    v_mfma_f32_16x16x32_bf16 v[72:75], v[152:155], v[132:135], v[72:75]
    v_mfma_f32_16x16x32_bf16 v[76:79], v[152:155], v[136:139], v[76:79]
    v_mfma_f32_16x16x32_bf16 v[80:83], v[156:159], v[124:127], v[80:83]
    v_mfma_f32_16x16x32_bf16 v[84:87], v[156:159], v[128:131], v[84:87]
    s_waitcnt lgkmcnt(0)
    v_mfma_f32_16x16x32_bf16 v[16:19], v[104:107], v[88:91], v[16:19]
    v_mfma_f32_16x16x32_bf16 v[20:23], v[104:107], v[92:95], v[20:23]
    ds_read_b128 v[124:127], v233 offset:0
    v_mfma_f32_16x16x32_bf16 v[24:27], v[104:107], v[96:99], v[24:27]
    ds_read_b128 v[140:143], v239 offset:0
    v_mfma_f32_16x16x32_bf16 v[28:31], v[104:107], v[100:103], v[28:31]
    ds_read_b128 v[128:131], v233 offset:512
    v_mfma_f32_16x16x32_bf16 v[32:35], v[108:111], v[88:91], v[32:35]
    ds_read_b128 v[132:135], v236 offset:0
    v_mfma_f32_16x16x32_bf16 v[36:39], v[108:111], v[92:95], v[36:39]
    ds_read_b128 v[136:139], v236 offset:512
    v_mfma_f32_16x16x32_bf16 v[40:43], v[108:111], v[96:99], v[40:43]
    ds_read_b128 v[144:147], v239 offset:1024
    v_mfma_f32_16x16x32_bf16 v[44:47], v[108:111], v[100:103], v[44:47]
    ds_read_b128 v[148:151], v239 offset:2048
    v_mfma_f32_16x16x32_bf16 v[48:51], v[112:115], v[88:91], v[48:51]
    ds_read_b128 v[152:155], v239 offset:3072
    v_mfma_f32_16x16x32_bf16 v[52:55], v[112:115], v[92:95], v[52:55]
    ds_read_b128 v[156:159], v242 offset:0
    v_mfma_f32_16x16x32_bf16 v[56:59], v[112:115], v[96:99], v[56:59]
    v_mfma_f32_16x16x32_bf16 v[60:63], v[112:115], v[100:103], v[60:63]
    v_mfma_f32_16x16x32_bf16 v[64:67], v[116:119], v[88:91], v[64:67]
    v_mfma_f32_16x16x32_bf16 v[68:71], v[116:119], v[92:95], v[68:71]
    v_mfma_f32_16x16x32_bf16 v[72:75], v[116:119], v[96:99], v[72:75]
    v_mfma_f32_16x16x32_bf16 v[76:79], v[116:119], v[100:103], v[76:79]
    v_mfma_f32_16x16x32_bf16 v[80:83], v[120:123], v[88:91], v[80:83]
    v_mfma_f32_16x16x32_bf16 v[84:87], v[120:123], v[92:95], v[84:87]
    s_waitcnt lgkmcnt(0)
    v_mfma_f32_16x16x32_bf16 v[16:19], v[140:143], v[124:127], v[16:19]
    v_mfma_f32_16x16x32_bf16 v[20:23], v[140:143], v[128:131], v[20:23]
    s_barrier
    ds_read_b128 v[88:91], v233 offset:17408
    v_mfma_f32_16x16x32_bf16 v[24:27], v[140:143], v[132:135], v[24:27]
    ds_read_b128 v[104:107], v239 offset:17408
    v_mfma_f32_16x16x32_bf16 v[28:31], v[140:143], v[136:139], v[28:31]
    ds_read_b128 v[92:95], v233 offset:17920
    v_mfma_f32_16x16x32_bf16 v[32:35], v[144:147], v[124:127], v[32:35]
    ds_read_b128 v[96:99], v236 offset:17408
    v_mfma_f32_16x16x32_bf16 v[36:39], v[144:147], v[128:131], v[36:39]
    ds_read_b128 v[100:103], v236 offset:17920
    v_mfma_f32_16x16x32_bf16 v[40:43], v[144:147], v[132:135], v[40:43]
    ds_read_b128 v[108:111], v239 offset:18432
    v_mfma_f32_16x16x32_bf16 v[44:47], v[144:147], v[136:139], v[44:47]
    ds_read_b128 v[112:115], v239 offset:19456
    v_mfma_f32_16x16x32_bf16 v[48:51], v[148:151], v[124:127], v[48:51]
    ds_read_b128 v[116:119], v239 offset:20480
    v_mfma_f32_16x16x32_bf16 v[52:55], v[148:151], v[128:131], v[52:55]
    ds_read_b128 v[120:123], v242 offset:17408
    v_mfma_f32_16x16x32_bf16 v[56:59], v[148:151], v[132:135], v[56:59]
    v_mfma_f32_16x16x32_bf16 v[60:63], v[148:151], v[136:139], v[60:63]
    v_mfma_f32_16x16x32_bf16 v[64:67], v[152:155], v[124:127], v[64:67]
    v_mfma_f32_16x16x32_bf16 v[68:71], v[152:155], v[128:131], v[68:71]
    v_mfma_f32_16x16x32_bf16 v[72:75], v[152:155], v[132:135], v[72:75]
    v_mfma_f32_16x16x32_bf16 v[76:79], v[152:155], v[136:139], v[76:79]
    v_mfma_f32_16x16x32_bf16 v[80:83], v[156:159], v[124:127], v[80:83]
    v_mfma_f32_16x16x32_bf16 v[84:87], v[156:159], v[128:131], v[84:87]
    s_waitcnt lgkmcnt(0)
    v_mfma_f32_16x16x32_bf16 v[16:19], v[104:107], v[88:91], v[16:19]
    v_mfma_f32_16x16x32_bf16 v[20:23], v[104:107], v[92:95], v[20:23]
    ds_read_b128 v[124:127], v233 offset:34816
    v_mfma_f32_16x16x32_bf16 v[24:27], v[104:107], v[96:99], v[24:27]
    ds_read_b128 v[140:143], v239 offset:34816
    v_mfma_f32_16x16x32_bf16 v[28:31], v[104:107], v[100:103], v[28:31]
    ds_read_b128 v[128:131], v233 offset:35328
    v_mfma_f32_16x16x32_bf16 v[32:35], v[108:111], v[88:91], v[32:35]
    ds_read_b128 v[132:135], v236 offset:34816
    v_mfma_f32_16x16x32_bf16 v[36:39], v[108:111], v[92:95], v[36:39]
    ds_read_b128 v[136:139], v236 offset:35328
    v_mfma_f32_16x16x32_bf16 v[40:43], v[108:111], v[96:99], v[40:43]
    ds_read_b128 v[144:147], v239 offset:35840
    v_mfma_f32_16x16x32_bf16 v[44:47], v[108:111], v[100:103], v[44:47]
    ds_read_b128 v[148:151], v239 offset:36864
    v_mfma_f32_16x16x32_bf16 v[48:51], v[112:115], v[88:91], v[48:51]
    ds_read_b128 v[152:155], v239 offset:37888
    v_mfma_f32_16x16x32_bf16 v[52:55], v[112:115], v[92:95], v[52:55]
    ds_read_b128 v[156:159], v242 offset:34816
    v_mfma_f32_16x16x32_bf16 v[56:59], v[112:115], v[96:99], v[56:59]
    v_mfma_f32_16x16x32_bf16 v[60:63], v[112:115], v[100:103], v[60:63]
    v_mfma_f32_16x16x32_bf16 v[64:67], v[116:119], v[88:91], v[64:67]
    v_mfma_f32_16x16x32_bf16 v[68:71], v[116:119], v[92:95], v[68:71]
    v_mfma_f32_16x16x32_bf16 v[72:75], v[116:119], v[96:99], v[72:75]
    v_mfma_f32_16x16x32_bf16 v[76:79], v[116:119], v[100:103], v[76:79]
    v_mfma_f32_16x16x32_bf16 v[80:83], v[120:123], v[88:91], v[80:83]
    v_mfma_f32_16x16x32_bf16 v[84:87], v[120:123], v[92:95], v[84:87]
    s_waitcnt lgkmcnt(0)
    v_mfma_f32_16x16x32_bf16 v[16:19], v[140:143], v[124:127], v[16:19]
    v_mfma_f32_16x16x32_bf16 v[20:23], v[140:143], v[128:131], v[20:23]
    s_barrier
    ds_read_b128 v[88:91], v234 offset:0
    v_mfma_f32_16x16x32_bf16 v[24:27], v[140:143], v[132:135], v[24:27]
    ds_read_b128 v[104:107], v240 offset:0
    v_mfma_f32_16x16x32_bf16 v[28:31], v[140:143], v[136:139], v[28:31]
    ds_read_b128 v[92:95], v234 offset:512
    v_mfma_f32_16x16x32_bf16 v[32:35], v[144:147], v[124:127], v[32:35]
    ds_read_b128 v[96:99], v237 offset:0
    v_mfma_f32_16x16x32_bf16 v[36:39], v[144:147], v[128:131], v[36:39]
    ds_read_b128 v[100:103], v237 offset:512
    v_mfma_f32_16x16x32_bf16 v[40:43], v[144:147], v[132:135], v[40:43]
    ds_read_b128 v[108:111], v240 offset:1024
    v_mfma_f32_16x16x32_bf16 v[44:47], v[144:147], v[136:139], v[44:47]
    ds_read_b128 v[112:115], v240 offset:2048
    v_mfma_f32_16x16x32_bf16 v[48:51], v[148:151], v[124:127], v[48:51]
    ds_read_b128 v[116:119], v240 offset:3072
    v_mfma_f32_16x16x32_bf16 v[52:55], v[148:151], v[128:131], v[52:55]
    ds_read_b128 v[120:123], v243 offset:0
    v_mfma_f32_16x16x32_bf16 v[56:59], v[148:151], v[132:135], v[56:59]
    v_mfma_f32_16x16x32_bf16 v[60:63], v[148:151], v[136:139], v[60:63]
    v_mfma_f32_16x16x32_bf16 v[64:67], v[152:155], v[124:127], v[64:67]
    v_mfma_f32_16x16x32_bf16 v[68:71], v[152:155], v[128:131], v[68:71]
    v_mfma_f32_16x16x32_bf16 v[72:75], v[152:155], v[132:135], v[72:75]
    v_mfma_f32_16x16x32_bf16 v[76:79], v[152:155], v[136:139], v[76:79]
    v_mfma_f32_16x16x32_bf16 v[80:83], v[156:159], v[124:127], v[80:83]
    v_mfma_f32_16x16x32_bf16 v[84:87], v[156:159], v[128:131], v[84:87]
    s_waitcnt lgkmcnt(0)
    v_mfma_f32_16x16x32_bf16 v[16:19], v[104:107], v[88:91], v[16:19]
    v_mfma_f32_16x16x32_bf16 v[20:23], v[104:107], v[92:95], v[20:23]
    ds_read_b128 v[124:127], v234 offset:17408
    v_mfma_f32_16x16x32_bf16 v[24:27], v[104:107], v[96:99], v[24:27]
    ds_read_b128 v[140:143], v240 offset:17408
    v_mfma_f32_16x16x32_bf16 v[28:31], v[104:107], v[100:103], v[28:31]
    ds_read_b128 v[128:131], v234 offset:17920
    v_mfma_f32_16x16x32_bf16 v[32:35], v[108:111], v[88:91], v[32:35]
    ds_read_b128 v[132:135], v237 offset:17408
    v_mfma_f32_16x16x32_bf16 v[36:39], v[108:111], v[92:95], v[36:39]
    ds_read_b128 v[136:139], v237 offset:17920
    v_mfma_f32_16x16x32_bf16 v[40:43], v[108:111], v[96:99], v[40:43]
    ds_read_b128 v[144:147], v240 offset:18432
    v_mfma_f32_16x16x32_bf16 v[44:47], v[108:111], v[100:103], v[44:47]
    ds_read_b128 v[148:151], v240 offset:19456
    v_mfma_f32_16x16x32_bf16 v[48:51], v[112:115], v[88:91], v[48:51]
    ds_read_b128 v[152:155], v240 offset:20480
    v_mfma_f32_16x16x32_bf16 v[52:55], v[112:115], v[92:95], v[52:55]
    ds_read_b128 v[156:159], v243 offset:17408
    v_mfma_f32_16x16x32_bf16 v[56:59], v[112:115], v[96:99], v[56:59]
    v_mfma_f32_16x16x32_bf16 v[60:63], v[112:115], v[100:103], v[60:63]
    v_mfma_f32_16x16x32_bf16 v[64:67], v[116:119], v[88:91], v[64:67]
    v_mfma_f32_16x16x32_bf16 v[68:71], v[116:119], v[92:95], v[68:71]
    v_mfma_f32_16x16x32_bf16 v[72:75], v[116:119], v[96:99], v[72:75]
    v_mfma_f32_16x16x32_bf16 v[76:79], v[116:119], v[100:103], v[76:79]
    v_mfma_f32_16x16x32_bf16 v[80:83], v[120:123], v[88:91], v[80:83]
    v_mfma_f32_16x16x32_bf16 v[84:87], v[120:123], v[92:95], v[84:87]
    s_waitcnt lgkmcnt(0)
    v_mfma_f32_16x16x32_bf16 v[16:19], v[140:143], v[124:127], v[16:19]
    v_mfma_f32_16x16x32_bf16 v[20:23], v[140:143], v[128:131], v[20:23]
    s_barrier
    ds_read_b128 v[88:91], v232 offset:0
    v_mfma_f32_16x16x32_bf16 v[24:27], v[140:143], v[132:135], v[24:27]
    ds_read_b128 v[104:107], v238 offset:0
    v_mfma_f32_16x16x32_bf16 v[28:31], v[140:143], v[136:139], v[28:31]
    ds_read_b128 v[92:95], v232 offset:512
    v_mfma_f32_16x16x32_bf16 v[32:35], v[144:147], v[124:127], v[32:35]
    ds_read_b128 v[96:99], v235 offset:0
    v_mfma_f32_16x16x32_bf16 v[36:39], v[144:147], v[128:131], v[36:39]
    ds_read_b128 v[100:103], v235 offset:512
    v_mfma_f32_16x16x32_bf16 v[40:43], v[144:147], v[132:135], v[40:43]
    ds_read_b128 v[108:111], v238 offset:1024
    v_mfma_f32_16x16x32_bf16 v[44:47], v[144:147], v[136:139], v[44:47]
    ds_read_b128 v[112:115], v238 offset:2048
    v_mfma_f32_16x16x32_bf16 v[48:51], v[148:151], v[124:127], v[48:51]
    ds_read_b128 v[116:119], v238 offset:3072
    v_mfma_f32_16x16x32_bf16 v[52:55], v[148:151], v[128:131], v[52:55]
    ds_read_b128 v[120:123], v241 offset:0
    v_mfma_f32_16x16x32_bf16 v[56:59], v[148:151], v[132:135], v[56:59]
    v_mfma_f32_16x16x32_bf16 v[60:63], v[148:151], v[136:139], v[60:63]
    v_mfma_f32_16x16x32_bf16 v[64:67], v[152:155], v[124:127], v[64:67]
    v_mfma_f32_16x16x32_bf16 v[68:71], v[152:155], v[128:131], v[68:71]
    v_mfma_f32_16x16x32_bf16 v[72:75], v[152:155], v[132:135], v[72:75]
    v_mfma_f32_16x16x32_bf16 v[76:79], v[152:155], v[136:139], v[76:79]
    v_mfma_f32_16x16x32_bf16 v[80:83], v[156:159], v[124:127], v[80:83]
    v_mfma_f32_16x16x32_bf16 v[84:87], v[156:159], v[128:131], v[84:87]
    s_waitcnt lgkmcnt(0)
    v_mfma_f32_16x16x32_bf16 v[16:19], v[104:107], v[88:91], v[16:19]
    v_mfma_f32_16x16x32_bf16 v[20:23], v[104:107], v[92:95], v[20:23]
    ds_read_b128 v[124:127], v232 offset:17408
    v_mfma_f32_16x16x32_bf16 v[24:27], v[104:107], v[96:99], v[24:27]
    ds_read_b128 v[140:143], v238 offset:17408
    v_mfma_f32_16x16x32_bf16 v[28:31], v[104:107], v[100:103], v[28:31]
    ds_read_b128 v[128:131], v232 offset:17920
    v_mfma_f32_16x16x32_bf16 v[32:35], v[108:111], v[88:91], v[32:35]
    ds_read_b128 v[132:135], v235 offset:17408
    v_mfma_f32_16x16x32_bf16 v[36:39], v[108:111], v[92:95], v[36:39]
    ds_read_b128 v[136:139], v235 offset:17920
    v_mfma_f32_16x16x32_bf16 v[40:43], v[108:111], v[96:99], v[40:43]
    ds_read_b128 v[144:147], v238 offset:18432
    v_mfma_f32_16x16x32_bf16 v[44:47], v[108:111], v[100:103], v[44:47]
    ds_read_b128 v[148:151], v238 offset:19456
    v_mfma_f32_16x16x32_bf16 v[48:51], v[112:115], v[88:91], v[48:51]
    ds_read_b128 v[152:155], v238 offset:20480
    v_mfma_f32_16x16x32_bf16 v[52:55], v[112:115], v[92:95], v[52:55]
    ds_read_b128 v[156:159], v241 offset:17408
    v_mfma_f32_16x16x32_bf16 v[56:59], v[112:115], v[96:99], v[56:59]
    v_mfma_f32_16x16x32_bf16 v[60:63], v[112:115], v[100:103], v[60:63]
    v_mfma_f32_16x16x32_bf16 v[64:67], v[116:119], v[88:91], v[64:67]
    v_mfma_f32_16x16x32_bf16 v[68:71], v[116:119], v[92:95], v[68:71]
    v_mfma_f32_16x16x32_bf16 v[72:75], v[116:119], v[96:99], v[72:75]
    v_mfma_f32_16x16x32_bf16 v[76:79], v[116:119], v[100:103], v[76:79]
    v_mfma_f32_16x16x32_bf16 v[80:83], v[120:123], v[88:91], v[80:83]
    v_mfma_f32_16x16x32_bf16 v[84:87], v[120:123], v[92:95], v[84:87]
    s_waitcnt lgkmcnt(0)
    v_mfma_f32_16x16x32_bf16 v[16:19], v[140:143], v[124:127], v[16:19]
    v_mfma_f32_16x16x32_bf16 v[20:23], v[140:143], v[128:131], v[20:23]
    s_barrier
    ds_read_b128 v[88:91], v232 offset:34816
    v_mfma_f32_16x16x32_bf16 v[24:27], v[140:143], v[132:135], v[24:27]
    ds_read_b128 v[104:107], v238 offset:34816
    v_mfma_f32_16x16x32_bf16 v[28:31], v[140:143], v[136:139], v[28:31]
    ds_read_b128 v[92:95], v232 offset:35328
    v_mfma_f32_16x16x32_bf16 v[32:35], v[144:147], v[124:127], v[32:35]
    ds_read_b128 v[96:99], v235 offset:34816
    v_mfma_f32_16x16x32_bf16 v[36:39], v[144:147], v[128:131], v[36:39]
    ds_read_b128 v[100:103], v235 offset:35328
    v_mfma_f32_16x16x32_bf16 v[40:43], v[144:147], v[132:135], v[40:43]
    ds_read_b128 v[108:111], v238 offset:35840
    v_mfma_f32_16x16x32_bf16 v[44:47], v[144:147], v[136:139], v[44:47]
    ds_read_b128 v[112:115], v238 offset:36864
    v_mfma_f32_16x16x32_bf16 v[48:51], v[148:151], v[124:127], v[48:51]
    ds_read_b128 v[116:119], v238 offset:37888
    v_mfma_f32_16x16x32_bf16 v[52:55], v[148:151], v[128:131], v[52:55]
    ds_read_b128 v[120:123], v241 offset:34816
    v_mfma_f32_16x16x32_bf16 v[56:59], v[148:151], v[132:135], v[56:59]
    v_mfma_f32_16x16x32_bf16 v[60:63], v[148:151], v[136:139], v[60:63]
    v_mfma_f32_16x16x32_bf16 v[64:67], v[152:155], v[124:127], v[64:67]
    v_mfma_f32_16x16x32_bf16 v[68:71], v[152:155], v[128:131], v[68:71]
    v_mfma_f32_16x16x32_bf16 v[72:75], v[152:155], v[132:135], v[72:75]
    v_mfma_f32_16x16x32_bf16 v[76:79], v[152:155], v[136:139], v[76:79]
    v_mfma_f32_16x16x32_bf16 v[80:83], v[156:159], v[124:127], v[80:83]
    v_mfma_f32_16x16x32_bf16 v[84:87], v[156:159], v[128:131], v[84:87]
    s_waitcnt lgkmcnt(0)
    v_mfma_f32_16x16x32_bf16 v[16:19], v[104:107], v[88:91], v[16:19]
    v_mfma_f32_16x16x32_bf16 v[20:23], v[104:107], v[92:95], v[20:23]
    ds_read_b128 v[124:127], v233 offset:0
    v_mfma_f32_16x16x32_bf16 v[24:27], v[104:107], v[96:99], v[24:27]
    ds_read_b128 v[140:143], v239 offset:0
    v_mfma_f32_16x16x32_bf16 v[28:31], v[104:107], v[100:103], v[28:31]
    ds_read_b128 v[128:131], v233 offset:512
    v_mfma_f32_16x16x32_bf16 v[32:35], v[108:111], v[88:91], v[32:35]
    ds_read_b128 v[132:135], v236 offset:0
    v_mfma_f32_16x16x32_bf16 v[36:39], v[108:111], v[92:95], v[36:39]
    ds_read_b128 v[136:139], v236 offset:512
    v_mfma_f32_16x16x32_bf16 v[40:43], v[108:111], v[96:99], v[40:43]
    ds_read_b128 v[144:147], v239 offset:1024
    v_mfma_f32_16x16x32_bf16 v[44:47], v[108:111], v[100:103], v[44:47]
    ds_read_b128 v[148:151], v239 offset:2048
    v_mfma_f32_16x16x32_bf16 v[48:51], v[112:115], v[88:91], v[48:51]
    ds_read_b128 v[152:155], v239 offset:3072
    v_mfma_f32_16x16x32_bf16 v[52:55], v[112:115], v[92:95], v[52:55]
    ds_read_b128 v[156:159], v242 offset:0
    v_mfma_f32_16x16x32_bf16 v[56:59], v[112:115], v[96:99], v[56:59]
    v_mfma_f32_16x16x32_bf16 v[60:63], v[112:115], v[100:103], v[60:63]
    v_mfma_f32_16x16x32_bf16 v[64:67], v[116:119], v[88:91], v[64:67]
    v_mfma_f32_16x16x32_bf16 v[68:71], v[116:119], v[92:95], v[68:71]
    v_mfma_f32_16x16x32_bf16 v[72:75], v[116:119], v[96:99], v[72:75]
    v_mfma_f32_16x16x32_bf16 v[76:79], v[116:119], v[100:103], v[76:79]
    v_mfma_f32_16x16x32_bf16 v[80:83], v[120:123], v[88:91], v[80:83]
    v_mfma_f32_16x16x32_bf16 v[84:87], v[120:123], v[92:95], v[84:87]
    s_waitcnt lgkmcnt(0)
    v_mfma_f32_16x16x32_bf16 v[16:19], v[140:143], v[124:127], v[16:19]
    v_mfma_f32_16x16x32_bf16 v[20:23], v[140:143], v[128:131], v[20:23]
    s_barrier
    ds_read_b128 v[88:91], v233 offset:17408
    v_mfma_f32_16x16x32_bf16 v[24:27], v[140:143], v[132:135], v[24:27]
    ds_read_b128 v[104:107], v239 offset:17408
    v_mfma_f32_16x16x32_bf16 v[28:31], v[140:143], v[136:139], v[28:31]
    ds_read_b128 v[92:95], v233 offset:17920
    v_mfma_f32_16x16x32_bf16 v[32:35], v[144:147], v[124:127], v[32:35]
    ds_read_b128 v[96:99], v236 offset:17408
    v_mfma_f32_16x16x32_bf16 v[36:39], v[144:147], v[128:131], v[36:39]
    ds_read_b128 v[100:103], v236 offset:17920
    v_mfma_f32_16x16x32_bf16 v[40:43], v[144:147], v[132:135], v[40:43]
    ds_read_b128 v[108:111], v239 offset:18432
    v_mfma_f32_16x16x32_bf16 v[44:47], v[144:147], v[136:139], v[44:47]
    ds_read_b128 v[112:115], v239 offset:19456
    v_mfma_f32_16x16x32_bf16 v[48:51], v[148:151], v[124:127], v[48:51]
    ds_read_b128 v[116:119], v239 offset:20480
    v_mfma_f32_16x16x32_bf16 v[52:55], v[148:151], v[128:131], v[52:55]
    ds_read_b128 v[120:123], v242 offset:17408
    v_mfma_f32_16x16x32_bf16 v[56:59], v[148:151], v[132:135], v[56:59]
    v_mfma_f32_16x16x32_bf16 v[60:63], v[148:151], v[136:139], v[60:63]
    v_mfma_f32_16x16x32_bf16 v[64:67], v[152:155], v[124:127], v[64:67]
    v_mfma_f32_16x16x32_bf16 v[68:71], v[152:155], v[128:131], v[68:71]
    v_mfma_f32_16x16x32_bf16 v[72:75], v[152:155], v[132:135], v[72:75]
    v_mfma_f32_16x16x32_bf16 v[76:79], v[152:155], v[136:139], v[76:79]
    v_mfma_f32_16x16x32_bf16 v[80:83], v[156:159], v[124:127], v[80:83]
    v_mfma_f32_16x16x32_bf16 v[84:87], v[156:159], v[128:131], v[84:87]
    global_load_dword v247, v246, s[52:53] sc1
    s_waitcnt lgkmcnt(0)
    v_mfma_f32_16x16x32_bf16 v[16:19], v[104:107], v[88:91], v[16:19]
    v_mfma_f32_16x16x32_bf16 v[20:23], v[104:107], v[92:95], v[20:23]
    ds_read_b128 v[124:127], v233 offset:34816
    v_mfma_f32_16x16x32_bf16 v[24:27], v[104:107], v[96:99], v[24:27]
    ds_read_b128 v[140:143], v239 offset:34816
    v_mfma_f32_16x16x32_bf16 v[28:31], v[104:107], v[100:103], v[28:31]
    ds_read_b128 v[128:131], v233 offset:35328
    v_mfma_f32_16x16x32_bf16 v[32:35], v[108:111], v[88:91], v[32:35]
    ds_read_b128 v[132:135], v236 offset:34816
    v_mfma_f32_16x16x32_bf16 v[36:39], v[108:111], v[92:95], v[36:39]
    ds_read_b128 v[136:139], v236 offset:35328
    v_mfma_f32_16x16x32_bf16 v[40:43], v[108:111], v[96:99], v[40:43]
    ds_read_b128 v[144:147], v239 offset:35840
    v_mfma_f32_16x16x32_bf16 v[44:47], v[108:111], v[100:103], v[44:47]
    ds_read_b128 v[148:151], v239 offset:36864
    v_mfma_f32_16x16x32_bf16 v[48:51], v[112:115], v[88:91], v[48:51]
    ds_read_b128 v[152:155], v239 offset:37888
    v_mfma_f32_16x16x32_bf16 v[52:55], v[112:115], v[92:95], v[52:55]
    ds_read_b128 v[156:159], v242 offset:34816
    v_mfma_f32_16x16x32_bf16 v[56:59], v[112:115], v[96:99], v[56:59]
    v_mfma_f32_16x16x32_bf16 v[60:63], v[112:115], v[100:103], v[60:63]
    v_mfma_f32_16x16x32_bf16 v[64:67], v[116:119], v[88:91], v[64:67]
    v_mfma_f32_16x16x32_bf16 v[68:71], v[116:119], v[92:95], v[68:71]
    v_mfma_f32_16x16x32_bf16 v[72:75], v[116:119], v[96:99], v[72:75]
    v_mfma_f32_16x16x32_bf16 v[76:79], v[116:119], v[100:103], v[76:79]
    v_mfma_f32_16x16x32_bf16 v[80:83], v[120:123], v[88:91], v[80:83]
    v_mfma_f32_16x16x32_bf16 v[84:87], v[120:123], v[92:95], v[84:87]
    s_waitcnt lgkmcnt(0)
    v_mfma_f32_16x16x32_bf16 v[16:19], v[140:143], v[124:127], v[16:19]
    v_mfma_f32_16x16x32_bf16 v[20:23], v[140:143], v[128:131], v[20:23]
    s_barrier
    ds_read_b128 v[88:91], v234 offset:0
    v_mfma_f32_16x16x32_bf16 v[24:27], v[140:143], v[132:135], v[24:27]
    ds_read_b128 v[104:107], v240 offset:0
    v_mfma_f32_16x16x32_bf16 v[28:31], v[140:143], v[136:139], v[28:31]
    ds_read_b128 v[92:95], v234 offset:512
    v_mfma_f32_16x16x32_bf16 v[32:35], v[144:147], v[124:127], v[32:35]
    ds_read_b128 v[96:99], v237 offset:0
    v_mfma_f32_16x16x32_bf16 v[36:39], v[144:147], v[128:131], v[36:39]
    ds_read_b128 v[100:103], v237 offset:512
    v_mfma_f32_16x16x32_bf16 v[40:43], v[144:147], v[132:135], v[40:43]
    ds_read_b128 v[108:111], v240 offset:1024
    v_mfma_f32_16x16x32_bf16 v[44:47], v[144:147], v[136:139], v[44:47]
    ds_read_b128 v[112:115], v240 offset:2048
    v_mfma_f32_16x16x32_bf16 v[48:51], v[148:151], v[124:127], v[48:51]
    ds_read_b128 v[116:119], v240 offset:3072
    v_mfma_f32_16x16x32_bf16 v[52:55], v[148:151], v[128:131], v[52:55]
    ds_read_b128 v[120:123], v243 offset:0
    v_mfma_f32_16x16x32_bf16 v[56:59], v[148:151], v[132:135], v[56:59]
    v_mfma_f32_16x16x32_bf16 v[60:63], v[148:151], v[136:139], v[60:63]
    v_mfma_f32_16x16x32_bf16 v[64:67], v[152:155], v[124:127], v[64:67]
    v_mfma_f32_16x16x32_bf16 v[68:71], v[152:155], v[128:131], v[68:71]
    v_mfma_f32_16x16x32_bf16 v[72:75], v[152:155], v[132:135], v[72:75]
    v_mfma_f32_16x16x32_bf16 v[76:79], v[152:155], v[136:139], v[76:79]
    v_mfma_f32_16x16x32_bf16 v[80:83], v[156:159], v[124:127], v[80:83]
    v_mfma_f32_16x16x32_bf16 v[84:87], v[156:159], v[128:131], v[84:87]
    s_waitcnt lgkmcnt(0)
    v_mfma_f32_16x16x32_bf16 v[16:19], v[104:107], v[88:91], v[16:19]
    v_mfma_f32_16x16x32_bf16 v[20:23], v[104:107], v[92:95], v[20:23]
    ds_read_b128 v[124:127], v234 offset:17408
    v_mfma_f32_16x16x32_bf16 v[24:27], v[104:107], v[96:99], v[24:27]
    ds_read_b128 v[140:143], v240 offset:17408
    v_mfma_f32_16x16x32_bf16 v[28:31], v[104:107], v[100:103], v[28:31]
    ds_read_b128 v[128:131], v234 offset:17920
    v_mfma_f32_16x16x32_bf16 v[32:35], v[108:111], v[88:91], v[32:35]
    ds_read_b128 v[132:135], v237 offset:17408
    v_mfma_f32_16x16x32_bf16 v[36:39], v[108:111], v[92:95], v[36:39]
    ds_read_b128 v[136:139], v237 offset:17920
    v_mfma_f32_16x16x32_bf16 v[40:43], v[108:111], v[96:99], v[40:43]
    ds_read_b128 v[144:147], v240 offset:18432
    v_mfma_f32_16x16x32_bf16 v[44:47], v[108:111], v[100:103], v[44:47]
    ds_read_b128 v[148:151], v240 offset:19456
    v_mfma_f32_16x16x32_bf16 v[48:51], v[112:115], v[88:91], v[48:51]
    ds_read_b128 v[152:155], v240 offset:20480
    v_mfma_f32_16x16x32_bf16 v[52:55], v[112:115], v[92:95], v[52:55]
    ds_read_b128 v[156:159], v243 offset:17408
    v_mfma_f32_16x16x32_bf16 v[56:59], v[112:115], v[96:99], v[56:59]
    v_mfma_f32_16x16x32_bf16 v[60:63], v[112:115], v[100:103], v[60:63]
    v_mfma_f32_16x16x32_bf16 v[64:67], v[116:119], v[88:91], v[64:67]
    v_mfma_f32_16x16x32_bf16 v[68:71], v[116:119], v[92:95], v[68:71]
    v_mfma_f32_16x16x32_bf16 v[72:75], v[116:119], v[96:99], v[72:75]
    v_mfma_f32_16x16x32_bf16 v[76:79], v[116:119], v[100:103], v[76:79]
    v_mfma_f32_16x16x32_bf16 v[80:83], v[120:123], v[88:91], v[80:83]
    v_mfma_f32_16x16x32_bf16 v[84:87], v[120:123], v[92:95], v[84:87]
    s_waitcnt lgkmcnt(0)
    v_mfma_f32_16x16x32_bf16 v[16:19], v[140:143], v[124:127], v[16:19]
    v_mfma_f32_16x16x32_bf16 v[20:23], v[140:143], v[128:131], v[20:23]
    s_barrier
    ds_read_b128 v[88:91], v232 offset:0
    v_mfma_f32_16x16x32_bf16 v[24:27], v[140:143], v[132:135], v[24:27]
    ds_read_b128 v[104:107], v238 offset:0
    v_mfma_f32_16x16x32_bf16 v[28:31], v[140:143], v[136:139], v[28:31]
    ds_read_b128 v[92:95], v232 offset:512
    v_mfma_f32_16x16x32_bf16 v[32:35], v[144:147], v[124:127], v[32:35]
    ds_read_b128 v[96:99], v235 offset:0
    v_mfma_f32_16x16x32_bf16 v[36:39], v[144:147], v[128:131], v[36:39]
    ds_read_b128 v[100:103], v235 offset:512
    v_mfma_f32_16x16x32_bf16 v[40:43], v[144:147], v[132:135], v[40:43]
    ds_read_b128 v[108:111], v238 offset:1024
    v_mfma_f32_16x16x32_bf16 v[44:47], v[144:147], v[136:139], v[44:47]
    ds_read_b128 v[112:115], v238 offset:2048
    v_mfma_f32_16x16x32_bf16 v[48:51], v[148:151], v[124:127], v[48:51]
    ds_read_b128 v[116:119], v238 offset:3072
    v_mfma_f32_16x16x32_bf16 v[52:55], v[148:151], v[128:131], v[52:55]
    ds_read_b128 v[120:123], v241 offset:0
    v_mfma_f32_16x16x32_bf16 v[56:59], v[148:151], v[132:135], v[56:59]
    v_mfma_f32_16x16x32_bf16 v[60:63], v[148:151], v[136:139], v[60:63]
    v_mfma_f32_16x16x32_bf16 v[64:67], v[152:155], v[124:127], v[64:67]
    v_mfma_f32_16x16x32_bf16 v[68:71], v[152:155], v[128:131], v[68:71]
    v_mfma_f32_16x16x32_bf16 v[72:75], v[152:155], v[132:135], v[72:75]
    v_mfma_f32_16x16x32_bf16 v[76:79], v[152:155], v[136:139], v[76:79]
    v_mfma_f32_16x16x32_bf16 v[80:83], v[156:159], v[124:127], v[80:83]
    v_mfma_f32_16x16x32_bf16 v[84:87], v[156:159], v[128:131], v[84:87]
L_k3po_27:
    s_waitcnt vmcnt(0)
    v_cmp_ne_u32 vcc, 0, v247
    s_nop 1
    s_cmp_eq_u64 vcc, -1
    s_cbranch_scc1 L_k3pok_28
    global_load_dword v247, v246, s[52:53] sc1
    s_branch L_k3po_27
L_k3pok_28:

    s_mov_b32 s55, 0
    s_waitcnt lgkmcnt(0)
    v_mfma_f32_16x16x32_bf16 v[16:19], v[104:107], v[88:91], v[16:19]
    v_mfma_f32_16x16x32_bf16 v[20:23], v[104:107], v[92:95], v[20:23]
    ds_read_b128 v[124:127], v232 offset:17408
    v_mfma_f32_16x16x32_bf16 v[24:27], v[104:107], v[96:99], v[24:27]
    ds_read_b128 v[140:143], v238 offset:17408
    v_mfma_f32_16x16x32_bf16 v[28:31], v[104:107], v[100:103], v[28:31]
    ds_read_b128 v[128:131], v232 offset:17920
    v_mfma_f32_16x16x32_bf16 v[32:35], v[108:111], v[88:91], v[32:35]
    ds_read_b128 v[132:135], v235 offset:17408
    v_mfma_f32_16x16x32_bf16 v[36:39], v[108:111], v[92:95], v[36:39]
    ds_read_b128 v[136:139], v235 offset:17920
    v_mfma_f32_16x16x32_bf16 v[40:43], v[108:111], v[96:99], v[40:43]
    ds_read_b128 v[144:147], v238 offset:18432
    v_mfma_f32_16x16x32_bf16 v[44:47], v[108:111], v[100:103], v[44:47]
    ds_read_b128 v[148:151], v238 offset:19456
    v_mfma_f32_16x16x32_bf16 v[48:51], v[112:115], v[88:91], v[48:51]
    ds_read_b128 v[152:155], v238 offset:20480
    v_mfma_f32_16x16x32_bf16 v[52:55], v[112:115], v[92:95], v[52:55]
    ds_read_b128 v[156:159], v241 offset:17408
    v_mfma_f32_16x16x32_bf16 v[56:59], v[112:115], v[96:99], v[56:59]
    buffer_load_dwordx4 v[160:163], v14, s[28:31], s55 offen sc1
    v_mfma_f32_16x16x32_bf16 v[60:63], v[112:115], v[100:103], v[60:63]
    buffer_load_dwordx4 v[164:167], v15, s[28:31], s55 offen sc1
    v_mfma_f32_16x16x32_bf16 v[64:67], v[116:119], v[88:91], v[64:67]
    v_mfma_f32_16x16x32_bf16 v[68:71], v[116:119], v[92:95], v[68:71]
    v_mfma_f32_16x16x32_bf16 v[72:75], v[116:119], v[96:99], v[72:75]
    v_mfma_f32_16x16x32_bf16 v[76:79], v[116:119], v[100:103], v[76:79]
    v_mfma_f32_16x16x32_bf16 v[80:83], v[120:123], v[88:91], v[80:83]
    v_mfma_f32_16x16x32_bf16 v[84:87], v[120:123], v[92:95], v[84:87]
    s_mov_b32 s55, 131072
    s_waitcnt lgkmcnt(0)
    v_mfma_f32_16x16x32_bf16 v[16:19], v[140:143], v[124:127], v[16:19]
    v_mfma_f32_16x16x32_bf16 v[20:23], v[140:143], v[128:131], v[20:23]
    s_barrier
    ds_read_b128 v[88:91], v232 offset:34816
    v_mfma_f32_16x16x32_bf16 v[24:27], v[140:143], v[132:135], v[24:27]
    ds_read_b128 v[104:107], v238 offset:34816
    v_mfma_f32_16x16x32_bf16 v[28:31], v[140:143], v[136:139], v[28:31]
    ds_read_b128 v[92:95], v232 offset:35328
    v_mfma_f32_16x16x32_bf16 v[32:35], v[144:147], v[124:127], v[32:35]
    ds_read_b128 v[96:99], v235 offset:34816
    v_mfma_f32_16x16x32_bf16 v[36:39], v[144:147], v[128:131], v[36:39]
    ds_read_b128 v[100:103], v235 offset:35328
    v_mfma_f32_16x16x32_bf16 v[40:43], v[144:147], v[132:135], v[40:43]
    ds_read_b128 v[108:111], v238 offset:35840
    v_mfma_f32_16x16x32_bf16 v[44:47], v[144:147], v[136:139], v[44:47]
    ds_read_b128 v[112:115], v238 offset:36864
    v_mfma_f32_16x16x32_bf16 v[48:51], v[148:151], v[124:127], v[48:51]
    ds_read_b128 v[116:119], v238 offset:37888
    v_mfma_f32_16x16x32_bf16 v[52:55], v[148:151], v[128:131], v[52:55]
    ds_read_b128 v[120:123], v241 offset:34816
    v_mfma_f32_16x16x32_bf16 v[56:59], v[148:151], v[132:135], v[56:59]
    buffer_load_dwordx4 v[168:171], v14, s[28:31], s55 offen sc1
    v_mfma_f32_16x16x32_bf16 v[60:63], v[148:151], v[136:139], v[60:63]
    buffer_load_dwordx4 v[172:175], v15, s[28:31], s55 offen sc1
    v_mfma_f32_16x16x32_bf16 v[64:67], v[152:155], v[124:127], v[64:67]
    v_mfma_f32_16x16x32_bf16 v[68:71], v[152:155], v[128:131], v[68:71]
    v_mfma_f32_16x16x32_bf16 v[72:75], v[152:155], v[132:135], v[72:75]
    v_mfma_f32_16x16x32_bf16 v[76:79], v[152:155], v[136:139], v[76:79]
    v_mfma_f32_16x16x32_bf16 v[80:83], v[156:159], v[124:127], v[80:83]
    v_mfma_f32_16x16x32_bf16 v[84:87], v[156:159], v[128:131], v[84:87]
    s_mov_b32 s55, 262144
    s_waitcnt lgkmcnt(0)
    v_mfma_f32_16x16x32_bf16 v[16:19], v[104:107], v[88:91], v[16:19]
    v_mfma_f32_16x16x32_bf16 v[20:23], v[104:107], v[92:95], v[20:23]
    ds_read_b128 v[124:127], v233 offset:0
    v_mfma_f32_16x16x32_bf16 v[24:27], v[104:107], v[96:99], v[24:27]
    ds_read_b128 v[140:143], v239 offset:0
    v_mfma_f32_16x16x32_bf16 v[28:31], v[104:107], v[100:103], v[28:31]
    ds_read_b128 v[128:131], v233 offset:512
    v_mfma_f32_16x16x32_bf16 v[32:35], v[108:111], v[88:91], v[32:35]
    ds_read_b128 v[132:135], v236 offset:0
    v_mfma_f32_16x16x32_bf16 v[36:39], v[108:111], v[92:95], v[36:39]
    ds_read_b128 v[136:139], v236 offset:512
    v_mfma_f32_16x16x32_bf16 v[40:43], v[108:111], v[96:99], v[40:43]
    ds_read_b128 v[144:147], v239 offset:1024
    v_mfma_f32_16x16x32_bf16 v[44:47], v[108:111], v[100:103], v[44:47]
    ds_read_b128 v[148:151], v239 offset:2048
    v_mfma_f32_16x16x32_bf16 v[48:51], v[112:115], v[88:91], v[48:51]
    ds_read_b128 v[152:155], v239 offset:3072
    v_mfma_f32_16x16x32_bf16 v[52:55], v[112:115], v[92:95], v[52:55]
    ds_read_b128 v[156:159], v242 offset:0
    v_mfma_f32_16x16x32_bf16 v[56:59], v[112:115], v[96:99], v[56:59]
    buffer_load_dwordx4 v[176:179], v14, s[28:31], s55 offen sc1
    v_mfma_f32_16x16x32_bf16 v[60:63], v[112:115], v[100:103], v[60:63]
    buffer_load_dwordx4 v[180:183], v15, s[28:31], s55 offen sc1
    v_mfma_f32_16x16x32_bf16 v[64:67], v[116:119], v[88:91], v[64:67]
    v_mfma_f32_16x16x32_bf16 v[68:71], v[116:119], v[92:95], v[68:71]
    v_mfma_f32_16x16x32_bf16 v[72:75], v[116:119], v[96:99], v[72:75]
    v_mfma_f32_16x16x32_bf16 v[76:79], v[116:119], v[100:103], v[76:79]
    v_mfma_f32_16x16x32_bf16 v[80:83], v[120:123], v[88:91], v[80:83]
    v_mfma_f32_16x16x32_bf16 v[84:87], v[120:123], v[92:95], v[84:87]
    s_mov_b32 s55, 786432
    s_waitcnt lgkmcnt(0)
    v_mfma_f32_16x16x32_bf16 v[16:19], v[140:143], v[124:127], v[16:19]
    v_mfma_f32_16x16x32_bf16 v[20:23], v[140:143], v[128:131], v[20:23]
    s_barrier
    ds_read_b128 v[88:91], v233 offset:17408
    v_mfma_f32_16x16x32_bf16 v[24:27], v[140:143], v[132:135], v[24:27]
    ds_read_b128 v[104:107], v239 offset:17408
    v_mfma_f32_16x16x32_bf16 v[28:31], v[140:143], v[136:139], v[28:31]
    ds_read_b128 v[92:95], v233 offset:17920
    v_mfma_f32_16x16x32_bf16 v[32:35], v[144:147], v[124:127], v[32:35]
    ds_read_b128 v[96:99], v236 offset:17408
    v_mfma_f32_16x16x32_bf16 v[36:39], v[144:147], v[128:131], v[36:39]
    ds_read_b128 v[100:103], v236 offset:17920
    v_mfma_f32_16x16x32_bf16 v[40:43], v[144:147], v[132:135], v[40:43]
    ds_read_b128 v[108:111], v239 offset:18432
    v_mfma_f32_16x16x32_bf16 v[44:47], v[144:147], v[136:139], v[44:47]
    ds_read_b128 v[112:115], v239 offset:19456
    v_mfma_f32_16x16x32_bf16 v[48:51], v[148:151], v[124:127], v[48:51]
    ds_read_b128 v[116:119], v239 offset:20480
    v_mfma_f32_16x16x32_bf16 v[52:55], v[148:151], v[128:131], v[52:55]
    ds_read_b128 v[120:123], v242 offset:17408
    v_mfma_f32_16x16x32_bf16 v[56:59], v[148:151], v[132:135], v[56:59]
    buffer_load_dwordx4 v[184:187], v14, s[28:31], s55 offen sc1
    v_mfma_f32_16x16x32_bf16 v[60:63], v[148:151], v[136:139], v[60:63]
    buffer_load_dwordx4 v[188:191], v15, s[28:31], s55 offen sc1
    v_mfma_f32_16x16x32_bf16 v[64:67], v[152:155], v[124:127], v[64:67]
    v_mfma_f32_16x16x32_bf16 v[68:71], v[152:155], v[128:131], v[68:71]
    v_mfma_f32_16x16x32_bf16 v[72:75], v[152:155], v[132:135], v[72:75]
    v_mfma_f32_16x16x32_bf16 v[76:79], v[152:155], v[136:139], v[76:79]
    v_mfma_f32_16x16x32_bf16 v[80:83], v[156:159], v[124:127], v[80:83]
    v_mfma_f32_16x16x32_bf16 v[84:87], v[156:159], v[128:131], v[84:87]
    s_mov_b32 s55, 917504
    s_waitcnt lgkmcnt(0)
    v_mfma_f32_16x16x32_bf16 v[16:19], v[104:107], v[88:91], v[16:19]
    v_mfma_f32_16x16x32_bf16 v[20:23], v[104:107], v[92:95], v[20:23]
    ds_read_b128 v[124:127], v233 offset:34816
    v_mfma_f32_16x16x32_bf16 v[24:27], v[104:107], v[96:99], v[24:27]
    ds_read_b128 v[140:143], v239 offset:34816
    v_mfma_f32_16x16x32_bf16 v[28:31], v[104:107], v[100:103], v[28:31]
    ds_read_b128 v[128:131], v233 offset:35328
    v_mfma_f32_16x16x32_bf16 v[32:35], v[108:111], v[88:91], v[32:35]
    ds_read_b128 v[132:135], v236 offset:34816
    v_mfma_f32_16x16x32_bf16 v[36:39], v[108:111], v[92:95], v[36:39]
    ds_read_b128 v[136:139], v236 offset:35328
    v_mfma_f32_16x16x32_bf16 v[40:43], v[108:111], v[96:99], v[40:43]
    ds_read_b128 v[144:147], v239 offset:35840
    v_mfma_f32_16x16x32_bf16 v[44:47], v[108:111], v[100:103], v[44:47]
    ds_read_b128 v[148:151], v239 offset:36864
    v_mfma_f32_16x16x32_bf16 v[48:51], v[112:115], v[88:91], v[48:51]
    ds_read_b128 v[152:155], v239 offset:37888
    v_mfma_f32_16x16x32_bf16 v[52:55], v[112:115], v[92:95], v[52:55]
    ds_read_b128 v[156:159], v242 offset:34816
    v_mfma_f32_16x16x32_bf16 v[56:59], v[112:115], v[96:99], v[56:59]
    buffer_load_dwordx4 v[192:195], v14, s[28:31], s55 offen sc1
    v_mfma_f32_16x16x32_bf16 v[60:63], v[112:115], v[100:103], v[60:63]
    buffer_load_dwordx4 v[196:199], v15, s[28:31], s55 offen sc1
    v_mfma_f32_16x16x32_bf16 v[64:67], v[116:119], v[88:91], v[64:67]
    v_mfma_f32_16x16x32_bf16 v[68:71], v[116:119], v[92:95], v[68:71]
    v_mfma_f32_16x16x32_bf16 v[72:75], v[116:119], v[96:99], v[72:75]
    v_mfma_f32_16x16x32_bf16 v[76:79], v[116:119], v[100:103], v[76:79]
    v_mfma_f32_16x16x32_bf16 v[80:83], v[120:123], v[88:91], v[80:83]
    v_mfma_f32_16x16x32_bf16 v[84:87], v[120:123], v[92:95], v[84:87]
    s_mov_b32 s55, 1048576
    s_waitcnt lgkmcnt(0)
    v_mfma_f32_16x16x32_bf16 v[16:19], v[140:143], v[124:127], v[16:19]
    v_mfma_f32_16x16x32_bf16 v[20:23], v[140:143], v[128:131], v[20:23]
    s_barrier
    ds_read_b128 v[88:91], v234 offset:0
    v_mfma_f32_16x16x32_bf16 v[24:27], v[140:143], v[132:135], v[24:27]
    ds_read_b128 v[104:107], v240 offset:0
    v_mfma_f32_16x16x32_bf16 v[28:31], v[140:143], v[136:139], v[28:31]
    ds_read_b128 v[92:95], v234 offset:512
    v_mfma_f32_16x16x32_bf16 v[32:35], v[144:147], v[124:127], v[32:35]
    ds_read_b128 v[96:99], v237 offset:0
    v_mfma_f32_16x16x32_bf16 v[36:39], v[144:147], v[128:131], v[36:39]
    ds_read_b128 v[100:103], v237 offset:512
    v_mfma_f32_16x16x32_bf16 v[40:43], v[144:147], v[132:135], v[40:43]
    ds_read_b128 v[108:111], v240 offset:1024
    v_mfma_f32_16x16x32_bf16 v[44:47], v[144:147], v[136:139], v[44:47]
    ds_read_b128 v[112:115], v240 offset:2048
    v_mfma_f32_16x16x32_bf16 v[48:51], v[148:151], v[124:127], v[48:51]
    ds_read_b128 v[116:119], v240 offset:3072
    v_mfma_f32_16x16x32_bf16 v[52:55], v[148:151], v[128:131], v[52:55]
    ds_read_b128 v[120:123], v243 offset:0
    v_mfma_f32_16x16x32_bf16 v[56:59], v[148:151], v[132:135], v[56:59]
    buffer_load_dwordx4 v[200:203], v14, s[28:31], s55 offen sc1
    v_mfma_f32_16x16x32_bf16 v[60:63], v[148:151], v[136:139], v[60:63]
    buffer_load_dwordx4 v[204:207], v15, s[28:31], s55 offen sc1
    v_mfma_f32_16x16x32_bf16 v[64:67], v[152:155], v[124:127], v[64:67]
    v_mfma_f32_16x16x32_bf16 v[68:71], v[152:155], v[128:131], v[68:71]
    v_mfma_f32_16x16x32_bf16 v[72:75], v[152:155], v[132:135], v[72:75]
    v_mfma_f32_16x16x32_bf16 v[76:79], v[152:155], v[136:139], v[76:79]
    v_mfma_f32_16x16x32_bf16 v[80:83], v[156:159], v[124:127], v[80:83]
    v_mfma_f32_16x16x32_bf16 v[84:87], v[156:159], v[128:131], v[84:87]
    s_mov_b32 s55, 1572864
    s_waitcnt lgkmcnt(0)
    v_mfma_f32_16x16x32_bf16 v[16:19], v[104:107], v[88:91], v[16:19]
    v_mfma_f32_16x16x32_bf16 v[20:23], v[104:107], v[92:95], v[20:23]
    ds_read_b128 v[124:127], v234 offset:17408
    v_mfma_f32_16x16x32_bf16 v[24:27], v[104:107], v[96:99], v[24:27]
    ds_read_b128 v[140:143], v240 offset:17408
    v_mfma_f32_16x16x32_bf16 v[28:31], v[104:107], v[100:103], v[28:31]
    ds_read_b128 v[128:131], v234 offset:17920
    v_mfma_f32_16x16x32_bf16 v[32:35], v[108:111], v[88:91], v[32:35]
    ds_read_b128 v[132:135], v237 offset:17408
    v_mfma_f32_16x16x32_bf16 v[36:39], v[108:111], v[92:95], v[36:39]
    ds_read_b128 v[136:139], v237 offset:17920
    v_mfma_f32_16x16x32_bf16 v[40:43], v[108:111], v[96:99], v[40:43]
    ds_read_b128 v[144:147], v240 offset:18432
    v_mfma_f32_16x16x32_bf16 v[44:47], v[108:111], v[100:103], v[44:47]
    ds_read_b128 v[148:151], v240 offset:19456
    v_mfma_f32_16x16x32_bf16 v[48:51], v[112:115], v[88:91], v[48:51]
    ds_read_b128 v[152:155], v240 offset:20480
    v_mfma_f32_16x16x32_bf16 v[52:55], v[112:115], v[92:95], v[52:55]
    ds_read_b128 v[156:159], v243 offset:17408
    v_mfma_f32_16x16x32_bf16 v[56:59], v[112:115], v[96:99], v[56:59]
    buffer_load_dwordx4 v[208:211], v14, s[28:31], s55 offen sc1
    v_mfma_f32_16x16x32_bf16 v[60:63], v[112:115], v[100:103], v[60:63]
    buffer_load_dwordx4 v[212:215], v15, s[28:31], s55 offen sc1
    v_mfma_f32_16x16x32_bf16 v[64:67], v[116:119], v[88:91], v[64:67]
    v_mfma_f32_16x16x32_bf16 v[68:71], v[116:119], v[92:95], v[68:71]
    v_mfma_f32_16x16x32_bf16 v[72:75], v[116:119], v[96:99], v[72:75]
    v_mfma_f32_16x16x32_bf16 v[76:79], v[116:119], v[100:103], v[76:79]
    v_mfma_f32_16x16x32_bf16 v[80:83], v[120:123], v[88:91], v[80:83]
    v_mfma_f32_16x16x32_bf16 v[84:87], v[120:123], v[92:95], v[84:87]
    s_mov_b32 s55, 1703936
    s_waitcnt lgkmcnt(0)
    v_mfma_f32_16x16x32_bf16 v[16:19], v[140:143], v[124:127], v[16:19]
    v_mfma_f32_16x16x32_bf16 v[20:23], v[140:143], v[128:131], v[20:23]
    s_barrier
    ds_read_b128 v[88:91], v232 offset:0
    v_mfma_f32_16x16x32_bf16 v[24:27], v[140:143], v[132:135], v[24:27]
    ds_read_b128 v[104:107], v238 offset:0
    v_mfma_f32_16x16x32_bf16 v[28:31], v[140:143], v[136:139], v[28:31]
    ds_read_b128 v[92:95], v232 offset:512
    v_mfma_f32_16x16x32_bf16 v[32:35], v[144:147], v[124:127], v[32:35]
    ds_read_b128 v[96:99], v235 offset:0
    v_mfma_f32_16x16x32_bf16 v[36:39], v[144:147], v[128:131], v[36:39]
    ds_read_b128 v[100:103], v235 offset:512
    v_mfma_f32_16x16x32_bf16 v[40:43], v[144:147], v[132:135], v[40:43]
    ds_read_b128 v[108:111], v238 offset:1024
    v_mfma_f32_16x16x32_bf16 v[44:47], v[144:147], v[136:139], v[44:47]
    ds_read_b128 v[112:115], v238 offset:2048
    v_mfma_f32_16x16x32_bf16 v[48:51], v[148:151], v[124:127], v[48:51]
    ds_read_b128 v[116:119], v238 offset:3072
    v_mfma_f32_16x16x32_bf16 v[52:55], v[148:151], v[128:131], v[52:55]
    ds_read_b128 v[120:123], v241 offset:0
    v_mfma_f32_16x16x32_bf16 v[56:59], v[148:151], v[132:135], v[56:59]
    buffer_load_dwordx4 v[216:219], v14, s[28:31], s55 offen sc1
    v_mfma_f32_16x16x32_bf16 v[60:63], v[148:151], v[136:139], v[60:63]
    buffer_load_dwordx4 v[220:223], v15, s[28:31], s55 offen sc1
    v_mfma_f32_16x16x32_bf16 v[64:67], v[152:155], v[124:127], v[64:67]
    v_mfma_f32_16x16x32_bf16 v[68:71], v[152:155], v[128:131], v[68:71]
    v_mfma_f32_16x16x32_bf16 v[72:75], v[152:155], v[132:135], v[72:75]
    v_mfma_f32_16x16x32_bf16 v[76:79], v[152:155], v[136:139], v[76:79]
    v_mfma_f32_16x16x32_bf16 v[80:83], v[156:159], v[124:127], v[80:83]
    v_mfma_f32_16x16x32_bf16 v[84:87], v[156:159], v[128:131], v[84:87]
    s_mov_b32 s55, 1835008
    s_waitcnt lgkmcnt(0)
    v_mfma_f32_16x16x32_bf16 v[16:19], v[104:107], v[88:91], v[16:19]
    v_mfma_f32_16x16x32_bf16 v[20:23], v[104:107], v[92:95], v[20:23]
    ds_read_b128 v[124:127], v232 offset:17408
    v_mfma_f32_16x16x32_bf16 v[24:27], v[104:107], v[96:99], v[24:27]
    ds_read_b128 v[140:143], v238 offset:17408
    v_mfma_f32_16x16x32_bf16 v[28:31], v[104:107], v[100:103], v[28:31]
    ds_read_b128 v[128:131], v232 offset:17920
    v_mfma_f32_16x16x32_bf16 v[32:35], v[108:111], v[88:91], v[32:35]
    ds_read_b128 v[132:135], v235 offset:17408
    v_mfma_f32_16x16x32_bf16 v[36:39], v[108:111], v[92:95], v[36:39]
    ds_read_b128 v[136:139], v235 offset:17920
    v_mfma_f32_16x16x32_bf16 v[40:43], v[108:111], v[96:99], v[40:43]
    ds_read_b128 v[144:147], v238 offset:18432
    v_mfma_f32_16x16x32_bf16 v[44:47], v[108:111], v[100:103], v[44:47]
    ds_read_b128 v[148:151], v238 offset:19456
    v_mfma_f32_16x16x32_bf16 v[48:51], v[112:115], v[88:91], v[48:51]
    ds_read_b128 v[152:155], v238 offset:20480
    v_mfma_f32_16x16x32_bf16 v[52:55], v[112:115], v[92:95], v[52:55]
    ds_read_b128 v[156:159], v241 offset:17408
    v_mfma_f32_16x16x32_bf16 v[56:59], v[112:115], v[96:99], v[56:59]
    buffer_load_dwordx4 v[224:227], v14, s[28:31], s55 offen sc1
    v_mfma_f32_16x16x32_bf16 v[60:63], v[112:115], v[100:103], v[60:63]
    buffer_load_dwordx4 v[228:231], v15, s[28:31], s55 offen sc1
    v_mfma_f32_16x16x32_bf16 v[64:67], v[116:119], v[88:91], v[64:67]
    v_mfma_f32_16x16x32_bf16 v[68:71], v[116:119], v[92:95], v[68:71]
    v_mfma_f32_16x16x32_bf16 v[72:75], v[116:119], v[96:99], v[72:75]
    v_mfma_f32_16x16x32_bf16 v[76:79], v[116:119], v[100:103], v[76:79]
    v_mfma_f32_16x16x32_bf16 v[80:83], v[120:123], v[88:91], v[80:83]
    v_mfma_f32_16x16x32_bf16 v[84:87], v[120:123], v[92:95], v[84:87]
    s_waitcnt lgkmcnt(0)
    v_mfma_f32_16x16x32_bf16 v[16:19], v[140:143], v[124:127], v[16:19]
    v_mfma_f32_16x16x32_bf16 v[20:23], v[140:143], v[128:131], v[20:23]
    s_barrier
    ds_read_b128 v[88:91], v232 offset:34816
    v_mfma_f32_16x16x32_bf16 v[24:27], v[140:143], v[132:135], v[24:27]
    ds_read_b128 v[104:107], v238 offset:34816
    v_mfma_f32_16x16x32_bf16 v[28:31], v[140:143], v[136:139], v[28:31]
    ds_read_b128 v[92:95], v232 offset:35328
    v_mfma_f32_16x16x32_bf16 v[32:35], v[144:147], v[124:127], v[32:35]
    ds_read_b128 v[96:99], v235 offset:34816
    v_mfma_f32_16x16x32_bf16 v[36:39], v[144:147], v[128:131], v[36:39]
    ds_read_b128 v[100:103], v235 offset:35328
    v_mfma_f32_16x16x32_bf16 v[40:43], v[144:147], v[132:135], v[40:43]
    ds_read_b128 v[108:111], v238 offset:35840
    v_mfma_f32_16x16x32_bf16 v[44:47], v[144:147], v[136:139], v[44:47]
    ds_read_b128 v[112:115], v238 offset:36864
    v_mfma_f32_16x16x32_bf16 v[48:51], v[148:151], v[124:127], v[48:51]
    ds_read_b128 v[116:119], v238 offset:37888
    v_mfma_f32_16x16x32_bf16 v[52:55], v[148:151], v[128:131], v[52:55]
    ds_read_b128 v[120:123], v241 offset:34816
    v_mfma_f32_16x16x32_bf16 v[56:59], v[148:151], v[132:135], v[56:59]
    v_mfma_f32_16x16x32_bf16 v[60:63], v[148:151], v[136:139], v[60:63]
    v_mfma_f32_16x16x32_bf16 v[64:67], v[152:155], v[124:127], v[64:67]
    v_mfma_f32_16x16x32_bf16 v[68:71], v[152:155], v[128:131], v[68:71]
    v_mfma_f32_16x16x32_bf16 v[72:75], v[152:155], v[132:135], v[72:75]
    v_mfma_f32_16x16x32_bf16 v[76:79], v[152:155], v[136:139], v[76:79]
    v_mfma_f32_16x16x32_bf16 v[80:83], v[156:159], v[124:127], v[80:83]
    v_mfma_f32_16x16x32_bf16 v[84:87], v[156:159], v[128:131], v[84:87]
    s_waitcnt lgkmcnt(0)
    v_mfma_f32_16x16x32_bf16 v[16:19], v[104:107], v[88:91], v[16:19]
    v_mfma_f32_16x16x32_bf16 v[20:23], v[104:107], v[92:95], v[20:23]
    ds_read_b128 v[124:127], v233 offset:0
    v_mfma_f32_16x16x32_bf16 v[24:27], v[104:107], v[96:99], v[24:27]
    ds_read_b128 v[140:143], v239 offset:0
    v_mfma_f32_16x16x32_bf16 v[28:31], v[104:107], v[100:103], v[28:31]
    ds_read_b128 v[128:131], v233 offset:512
    v_mfma_f32_16x16x32_bf16 v[32:35], v[108:111], v[88:91], v[32:35]
    ds_read_b128 v[132:135], v236 offset:0
    v_mfma_f32_16x16x32_bf16 v[36:39], v[108:111], v[92:95], v[36:39]
    ds_read_b128 v[136:139], v236 offset:512
    v_mfma_f32_16x16x32_bf16 v[40:43], v[108:111], v[96:99], v[40:43]
    ds_read_b128 v[144:147], v239 offset:1024
    v_mfma_f32_16x16x32_bf16 v[44:47], v[108:111], v[100:103], v[44:47]
    ds_read_b128 v[148:151], v239 offset:2048
    v_mfma_f32_16x16x32_bf16 v[48:51], v[112:115], v[88:91], v[48:51]
    ds_read_b128 v[152:155], v239 offset:3072
    v_mfma_f32_16x16x32_bf16 v[52:55], v[112:115], v[92:95], v[52:55]
    ds_read_b128 v[156:159], v242 offset:0
    v_mfma_f32_16x16x32_bf16 v[56:59], v[112:115], v[96:99], v[56:59]
    v_mfma_f32_16x16x32_bf16 v[60:63], v[112:115], v[100:103], v[60:63]
    v_mfma_f32_16x16x32_bf16 v[64:67], v[116:119], v[88:91], v[64:67]
    v_mfma_f32_16x16x32_bf16 v[68:71], v[116:119], v[92:95], v[68:71]
    v_mfma_f32_16x16x32_bf16 v[72:75], v[116:119], v[96:99], v[72:75]
    v_mfma_f32_16x16x32_bf16 v[76:79], v[116:119], v[100:103], v[76:79]
    v_mfma_f32_16x16x32_bf16 v[80:83], v[120:123], v[88:91], v[80:83]
    v_mfma_f32_16x16x32_bf16 v[84:87], v[120:123], v[92:95], v[84:87]
    s_waitcnt lgkmcnt(0)
    v_mfma_f32_16x16x32_bf16 v[16:19], v[140:143], v[124:127], v[16:19]
    v_mfma_f32_16x16x32_bf16 v[20:23], v[140:143], v[128:131], v[20:23]
    s_barrier
    ds_read_b128 v[88:91], v12 offset:0
    v_mfma_f32_16x16x32_bf16 v[24:27], v[140:143], v[132:135], v[24:27]
    ds_read_b128 v[92:95], v12 offset:1024
    v_mfma_f32_16x16x32_bf16 v[28:31], v[140:143], v[136:139], v[28:31]
    ds_read_b128 v[96:99], v12 offset:2048
    v_mfma_f32_16x16x32_bf16 v[32:35], v[144:147], v[124:127], v[32:35]
    ds_read_b128 v[100:103], v12 offset:3072
    v_mfma_f32_16x16x32_bf16 v[36:39], v[144:147], v[128:131], v[36:39]
    ds_read_b128 v[104:107], v13 offset:0
    v_mfma_f32_16x16x32_bf16 v[40:43], v[144:147], v[132:135], v[40:43]
    v_mfma_f32_16x16x32_bf16 v[44:47], v[144:147], v[136:139], v[44:47]
    v_mfma_f32_16x16x32_bf16 v[48:51], v[148:151], v[124:127], v[48:51]
    v_mfma_f32_16x16x32_bf16 v[52:55], v[148:151], v[128:131], v[52:55]
    v_mfma_f32_16x16x32_bf16 v[56:59], v[148:151], v[132:135], v[56:59]
    v_mfma_f32_16x16x32_bf16 v[60:63], v[148:151], v[136:139], v[60:63]
    v_mfma_f32_16x16x32_bf16 v[64:67], v[152:155], v[124:127], v[64:67]
    v_mfma_f32_16x16x32_bf16 v[68:71], v[152:155], v[128:131], v[68:71]
    v_mfma_f32_16x16x32_bf16 v[72:75], v[152:155], v[132:135], v[72:75]
    v_mfma_f32_16x16x32_bf16 v[76:79], v[152:155], v[136:139], v[76:79]
    v_mfma_f32_16x16x32_bf16 v[80:83], v[156:159], v[124:127], v[80:83]
    v_mfma_f32_16x16x32_bf16 v[84:87], v[156:159], v[128:131], v[84:87]
    s_cmp_eq_u32 s3, s42
    s_cbranch_scc1 L_k3own_29
    s_add_u32 s58, s56, 0
    s_add_u32 s59, s56, 2560
    s_add_u32 s60, s56, 5120
    s_add_u32 s61, s56, 7168
    v_cvt_pk_bf16_f32 v16, v16, v17
    v_cvt_pk_bf16_f32 v17, v18, v19
    v_cvt_pk_bf16_f32 v18, v32, v33
    v_cvt_pk_bf16_f32 v19, v34, v35
    buffer_store_dwordx4 v[16:19], v6, s[32:35], s58 offen offset:0 sc1
    v_cvt_pk_bf16_f32 v20, v20, v21
    v_cvt_pk_bf16_f32 v21, v22, v23
    v_cvt_pk_bf16_f32 v22, v36, v37
    v_cvt_pk_bf16_f32 v23, v38, v39
    buffer_store_dwordx4 v[20:23], v6, s[32:35], s59 offen offset:0 sc1
    v_cvt_pk_bf16_f32 v24, v24, v25
    v_cvt_pk_bf16_f32 v25, v26, v27
    v_cvt_pk_bf16_f32 v26, v40, v41
    v_cvt_pk_bf16_f32 v27, v42, v43
    buffer_store_dwordx4 v[24:27], v6, s[32:35], s60 offen offset:0 sc1
    v_cvt_pk_bf16_f32 v28, v28, v29
    v_cvt_pk_bf16_f32 v29, v30, v31
    v_cvt_pk_bf16_f32 v30, v44, v45
    v_cvt_pk_bf16_f32 v31, v46, v47
    buffer_store_dwordx4 v[28:31], v6, s[32:35], s61 offen offset:0 sc1
    v_cvt_pk_bf16_f32 v48, v48, v49
    v_cvt_pk_bf16_f32 v49, v50, v51
    v_cvt_pk_bf16_f32 v50, v64, v65
    v_cvt_pk_bf16_f32 v51, v66, v67
    buffer_store_dwordx4 v[48:51], v6, s[32:35], s58 offen offset:1024 sc1
    v_cvt_pk_bf16_f32 v52, v52, v53
    v_cvt_pk_bf16_f32 v53, v54, v55
    v_cvt_pk_bf16_f32 v54, v68, v69
    v_cvt_pk_bf16_f32 v55, v70, v71
    buffer_store_dwordx4 v[52:55], v6, s[32:35], s59 offen offset:1024 sc1
    v_cvt_pk_bf16_f32 v56, v56, v57
    v_cvt_pk_bf16_f32 v57, v58, v59
    v_cvt_pk_bf16_f32 v58, v72, v73
    v_cvt_pk_bf16_f32 v59, v74, v75
    buffer_store_dwordx4 v[56:59], v6, s[32:35], s60 offen offset:1024 sc1
    v_cvt_pk_bf16_f32 v60, v60, v61
    v_cvt_pk_bf16_f32 v61, v62, v63
    v_cvt_pk_bf16_f32 v62, v76, v77
    v_cvt_pk_bf16_f32 v63, v78, v79
    buffer_store_dwordx4 v[60:63], v6, s[32:35], s61 offen offset:1024 sc1
    v_cvt_pk_bf16_f32 v80, v80, v81
    v_cvt_pk_bf16_f32 v81, v82, v83
    buffer_store_dwordx2 v[80:81], v1, s[32:35], s58 offen offset:2048 sc1
    v_cvt_pk_bf16_f32 v84, v84, v85
    v_cvt_pk_bf16_f32 v85, v86, v87
    buffer_store_dwordx2 v[84:85], v1, s[32:35], s59 offen offset:2048 sc1
    s_branch L_k3sph_30
L_k3own_29:
    s_nop 3
    ds_write_b128 v6, v[16:19] offset:34816
    ds_write_b128 v6, v[20:23] offset:39936
    ds_write_b128 v6, v[24:27] offset:45056
    ds_write_b128 v6, v[28:31] offset:50176
    ds_write_b128 v6, v[32:35] offset:35840
    ds_write_b128 v6, v[36:39] offset:40960
    ds_write_b128 v6, v[40:43] offset:46080
    ds_write_b128 v6, v[44:47] offset:51200
    ds_write_b128 v6, v[48:51] offset:36864
    ds_write_b128 v6, v[52:55] offset:41984
    ds_write_b128 v6, v[56:59] offset:47104
    ds_write_b128 v6, v[60:63] offset:52224
    ds_write_b128 v6, v[64:67] offset:37888
    ds_write_b128 v6, v[68:71] offset:43008
    ds_write_b128 v6, v[72:75] offset:48128
    ds_write_b128 v6, v[76:79] offset:53248
    ds_write_b128 v6, v[80:83] offset:38912
    ds_write_b128 v6, v[84:87] offset:44032
    s_waitcnt vmcnt(0)
L_k3sph_30:
    s_waitcnt vmcnt(10)
    s_waitcnt lgkmcnt(0)
    ds_read_b128 v[108:111], v12 offset:5120
    v_mfma_f32_16x16x32_bf16 v[124:127], v[88:91], v[160:163], 0
    ds_read_b128 v[112:115], v12 offset:6144
    v_mfma_f32_16x16x32_bf16 v[128:131], v[88:91], v[164:167], 0
    ds_read_b128 v[116:119], v12 offset:7168
    v_mfma_f32_16x16x32_bf16 v[132:135], v[92:95], v[160:163], 0
    ds_read_b128 v[120:123], v12 offset:8192
    v_mfma_f32_16x16x32_bf16 v[136:139], v[92:95], v[164:167], 0
    ds_read_b128 v[252:255], v13 offset:5120
    v_mfma_f32_16x16x32_bf16 v[140:143], v[96:99], v[160:163], 0
    v_mfma_f32_16x16x32_bf16 v[144:147], v[96:99], v[164:167], 0
    v_mfma_f32_16x16x32_bf16 v[148:151], v[100:103], v[160:163], 0
    v_mfma_f32_16x16x32_bf16 v[152:155], v[100:103], v[164:167], 0
    v_mfma_f32_16x16x32_bf16 v[156:159], v[104:107], v[160:163], 0
    s_waitcnt lgkmcnt(0)
    ds_read_b128 v[88:91], v12 offset:10240
    v_mfma_f32_16x16x32_bf16 v[124:127], v[108:111], v[168:171], v[124:127]
    ds_read_b128 v[92:95], v12 offset:11264
    v_mfma_f32_16x16x32_bf16 v[128:131], v[108:111], v[172:175], v[128:131]
    ds_read_b128 v[96:99], v12 offset:12288
    v_mfma_f32_16x16x32_bf16 v[132:135], v[112:115], v[168:171], v[132:135]
    ds_read_b128 v[100:103], v12 offset:13312
    v_mfma_f32_16x16x32_bf16 v[136:139], v[112:115], v[172:175], v[136:139]
    ds_read_b128 v[104:107], v13 offset:10240
    v_mfma_f32_16x16x32_bf16 v[140:143], v[116:119], v[168:171], v[140:143]
    v_mfma_f32_16x16x32_bf16 v[144:147], v[116:119], v[172:175], v[144:147]
    v_mfma_f32_16x16x32_bf16 v[148:151], v[120:123], v[168:171], v[148:151]
    v_mfma_f32_16x16x32_bf16 v[152:155], v[120:123], v[172:175], v[152:155]
    v_mfma_f32_16x16x32_bf16 v[156:159], v[252:255], v[168:171], v[156:159]
    s_waitcnt lgkmcnt(0)
    v_mfma_f32_16x16x32_bf16 v[124:127], v[88:91], v[176:179], v[124:127]
    s_barrier
    ds_read_b128 v[108:111], v12 offset:34816
    v_mfma_f32_16x16x32_bf16 v[128:131], v[88:91], v[180:183], v[128:131]
    ds_read_b128 v[112:115], v12 offset:35840
    v_mfma_f32_16x16x32_bf16 v[132:135], v[92:95], v[176:179], v[132:135]
    ds_read_b128 v[116:119], v12 offset:36864
    v_mfma_f32_16x16x32_bf16 v[136:139], v[92:95], v[180:183], v[136:139]
    ds_read_b128 v[120:123], v12 offset:37888
    v_mfma_f32_16x16x32_bf16 v[140:143], v[96:99], v[176:179], v[140:143]
    ds_read_b128 v[252:255], v13 offset:34816
    v_mfma_f32_16x16x32_bf16 v[144:147], v[96:99], v[180:183], v[144:147]
    v_mfma_f32_16x16x32_bf16 v[148:151], v[100:103], v[176:179], v[148:151]
    v_mfma_f32_16x16x32_bf16 v[152:155], v[100:103], v[180:183], v[152:155]
    v_mfma_f32_16x16x32_bf16 v[156:159], v[104:107], v[176:179], v[156:159]
    s_waitcnt lgkmcnt(0)
    ds_read_b128 v[88:91], v12 offset:39936
    v_mfma_f32_16x16x32_bf16 v[124:127], v[108:111], v[184:187], v[124:127]
    ds_read_b128 v[92:95], v12 offset:40960
    v_mfma_f32_16x16x32_bf16 v[128:131], v[108:111], v[188:191], v[128:131]
    ds_read_b128 v[96:99], v12 offset:41984
    v_mfma_f32_16x16x32_bf16 v[132:135], v[112:115], v[184:187], v[132:135]
    ds_read_b128 v[100:103], v12 offset:43008
    v_mfma_f32_16x16x32_bf16 v[136:139], v[112:115], v[188:191], v[136:139]
    ds_read_b128 v[104:107], v13 offset:39936
    v_mfma_f32_16x16x32_bf16 v[140:143], v[116:119], v[184:187], v[140:143]
    v_mfma_f32_16x16x32_bf16 v[144:147], v[116:119], v[188:191], v[144:147]
    v_mfma_f32_16x16x32_bf16 v[148:151], v[120:123], v[184:187], v[148:151]
    v_mfma_f32_16x16x32_bf16 v[152:155], v[120:123], v[188:191], v[152:155]
    v_mfma_f32_16x16x32_bf16 v[156:159], v[252:255], v[184:187], v[156:159]
    s_waitcnt lgkmcnt(0)
    ds_read_b128 v[108:111], v12 offset:45056
    v_mfma_f32_16x16x32_bf16 v[124:127], v[88:91], v[192:195], v[124:127]
    ds_read_b128 v[112:115], v12 offset:46080
    v_mfma_f32_16x16x32_bf16 v[128:131], v[88:91], v[196:199], v[128:131]
    ds_read_b128 v[116:119], v12 offset:47104
    v_mfma_f32_16x16x32_bf16 v[132:135], v[92:95], v[192:195], v[132:135]
    ds_read_b128 v[120:123], v12 offset:48128
    v_mfma_f32_16x16x32_bf16 v[136:139], v[92:95], v[196:199], v[136:139]
    ds_read_b128 v[252:255], v13 offset:45056
    v_mfma_f32_16x16x32_bf16 v[140:143], v[96:99], v[192:195], v[140:143]
    buffer_load_dwordx2 v[16:17], v7, s[16:19], s63 offen offset:0
    v_mfma_f32_16x16x32_bf16 v[144:147], v[96:99], v[196:199], v[144:147]
    buffer_load_dwordx2 v[26:27], v8, s[36:39], s63 offen offset:0
    v_mfma_f32_16x16x32_bf16 v[148:151], v[100:103], v[192:195], v[148:151]
    v_mfma_f32_16x16x32_bf16 v[152:155], v[100:103], v[196:199], v[152:155]
    v_mfma_f32_16x16x32_bf16 v[156:159], v[104:107], v[192:195], v[156:159]
    s_waitcnt lgkmcnt(0)
    v_mfma_f32_16x16x32_bf16 v[124:127], v[108:111], v[200:203], v[124:127]
    s_barrier
    ds_read_b128 v[88:91], v10 offset:0
    v_mfma_f32_16x16x32_bf16 v[128:131], v[108:111], v[204:207], v[128:131]
    ds_read_b128 v[92:95], v10 offset:1024
    v_mfma_f32_16x16x32_bf16 v[132:135], v[112:115], v[200:203], v[132:135]
    ds_read_b128 v[96:99], v10 offset:2048
    v_mfma_f32_16x16x32_bf16 v[136:139], v[112:115], v[204:207], v[136:139]
    ds_read_b128 v[100:103], v10 offset:3072
    v_mfma_f32_16x16x32_bf16 v[140:143], v[116:119], v[200:203], v[140:143]
    ds_read_b128 v[104:107], v11 offset:0
    v_mfma_f32_16x16x32_bf16 v[144:147], v[116:119], v[204:207], v[144:147]
    buffer_load_dwordx2 v[18:19], v7, s[16:19], s63 offen offset:32
    v_mfma_f32_16x16x32_bf16 v[148:151], v[120:123], v[200:203], v[148:151]
    buffer_load_dwordx2 v[28:29], v8, s[36:39], s63 offen offset:32
    v_mfma_f32_16x16x32_bf16 v[152:155], v[120:123], v[204:207], v[152:155]
    v_mfma_f32_16x16x32_bf16 v[156:159], v[252:255], v[200:203], v[156:159]
    s_waitcnt lgkmcnt(0)
    ds_read_b128 v[108:111], v10 offset:5120
    v_mfma_f32_16x16x32_bf16 v[124:127], v[88:91], v[208:211], v[124:127]
    ds_read_b128 v[112:115], v10 offset:6144
    v_mfma_f32_16x16x32_bf16 v[128:131], v[88:91], v[212:215], v[128:131]
    ds_read_b128 v[116:119], v10 offset:7168
    v_mfma_f32_16x16x32_bf16 v[132:135], v[92:95], v[208:211], v[132:135]
    ds_read_b128 v[120:123], v10 offset:8192
    v_mfma_f32_16x16x32_bf16 v[136:139], v[92:95], v[212:215], v[136:139]
    ds_read_b128 v[252:255], v11 offset:5120
    v_mfma_f32_16x16x32_bf16 v[140:143], v[96:99], v[208:211], v[140:143]
    buffer_load_dwordx2 v[20:21], v7, s[16:19], s63 offen offset:64
    v_mfma_f32_16x16x32_bf16 v[144:147], v[96:99], v[212:215], v[144:147]
    buffer_load_dwordx2 v[30:31], v8, s[36:39], s63 offen offset:64
    v_mfma_f32_16x16x32_bf16 v[148:151], v[100:103], v[208:211], v[148:151]
    v_mfma_f32_16x16x32_bf16 v[152:155], v[100:103], v[212:215], v[152:155]
    v_mfma_f32_16x16x32_bf16 v[156:159], v[104:107], v[208:211], v[156:159]
    s_waitcnt lgkmcnt(0)
    ds_read_b128 v[88:91], v10 offset:10240
    v_mfma_f32_16x16x32_bf16 v[124:127], v[108:111], v[216:219], v[124:127]
    ds_read_b128 v[92:95], v10 offset:11264
    v_mfma_f32_16x16x32_bf16 v[128:131], v[108:111], v[220:223], v[128:131]
    ds_read_b128 v[96:99], v10 offset:12288
    v_mfma_f32_16x16x32_bf16 v[132:135], v[112:115], v[216:219], v[132:135]
    ds_read_b128 v[100:103], v10 offset:13312
    v_mfma_f32_16x16x32_bf16 v[136:139], v[112:115], v[220:223], v[136:139]
    ds_read_b128 v[104:107], v11 offset:10240
    v_mfma_f32_16x16x32_bf16 v[140:143], v[116:119], v[216:219], v[140:143]
    buffer_load_dwordx2 v[22:23], v7, s[16:19], s63 offen offset:96
    v_mfma_f32_16x16x32_bf16 v[144:147], v[116:119], v[220:223], v[144:147]
    buffer_load_dwordx2 v[32:33], v8, s[36:39], s63 offen offset:96
    v_mfma_f32_16x16x32_bf16 v[148:151], v[120:123], v[216:219], v[148:151]
    v_mfma_f32_16x16x32_bf16 v[152:155], v[120:123], v[220:223], v[152:155]
    v_mfma_f32_16x16x32_bf16 v[156:159], v[252:255], v[216:219], v[156:159]
    s_waitcnt lgkmcnt(0)
    buffer_load_dwordx2 v[24:25], v7, s[16:19], 0 offen offset:128
    v_mfma_f32_16x16x32_bf16 v[124:127], v[88:91], v[224:227], v[124:127]
    buffer_load_dwordx2 v[34:35], v8, s[36:39], 0 offen offset:128
    v_mfma_f32_16x16x32_bf16 v[128:131], v[88:91], v[228:231], v[128:131]
    v_mfma_f32_16x16x32_bf16 v[132:135], v[92:95], v[224:227], v[132:135]
    v_mfma_f32_16x16x32_bf16 v[136:139], v[92:95], v[228:231], v[136:139]
    v_mfma_f32_16x16x32_bf16 v[140:143], v[96:99], v[224:227], v[140:143]
    v_mfma_f32_16x16x32_bf16 v[144:147], v[96:99], v[228:231], v[144:147]
    v_mfma_f32_16x16x32_bf16 v[148:151], v[100:103], v[224:227], v[148:151]
    v_mfma_f32_16x16x32_bf16 v[152:155], v[100:103], v[228:231], v[152:155]
    v_mfma_f32_16x16x32_bf16 v[156:159], v[104:107], v[224:227], v[156:159]
    s_mov_b32 s66, 0x00003f80
    s_mov_b32 s67, 0x3f800000
    s_add_u32 s58, s57, 0
    s_add_u32 s59, s57, 9216
    s_add_u32 s60, s57, 18432
    s_nop 3
    s_cmp_lg_u32 s46, 0
    s_cbranch_scc1 L_k3kg1_31

    ds_write_b128 v9, v[128:131] offset:1024
    ds_write_b128 v9, v[136:139] offset:3072
    ds_write_b128 v9, v[144:147] offset:5120
    ds_write_b128 v9, v[152:155] offset:7168
    s_waitcnt lgkmcnt(0)
    s_barrier
    ds_read_b128 v[60:63], v9 offset:0
    ds_read_b128 v[64:67], v9 offset:2048
    ds_read_b128 v[68:71], v9 offset:4096
    ds_read_b128 v[72:75], v9 offset:6144
    ds_read_b128 v[76:79], v9 offset:8192
    ds_read_b128 v[40:43], v5 offset:0
    ds_read_b128 v[44:47], v5 offset:1024
    ds_read_b128 v[48:51], v5 offset:2048
    ds_read_b128 v[52:55], v5 offset:3072
    ds_read_b128 v[56:59], v5 offset:4096
    s_waitcnt lgkmcnt(5)
    v_add_f32 v96, v124, v60
    v_add_f32 v97, v125, v61
    v_add_f32 v98, v126, v62
    v_add_f32 v99, v127, v63
    v_add_f32 v100, v132, v64
    v_add_f32 v101, v133, v65
    v_add_f32 v102, v134, v66
    v_add_f32 v103, v135, v67
    v_add_f32 v104, v140, v68
    v_add_f32 v105, v141, v69
    v_add_f32 v106, v142, v70
    v_add_f32 v107, v143, v71
    v_add_f32 v108, v148, v72
    v_add_f32 v109, v149, v73
    v_add_f32 v110, v150, v74
    v_add_f32 v111, v151, v75
    v_add_f32 v112, v156, v76
    v_add_f32 v113, v157, v77
    v_add_f32 v114, v158, v78
    v_add_f32 v115, v159, v79
    s_waitcnt lgkmcnt(0)
    v_mov_b32 v116, v40
    v_mov_b32 v117, v41
    v_mov_b32 v118, v42
    v_mov_b32 v119, v43
    v_mov_b32 v120, v44
    v_mov_b32 v121, v45
    v_mov_b32 v122, v46
    v_mov_b32 v123, v47
    v_mov_b32 v124, v48
    v_mov_b32 v125, v49
    v_mov_b32 v126, v50
    v_mov_b32 v127, v51
    v_mov_b32 v128, v52
    v_mov_b32 v129, v53
    v_mov_b32 v130, v54
    v_mov_b32 v131, v55
    v_mov_b32 v132, v56
    v_mov_b32 v133, v57
    v_mov_b32 v134, v58
    v_mov_b32 v135, v59
    s_waitcnt vmcnt(0)
    buffer_load_dwordx4 v[180:183], v6, s[32:35], s58 offen offset:0 sc1
    buffer_load_dwordx4 v[184:187], v6, s[32:35], s58 offen offset:1024 sc1
    buffer_load_dwordx2 v[188:189], v1, s[32:35], s58 offen offset:2048 sc1
    buffer_load_dwordx4 v[200:203], v6, s[32:35], s59 offen offset:0 sc1
    buffer_load_dwordx4 v[204:207], v6, s[32:35], s59 offen offset:1024 sc1
    buffer_load_dwordx2 v[208:209], v1, s[32:35], s59 offen offset:2048 sc1
    buffer_load_dwordx4 v[220:223], v6, s[32:35], s60 offen offset:0 sc1
    buffer_load_dwordx4 v[224:227], v6, s[32:35], s60 offen offset:1024 sc1
    buffer_load_dwordx2 v[228:229], v1, s[32:35], s60 offen offset:2048 sc1
    v_lshlrev_b32 v160, 16, v26
    v_lshlrev_b32 v136, 16, v16
    v_and_b32 v161, 0xffff0000, v26
    v_and_b32 v137, 0xffff0000, v16
    v_lshlrev_b32 v162, 16, v27
    v_lshlrev_b32 v138, 16, v17
    v_and_b32 v163, 0xffff0000, v27
    v_and_b32 v139, 0xffff0000, v17
    v_lshlrev_b32 v164, 16, v28
    v_lshlrev_b32 v140, 16, v18
    v_and_b32 v165, 0xffff0000, v28
    v_and_b32 v141, 0xffff0000, v18
    v_lshlrev_b32 v166, 16, v29
    v_lshlrev_b32 v142, 16, v19
    v_and_b32 v167, 0xffff0000, v29
    v_and_b32 v143, 0xffff0000, v19
    v_lshlrev_b32 v168, 16, v30
    v_lshlrev_b32 v144, 16, v20
    v_and_b32 v169, 0xffff0000, v30
    v_and_b32 v145, 0xffff0000, v20
    v_lshlrev_b32 v170, 16, v31
    v_lshlrev_b32 v146, 16, v21
    v_and_b32 v171, 0xffff0000, v31
    v_and_b32 v147, 0xffff0000, v21
    v_lshlrev_b32 v172, 16, v32
    v_lshlrev_b32 v148, 16, v22
    v_and_b32 v173, 0xffff0000, v32
    v_and_b32 v149, 0xffff0000, v22
    v_lshlrev_b32 v174, 16, v33
    v_lshlrev_b32 v150, 16, v23
    v_and_b32 v175, 0xffff0000, v33
    v_and_b32 v151, 0xffff0000, v23
    v_lshlrev_b32 v176, 16, v34
    v_lshlrev_b32 v152, 16, v24
    v_and_b32 v177, 0xffff0000, v34
    v_and_b32 v153, 0xffff0000, v24
    v_lshlrev_b32 v178, 16, v35
    v_lshlrev_b32 v154, 16, v25
    v_and_b32 v179, 0xffff0000, v35
    v_and_b32 v155, 0xffff0000, v25
    s_mov_b32 s61, 0
    s_waitcnt vmcnt(6)
L_k3ck_33:
    v_max3_u32 v244, v180, v181, v182
    v_max3_u32 v246, v183, v184, v185
    v_max3_u32 v244, v186, v187, v244
    v_max3_u32 v246, v188, v189, v246
    v_max_u32 v244, v244, v246
    v_cmp_eq_u32 vcc, -1, v244
    s_add_u32 s61, s61, 1
    s_nop 1
    s_cbranch_vccz L_k3ok_34
    s_cmp_ge_u32 s61, 0x10000
    s_cbranch_scc1 L_k3ok_34

    buffer_load_dwordx4 v[180:183], v6, s[32:35], s58 offen offset:0 sc1
    buffer_load_dwordx4 v[184:187], v6, s[32:35], s58 offen offset:1024 sc1
    buffer_load_dwordx2 v[188:189], v1, s[32:35], s58 offen offset:2048 sc1
    s_waitcnt vmcnt(0)
    s_branch L_k3ck_33
L_k3ok_34:
    v_dot2_f32_bf16 v116, v180, s66, v116
    v_dot2_f32_bf16 v117, v180, s67, v117
    v_dot2_f32_bf16 v118, v181, s66, v118
    v_dot2_f32_bf16 v119, v181, s67, v119
    v_dot2_f32_bf16 v120, v182, s66, v120
    v_dot2_f32_bf16 v121, v182, s67, v121
    v_dot2_f32_bf16 v122, v183, s66, v122
    v_dot2_f32_bf16 v123, v183, s67, v123
    v_dot2_f32_bf16 v124, v184, s66, v124
    v_dot2_f32_bf16 v125, v184, s67, v125
    v_dot2_f32_bf16 v126, v185, s66, v126
    v_dot2_f32_bf16 v127, v185, s67, v127
    v_dot2_f32_bf16 v128, v186, s66, v128
    v_dot2_f32_bf16 v129, v186, s67, v129
    v_dot2_f32_bf16 v130, v187, s66, v130
    v_dot2_f32_bf16 v131, v187, s67, v131
    v_dot2_f32_bf16 v132, v188, s66, v132
    v_dot2_f32_bf16 v133, v188, s67, v133
    v_dot2_f32_bf16 v134, v189, s66, v134
    v_dot2_f32_bf16 v135, v189, s67, v135
    s_waitcnt vmcnt(3)
L_k3ck_35:
    v_max3_u32 v244, v200, v201, v202
    v_max3_u32 v246, v203, v204, v205
    v_max3_u32 v244, v206, v207, v244
    v_max3_u32 v246, v208, v209, v246
    v_max_u32 v244, v244, v246
    v_cmp_eq_u32 vcc, -1, v244
    s_add_u32 s61, s61, 1
    s_nop 1
    s_cbranch_vccz L_k3ok_36
    s_cmp_ge_u32 s61, 0x10000
    s_cbranch_scc1 L_k3ok_36

    buffer_load_dwordx4 v[200:203], v6, s[32:35], s59 offen offset:0 sc1
    buffer_load_dwordx4 v[204:207], v6, s[32:35], s59 offen offset:1024 sc1
    buffer_load_dwordx2 v[208:209], v1, s[32:35], s59 offen offset:2048 sc1
    s_waitcnt vmcnt(0)
    s_branch L_k3ck_35
L_k3ok_36:
    v_dot2_f32_bf16 v116, v200, s66, v116
    v_dot2_f32_bf16 v117, v200, s67, v117
    v_dot2_f32_bf16 v118, v201, s66, v118
    v_dot2_f32_bf16 v119, v201, s67, v119
    v_dot2_f32_bf16 v120, v202, s66, v120
    v_dot2_f32_bf16 v121, v202, s67, v121
    v_dot2_f32_bf16 v122, v203, s66, v122
    v_dot2_f32_bf16 v123, v203, s67, v123
    v_dot2_f32_bf16 v124, v204, s66, v124
    v_dot2_f32_bf16 v125, v204, s67, v125
    v_dot2_f32_bf16 v126, v205, s66, v126
    v_dot2_f32_bf16 v127, v205, s67, v127
    v_dot2_f32_bf16 v128, v206, s66, v128
    v_dot2_f32_bf16 v129, v206, s67, v129
    v_dot2_f32_bf16 v130, v207, s66, v130
    v_dot2_f32_bf16 v131, v207, s67, v131
    v_dot2_f32_bf16 v132, v208, s66, v132
    v_dot2_f32_bf16 v133, v208, s67, v133
    v_dot2_f32_bf16 v134, v209, s66, v134
    v_dot2_f32_bf16 v135, v209, s67, v135
    s_waitcnt vmcnt(0)
L_k3ck_37:
    v_max3_u32 v244, v220, v221, v222
    v_max3_u32 v246, v223, v224, v225
    v_max3_u32 v244, v226, v227, v244
    v_max3_u32 v246, v228, v229, v246
    v_max_u32 v244, v244, v246
    v_cmp_eq_u32 vcc, -1, v244
    s_add_u32 s61, s61, 1
    s_nop 1
    s_cbranch_vccz L_k3ok_38
    s_cmp_ge_u32 s61, 0x10000
    s_cbranch_scc1 L_k3ok_38

    buffer_load_dwordx4 v[220:223], v6, s[32:35], s60 offen offset:0 sc1
    buffer_load_dwordx4 v[224:227], v6, s[32:35], s60 offen offset:1024 sc1
    buffer_load_dwordx2 v[228:229], v1, s[32:35], s60 offen offset:2048 sc1
    s_waitcnt vmcnt(0)
    s_branch L_k3ck_37
L_k3ok_38:
    v_dot2_f32_bf16 v116, v220, s66, v116
    v_dot2_f32_bf16 v117, v220, s67, v117
    v_dot2_f32_bf16 v118, v221, s66, v118
    v_dot2_f32_bf16 v119, v221, s67, v119
    v_dot2_f32_bf16 v120, v222, s66, v120
    v_dot2_f32_bf16 v121, v222, s67, v121
    v_dot2_f32_bf16 v122, v223, s66, v122
    v_dot2_f32_bf16 v123, v223, s67, v123
    v_dot2_f32_bf16 v124, v224, s66, v124
    v_dot2_f32_bf16 v125, v224, s67, v125
    v_dot2_f32_bf16 v126, v225, s66, v126
    v_dot2_f32_bf16 v127, v225, s67, v127
    v_dot2_f32_bf16 v128, v226, s66, v128
    v_dot2_f32_bf16 v129, v226, s67, v129
    v_dot2_f32_bf16 v130, v227, s66, v130
    v_dot2_f32_bf16 v131, v227, s67, v131
    v_dot2_f32_bf16 v132, v228, s66, v132
    v_dot2_f32_bf16 v133, v228, s67, v133
    v_dot2_f32_bf16 v134, v229, s66, v134
    v_dot2_f32_bf16 v135, v229, s67, v135
    s_branch L_k3epi_32
L_k3kg1_31:
    ds_write_b128 v9, v[124:127] offset:0
    ds_write_b128 v9, v[132:135] offset:2048
    ds_write_b128 v9, v[140:143] offset:4096
    ds_write_b128 v9, v[148:151] offset:6144
    ds_write_b128 v9, v[156:159] offset:8192
    s_waitcnt lgkmcnt(0)
    s_barrier
    ds_read_b128 v[60:63], v9 offset:1024
    ds_read_b128 v[64:67], v9 offset:3072
    ds_read_b128 v[68:71], v9 offset:5120
    ds_read_b128 v[72:75], v9 offset:7168
    ds_read_b128 v[40:43], v5 offset:0
    ds_read_b128 v[44:47], v5 offset:1024
    ds_read_b128 v[48:51], v5 offset:2048
    ds_read_b128 v[52:55], v5 offset:3072
    s_waitcnt lgkmcnt(4)
    v_add_f32 v96, v128, v60
    v_add_f32 v97, v129, v61
    v_add_f32 v98, v130, v62
    v_add_f32 v99, v131, v63
    v_add_f32 v100, v136, v64
    v_add_f32 v101, v137, v65
    v_add_f32 v102, v138, v66
    v_add_f32 v103, v139, v67
    v_add_f32 v104, v144, v68
    v_add_f32 v105, v145, v69
    v_add_f32 v106, v146, v70
    v_add_f32 v107, v147, v71
    v_add_f32 v108, v152, v72
    v_add_f32 v109, v153, v73
    v_add_f32 v110, v154, v74
    v_add_f32 v111, v155, v75
    s_waitcnt lgkmcnt(0)
    v_mov_b32 v116, v40
    v_mov_b32 v117, v41
    v_mov_b32 v118, v42
    v_mov_b32 v119, v43
    v_mov_b32 v120, v44
    v_mov_b32 v121, v45
    v_mov_b32 v122, v46
    v_mov_b32 v123, v47
    v_mov_b32 v124, v48
    v_mov_b32 v125, v49
    v_mov_b32 v126, v50
    v_mov_b32 v127, v51
    v_mov_b32 v128, v52
    v_mov_b32 v129, v53
    v_mov_b32 v130, v54
    v_mov_b32 v131, v55
    s_waitcnt vmcnt(0)
    buffer_load_dwordx4 v[180:183], v6, s[32:35], s58 offen offset:0 sc1
    buffer_load_dwordx4 v[184:187], v6, s[32:35], s58 offen offset:1024 sc1
    buffer_load_dwordx4 v[200:203], v6, s[32:35], s59 offen offset:0 sc1
    buffer_load_dwordx4 v[204:207], v6, s[32:35], s59 offen offset:1024 sc1
    buffer_load_dwordx4 v[220:223], v6, s[32:35], s60 offen offset:0 sc1
    buffer_load_dwordx4 v[224:227], v6, s[32:35], s60 offen offset:1024 sc1
    v_lshlrev_b32 v160, 16, v26
    v_lshlrev_b32 v136, 16, v16
    v_and_b32 v161, 0xffff0000, v26
    v_and_b32 v137, 0xffff0000, v16
    v_lshlrev_b32 v162, 16, v27
    v_lshlrev_b32 v138, 16, v17
    v_and_b32 v163, 0xffff0000, v27
    v_and_b32 v139, 0xffff0000, v17
    v_lshlrev_b32 v164, 16, v28
    v_lshlrev_b32 v140, 16, v18
    v_and_b32 v165, 0xffff0000, v28
    v_and_b32 v141, 0xffff0000, v18
    v_lshlrev_b32 v166, 16, v29
    v_lshlrev_b32 v142, 16, v19
    v_and_b32 v167, 0xffff0000, v29
    v_and_b32 v143, 0xffff0000, v19
    v_lshlrev_b32 v168, 16, v30
    v_lshlrev_b32 v144, 16, v20
    v_and_b32 v169, 0xffff0000, v30
    v_and_b32 v145, 0xffff0000, v20
    v_lshlrev_b32 v170, 16, v31
    v_lshlrev_b32 v146, 16, v21
    v_and_b32 v171, 0xffff0000, v31
    v_and_b32 v147, 0xffff0000, v21
    v_lshlrev_b32 v172, 16, v32
    v_lshlrev_b32 v148, 16, v22
    v_and_b32 v173, 0xffff0000, v32
    v_and_b32 v149, 0xffff0000, v22
    v_lshlrev_b32 v174, 16, v33
    v_lshlrev_b32 v150, 16, v23
    v_and_b32 v175, 0xffff0000, v33
    v_and_b32 v151, 0xffff0000, v23
    s_mov_b32 s61, 0
    s_waitcnt vmcnt(4)
L_k3ck_39:
    v_max3_u32 v244, v180, v181, v182
    v_max3_u32 v246, v183, v184, v185
    v_max3_u32 v244, v186, v187, v244
    v_max_u32 v244, v244, v246
    v_cmp_eq_u32 vcc, -1, v244
    s_add_u32 s61, s61, 1
    s_nop 1
    s_cbranch_vccz L_k3ok_40
    s_cmp_ge_u32 s61, 0x10000
    s_cbranch_scc1 L_k3ok_40

    buffer_load_dwordx4 v[180:183], v6, s[32:35], s58 offen offset:0 sc1
    buffer_load_dwordx4 v[184:187], v6, s[32:35], s58 offen offset:1024 sc1
    s_waitcnt vmcnt(0)
    s_branch L_k3ck_39
L_k3ok_40:
    v_dot2_f32_bf16 v116, v180, s66, v116
    v_dot2_f32_bf16 v117, v180, s67, v117
    v_dot2_f32_bf16 v118, v181, s66, v118
    v_dot2_f32_bf16 v119, v181, s67, v119
    v_dot2_f32_bf16 v120, v182, s66, v120
    v_dot2_f32_bf16 v121, v182, s67, v121
    v_dot2_f32_bf16 v122, v183, s66, v122
    v_dot2_f32_bf16 v123, v183, s67, v123
    v_dot2_f32_bf16 v124, v184, s66, v124
    v_dot2_f32_bf16 v125, v184, s67, v125
    v_dot2_f32_bf16 v126, v185, s66, v126
    v_dot2_f32_bf16 v127, v185, s67, v127
    v_dot2_f32_bf16 v128, v186, s66, v128
    v_dot2_f32_bf16 v129, v186, s67, v129
    v_dot2_f32_bf16 v130, v187, s66, v130
    v_dot2_f32_bf16 v131, v187, s67, v131
    s_waitcnt vmcnt(2)
L_k3ck_41:
    v_max3_u32 v244, v200, v201, v202
    v_max3_u32 v246, v203, v204, v205
    v_max3_u32 v244, v206, v207, v244
    v_max_u32 v244, v244, v246
    v_cmp_eq_u32 vcc, -1, v244
    s_add_u32 s61, s61, 1
    s_nop 1
    s_cbranch_vccz L_k3ok_42
    s_cmp_ge_u32 s61, 0x10000
    s_cbranch_scc1 L_k3ok_42

    buffer_load_dwordx4 v[200:203], v6, s[32:35], s59 offen offset:0 sc1
    buffer_load_dwordx4 v[204:207], v6, s[32:35], s59 offen offset:1024 sc1
    s_waitcnt vmcnt(0)
    s_branch L_k3ck_41
L_k3ok_42:
    v_dot2_f32_bf16 v116, v200, s66, v116
    v_dot2_f32_bf16 v117, v200, s67, v117
    v_dot2_f32_bf16 v118, v201, s66, v118
    v_dot2_f32_bf16 v119, v201, s67, v119
    v_dot2_f32_bf16 v120, v202, s66, v120
    v_dot2_f32_bf16 v121, v202, s67, v121
    v_dot2_f32_bf16 v122, v203, s66, v122
    v_dot2_f32_bf16 v123, v203, s67, v123
    v_dot2_f32_bf16 v124, v204, s66, v124
    v_dot2_f32_bf16 v125, v204, s67, v125
    v_dot2_f32_bf16 v126, v205, s66, v126
    v_dot2_f32_bf16 v127, v205, s67, v127
    v_dot2_f32_bf16 v128, v206, s66, v128
    v_dot2_f32_bf16 v129, v206, s67, v129
    v_dot2_f32_bf16 v130, v207, s66, v130
    v_dot2_f32_bf16 v131, v207, s67, v131
    s_waitcnt vmcnt(0)
L_k3ck_43:
    v_max3_u32 v244, v220, v221, v222
    v_max3_u32 v246, v223, v224, v225
    v_max3_u32 v244, v226, v227, v244
    v_max_u32 v244, v244, v246
    v_cmp_eq_u32 vcc, -1, v244
    s_add_u32 s61, s61, 1
    s_nop 1
    s_cbranch_vccz L_k3ok_44
    s_cmp_ge_u32 s61, 0x10000
    s_cbranch_scc1 L_k3ok_44

    buffer_load_dwordx4 v[220:223], v6, s[32:35], s60 offen offset:0 sc1
    buffer_load_dwordx4 v[224:227], v6, s[32:35], s60 offen offset:1024 sc1
    s_waitcnt vmcnt(0)
    s_branch L_k3ck_43
L_k3ok_44:
    v_dot2_f32_bf16 v116, v220, s66, v116
    v_dot2_f32_bf16 v117, v220, s67, v117
    v_dot2_f32_bf16 v118, v221, s66, v118
    v_dot2_f32_bf16 v119, v221, s67, v119
    v_dot2_f32_bf16 v120, v222, s66, v120
    v_dot2_f32_bf16 v121, v222, s67, v121
    v_dot2_f32_bf16 v122, v223, s66, v122
    v_dot2_f32_bf16 v123, v223, s67, v123
    v_dot2_f32_bf16 v124, v224, s66, v124
    v_dot2_f32_bf16 v125, v224, s67, v125
    v_dot2_f32_bf16 v126, v225, s66, v126
    v_dot2_f32_bf16 v127, v225, s67, v127
    v_dot2_f32_bf16 v128, v226, s66, v128
    v_dot2_f32_bf16 v129, v226, s67, v129
    v_dot2_f32_bf16 v130, v227, s66, v130
    v_dot2_f32_bf16 v131, v227, s67, v131
L_k3epi_32:
    v_cvt_pk_bf16_f32 v16, v116, v96
    v_cvt_pk_bf16_f32 v20, v117, v97
    v_cvt_pk_bf16_f32 v24, v118, v98
    v_cvt_pk_bf16_f32 v28, v119, v99
    v_cvt_pk_bf16_f32 v32, v120, v100
    v_cvt_pk_bf16_f32 v36, v121, v101
    v_cvt_pk_bf16_f32 v40, v122, v102
    v_cvt_pk_bf16_f32 v44, v123, v103
    v_cvt_pk_bf16_f32 v48, v124, v104
    v_cvt_pk_bf16_f32 v52, v125, v105
    v_cvt_pk_bf16_f32 v56, v126, v106
    v_cvt_pk_bf16_f32 v60, v127, v107
    v_cvt_pk_bf16_f32 v64, v128, v108
    v_cvt_pk_bf16_f32 v68, v129, v109
    v_cvt_pk_bf16_f32 v72, v130, v110
    v_cvt_pk_bf16_f32 v76, v131, v111
    v_cvt_pk_bf16_f32 v80, v132, v112
    v_cvt_pk_bf16_f32 v84, v133, v113
    v_cvt_pk_bf16_f32 v88, v134, v114
    v_cvt_pk_bf16_f32 v92, v135, v115
    v_dot2_f32_bf16 v116, v16, s66, v160
    v_dot2_f32_bf16 v117, v20, s66, v161
    v_dot2_f32_bf16 v118, v24, s66, v162
    v_dot2_f32_bf16 v119, v28, s66, v163
    v_dot2_f32_bf16 v120, v32, s66, v164
    v_dot2_f32_bf16 v121, v36, s66, v165
    v_dot2_f32_bf16 v122, v40, s66, v166
    v_dot2_f32_bf16 v123, v44, s66, v167
    v_dot2_f32_bf16 v124, v48, s66, v168
    v_dot2_f32_bf16 v125, v52, s66, v169
    v_dot2_f32_bf16 v126, v56, s66, v170
    v_dot2_f32_bf16 v127, v60, s66, v171
    v_dot2_f32_bf16 v128, v64, s66, v172
    v_dot2_f32_bf16 v129, v68, s66, v173
    v_dot2_f32_bf16 v130, v72, s66, v174
    v_dot2_f32_bf16 v131, v76, s66, v175
    v_dot2_f32_bf16 v132, v80, s66, v176
    v_dot2_f32_bf16 v133, v84, s66, v177
    v_dot2_f32_bf16 v134, v88, s66, v178
    v_dot2_f32_bf16 v135, v92, s66, v179
    v_cvt_pk_bf16_f32 v17, v116, v117
    v_cvt_pk_bf16_f32 v25, v118, v119
    v_cvt_pk_bf16_f32 v33, v120, v121
    v_cvt_pk_bf16_f32 v41, v122, v123
    v_cvt_pk_bf16_f32 v49, v124, v125
    v_cvt_pk_bf16_f32 v57, v126, v127
    v_cvt_pk_bf16_f32 v65, v128, v129
    v_cvt_pk_bf16_f32 v73, v130, v131
    v_cvt_pk_bf16_f32 v81, v132, v133
    v_cvt_pk_bf16_f32 v89, v134, v135
    v_lshlrev_b32 v116, 16, v17
    v_and_b32 v117, 0xffff0000, v17
    v_lshlrev_b32 v118, 16, v25
    v_and_b32 v119, 0xffff0000, v25
    v_lshlrev_b32 v120, 16, v33
    v_and_b32 v121, 0xffff0000, v33
    v_lshlrev_b32 v122, 16, v41
    v_and_b32 v123, 0xffff0000, v41
    v_lshlrev_b32 v124, 16, v49
    v_and_b32 v125, 0xffff0000, v49
    v_lshlrev_b32 v126, 16, v57
    v_and_b32 v127, 0xffff0000, v57
    v_lshlrev_b32 v128, 16, v65
    v_and_b32 v129, 0xffff0000, v65
    v_lshlrev_b32 v130, 16, v73
    v_and_b32 v131, 0xffff0000, v73
    v_lshlrev_b32 v132, 16, v81
    v_and_b32 v133, 0xffff0000, v81
    v_lshlrev_b32 v134, 16, v89
    v_and_b32 v135, 0xffff0000, v89
    v_mul_f32 v18, 0xbfb8aa3b, v116
    v_mul_f32 v22, 0xbfb8aa3b, v117
    v_mul_f32 v26, 0xbfb8aa3b, v118
    v_mul_f32 v30, 0xbfb8aa3b, v119
    v_mul_f32 v34, 0xbfb8aa3b, v120
    v_mul_f32 v38, 0xbfb8aa3b, v121
    v_mul_f32 v42, 0xbfb8aa3b, v122
    v_mul_f32 v46, 0xbfb8aa3b, v123
    v_mul_f32 v50, 0xbfb8aa3b, v124
    v_mul_f32 v54, 0xbfb8aa3b, v125
    v_mul_f32 v58, 0xbfb8aa3b, v126
    v_mul_f32 v62, 0xbfb8aa3b, v127
    v_mul_f32 v66, 0xbfb8aa3b, v128
    v_mul_f32 v70, 0xbfb8aa3b, v129
    v_mul_f32 v74, 0xbfb8aa3b, v130
    v_mul_f32 v78, 0xbfb8aa3b, v131
    v_mul_f32 v82, 0xbfb8aa3b, v132
    v_mul_f32 v86, 0xbfb8aa3b, v133
    v_mul_f32 v90, 0xbfb8aa3b, v134
    v_mul_f32 v94, 0xbfb8aa3b, v135
    v_exp_f32 v18, v18
    v_exp_f32 v22, v22
    v_exp_f32 v26, v26
    v_exp_f32 v30, v30
    v_exp_f32 v34, v34
    v_exp_f32 v38, v38
    v_exp_f32 v42, v42
    v_exp_f32 v46, v46
    v_exp_f32 v50, v50
    v_exp_f32 v54, v54
    v_exp_f32 v58, v58
    v_exp_f32 v62, v62
    v_exp_f32 v66, v66
    v_exp_f32 v70, v70
    v_exp_f32 v74, v74
    v_exp_f32 v78, v78
    v_exp_f32 v82, v82
    v_exp_f32 v86, v86
    v_exp_f32 v90, v90
    v_exp_f32 v94, v94
    v_add_f32 v18, 1.0, v18
    v_add_f32 v22, 1.0, v22
    v_add_f32 v26, 1.0, v26
    v_add_f32 v30, 1.0, v30
    v_add_f32 v34, 1.0, v34
    v_add_f32 v38, 1.0, v38
    v_add_f32 v42, 1.0, v42
    v_add_f32 v46, 1.0, v46
    v_add_f32 v50, 1.0, v50
    v_add_f32 v54, 1.0, v54
    v_add_f32 v58, 1.0, v58
    v_add_f32 v62, 1.0, v62
    v_add_f32 v66, 1.0, v66
    v_add_f32 v70, 1.0, v70
    v_add_f32 v74, 1.0, v74
    v_add_f32 v78, 1.0, v78
    v_add_f32 v82, 1.0, v82
    v_add_f32 v86, 1.0, v86
    v_add_f32 v90, 1.0, v90
    v_add_f32 v94, 1.0, v94
    v_rcp_f32 v18, v18
    v_rcp_f32 v22, v22
    v_rcp_f32 v26, v26
    v_rcp_f32 v30, v30
    v_rcp_f32 v34, v34
    v_rcp_f32 v38, v38
    v_rcp_f32 v42, v42
    v_rcp_f32 v46, v46
    v_rcp_f32 v50, v50
    v_rcp_f32 v54, v54
    v_rcp_f32 v58, v58
    v_rcp_f32 v62, v62
    v_rcp_f32 v66, v66
    v_rcp_f32 v70, v70
    v_rcp_f32 v74, v74
    v_rcp_f32 v78, v78
    v_rcp_f32 v82, v82
    v_rcp_f32 v86, v86
    v_rcp_f32 v90, v90
    v_rcp_f32 v94, v94
    v_mul_f32 v18, v116, v18
    v_mul_f32 v22, v117, v22
    v_mul_f32 v26, v118, v26
    v_mul_f32 v30, v119, v30
    v_mul_f32 v34, v120, v34
    v_mul_f32 v38, v121, v38
    v_mul_f32 v42, v122, v42
    v_mul_f32 v46, v123, v46
    v_mul_f32 v50, v124, v50
    v_mul_f32 v54, v125, v54
    v_mul_f32 v58, v126, v58
    v_mul_f32 v62, v127, v62
    v_mul_f32 v66, v128, v66
    v_mul_f32 v70, v129, v70
    v_mul_f32 v74, v130, v74
    v_mul_f32 v78, v131, v78
    v_mul_f32 v82, v132, v82
    v_mul_f32 v86, v133, v86
    v_mul_f32 v90, v134, v90
    v_mul_f32 v94, v135, v94
    v_cvt_pk_bf16_f32 v18, 0, v18
    v_cvt_pk_bf16_f32 v22, 0, v22
    v_cvt_pk_bf16_f32 v26, 0, v26
    v_cvt_pk_bf16_f32 v30, 0, v30
    v_cvt_pk_bf16_f32 v34, 0, v34
    v_cvt_pk_bf16_f32 v38, 0, v38
    v_cvt_pk_bf16_f32 v42, 0, v42
    v_cvt_pk_bf16_f32 v46, 0, v46
    v_cvt_pk_bf16_f32 v50, 0, v50
    v_cvt_pk_bf16_f32 v54, 0, v54
    v_cvt_pk_bf16_f32 v58, 0, v58
    v_cvt_pk_bf16_f32 v62, 0, v62
    v_cvt_pk_bf16_f32 v66, 0, v66
    v_cvt_pk_bf16_f32 v70, 0, v70
    v_cvt_pk_bf16_f32 v74, 0, v74
    v_cvt_pk_bf16_f32 v78, 0, v78
    v_cvt_pk_bf16_f32 v82, 0, v82
    v_cvt_pk_bf16_f32 v86, 0, v86
    v_cvt_pk_bf16_f32 v90, 0, v90
    v_cvt_pk_bf16_f32 v94, 0, v94
    v_dot2_f32_bf16 v116, v16, v18, 0
    v_dot2_f32_bf16 v117, v20, v22, 0
    v_dot2_f32_bf16 v118, v24, v26, 0
    v_dot2_f32_bf16 v119, v28, v30, 0
    v_dot2_f32_bf16 v120, v32, v34, 0
    v_dot2_f32_bf16 v121, v36, v38, 0
    v_dot2_f32_bf16 v122, v40, v42, 0
    v_dot2_f32_bf16 v123, v44, v46, 0
    v_dot2_f32_bf16 v124, v48, v50, 0
    v_dot2_f32_bf16 v125, v52, v54, 0
    v_dot2_f32_bf16 v126, v56, v58, 0
    v_dot2_f32_bf16 v127, v60, v62, 0
    v_dot2_f32_bf16 v128, v64, v66, 0
    v_dot2_f32_bf16 v129, v68, v70, 0
    v_dot2_f32_bf16 v130, v72, v74, 0
    v_dot2_f32_bf16 v131, v76, v78, 0
    v_dot2_f32_bf16 v132, v80, v82, 0
    v_dot2_f32_bf16 v133, v84, v86, 0
    v_dot2_f32_bf16 v134, v88, v90, 0
    v_dot2_f32_bf16 v135, v92, v94, 0
    v_cvt_pk_bf16_f32 v17, v116, v117
    v_cvt_pk_bf16_f32 v25, v118, v119
    v_cvt_pk_bf16_f32 v33, v120, v121
    v_cvt_pk_bf16_f32 v41, v122, v123
    v_cvt_pk_bf16_f32 v49, v124, v125
    v_cvt_pk_bf16_f32 v57, v126, v127
    v_cvt_pk_bf16_f32 v65, v128, v129
    v_cvt_pk_bf16_f32 v73, v130, v131
    v_cvt_pk_bf16_f32 v81, v132, v133
    v_cvt_pk_bf16_f32 v89, v134, v135
    v_dot2_f32_bf16 v116, v17, s66, v136
    v_dot2_f32_bf16 v117, v17, s67, v137
    v_dot2_f32_bf16 v118, v25, s66, v138
    v_dot2_f32_bf16 v119, v25, s67, v139
    v_dot2_f32_bf16 v120, v33, s66, v140
    v_dot2_f32_bf16 v121, v33, s67, v141
    v_dot2_f32_bf16 v122, v41, s66, v142
    v_dot2_f32_bf16 v123, v41, s67, v143
    v_dot2_f32_bf16 v124, v49, s66, v144
    v_dot2_f32_bf16 v125, v49, s67, v145
    v_dot2_f32_bf16 v126, v57, s66, v146
    v_dot2_f32_bf16 v127, v57, s67, v147
    v_dot2_f32_bf16 v128, v65, s66, v148
    v_dot2_f32_bf16 v129, v65, s67, v149
    v_dot2_f32_bf16 v130, v73, s66, v150
    v_dot2_f32_bf16 v131, v73, s67, v151
    v_dot2_f32_bf16 v132, v81, s66, v152
    v_dot2_f32_bf16 v133, v81, s67, v153
    v_dot2_f32_bf16 v134, v89, s66, v154
    v_dot2_f32_bf16 v135, v89, s67, v155
    s_nop 2
    v_cvt_pk_bf16_f32 v180, v116, v117
    v_cvt_pk_bf16_f32 v181, v118, v119
    buffer_store_dwordx2 v[180:181], v7, s[48:51], s63 offen offset:0
    v_cvt_pk_bf16_f32 v182, v120, v121
    v_cvt_pk_bf16_f32 v183, v122, v123
    buffer_store_dwordx2 v[182:183], v7, s[48:51], s63 offen offset:32
    v_cvt_pk_bf16_f32 v184, v124, v125
    v_cvt_pk_bf16_f32 v185, v126, v127
    buffer_store_dwordx2 v[184:185], v7, s[48:51], s63 offen offset:64
    v_cvt_pk_bf16_f32 v186, v128, v129
    v_cvt_pk_bf16_f32 v187, v130, v131
    buffer_store_dwordx2 v[186:187], v7, s[48:51], s63 offen offset:96
    s_cmp_lg_u32 s46, 0
    s_cbranch_scc1 L_k3fin_45
    v_cvt_pk_bf16_f32 v188, v132, v133
    v_cvt_pk_bf16_f32 v189, v134, v135
    buffer_store_dwordx2 v[188:189], v7, s[48:51], 0 offen offset:128
L_k3fin_45:
    s_endpgm
L_k3prod0_18:
    s_lshl_b32 s47, s43, 11
    v_add_u32 v5, s47, v6
    s_mul_i32 s50, s42, 144
    s_add_u32 s50, s50, 72
    s_lshl_b32 s50, s50, 15
    s_add_u32 s51, s50, 30720

    s_mul_i32 s54, s44, 1492992
    s_lshl_b32 s47, s41, 12
    s_add_u32 s54, s54, s47
    s_add_u32 s54, s54, 0
    s_add_u32 s55, s54, 4096

    s_lshl_b32 s47, s41, 2
    s_add_u32 s47, s47, s44
    s_mul_i32 s47, s47, 9
    s_add_u32 s47, s47, 72
    s_lshl_b32 s56, s47, 15
    s_lshl_b32 s47, s43, 11
    s_add_u32 s56, s56, s47
    s_lshl_b32 s47, s40, 10
    s_add_u32 s56, s56, s47
    s_sub_u32 s56, s56, 256

    v_add_u32 v7, 0, v2
    v_mul_u32_u24 v8, 52429, v7
    v_lshrrev_b32 v8, 22, v8
    v_mul_u32_u24 v9, 80, v8
    v_sub_u32 v7, v7, v9
    v_lshlrev_b32 v7, 4, v7
    v_lshl_add_u32 v7, v8, 15, v7
    v_add_u32 v9, 2064384, v7
    v_cmp_le_u32 vcc, 9, v8
    s_mov_b32 m0, 139264
    s_nop 1
    v_cndmask_b32 v7, v7, v9, vcc
    buffer_load_dwordx4 v7, s[24:27], s56 offen lds

    v_add_u32 v7, 256, v2
    v_mul_u32_u24 v8, 52429, v7
    v_lshrrev_b32 v8, 22, v8
    v_mul_u32_u24 v9, 80, v8
    v_sub_u32 v7, v7, v9
    v_lshlrev_b32 v7, 4, v7
    v_lshl_add_u32 v7, v8, 15, v7
    v_add_u32 v9, 2064384, v7
    v_cmp_le_u32 vcc, 9, v8
    s_mov_b32 m0, 143360
    s_nop 1
    v_cndmask_b32 v7, v7, v9, vcc
    buffer_load_dwordx4 v7, s[24:27], s56 offen lds

    v_add_u32 v7, 512, v2
    v_mul_u32_u24 v8, 52429, v7
    v_lshrrev_b32 v8, 22, v8
    v_mul_u32_u24 v9, 80, v8
    v_sub_u32 v7, v7, v9
    v_lshlrev_b32 v7, 4, v7
    v_lshl_add_u32 v7, v8, 15, v7
    v_add_u32 v9, 2064384, v7
    v_cmp_le_u32 vcc, 9, v8
    s_mov_b32 m0, 147456
    s_nop 1
    v_cndmask_b32 v7, v7, v9, vcc
    buffer_load_dwordx4 v7, s[24:27], s56 offen lds

    v_add_u32 v7, 768, v2
    v_mul_u32_u24 v8, 52429, v7
    v_lshrrev_b32 v8, 22, v8
    v_mul_u32_u24 v9, 80, v8
    v_sub_u32 v7, v7, v9
    v_lshlrev_b32 v7, 4, v7
    v_lshl_add_u32 v7, v8, 15, v7
    v_add_u32 v9, 2064384, v7
    v_cmp_le_u32 vcc, 9, v8
    s_mov_b32 m0, 151552
    s_nop 1
    v_cndmask_b32 v7, v7, v9, vcc
    buffer_load_dwordx4 v7, s[24:27], s56 offen lds

    v_add_u32 v7, 1024, v2
    v_mul_u32_u24 v8, 52429, v7
    v_lshrrev_b32 v8, 22, v8
    v_mul_u32_u24 v9, 80, v8
    v_sub_u32 v7, v7, v9
    v_lshlrev_b32 v7, 4, v7
    v_lshl_add_u32 v7, v8, 15, v7
    v_add_u32 v9, 2064384, v7
    v_cmp_le_u32 vcc, 9, v8
    s_mov_b32 m0, 155648
    s_nop 1
    v_cndmask_b32 v7, v7, v9, vcc
    buffer_load_dwordx4 v7, s[24:27], s56 offen lds

    v_add_u32 v7, 1280, v2
    v_mul_u32_u24 v8, 52429, v7
    v_lshrrev_b32 v8, 22, v8
    v_mul_u32_u24 v9, 80, v8
    v_sub_u32 v7, v7, v9
    v_lshlrev_b32 v7, 4, v7
    v_lshl_add_u32 v7, v8, 15, v7
    v_add_u32 v9, 2064384, v7
    v_cmp_le_u32 vcc, 9, v8
    s_mov_b32 m0, 159744
    s_nop 1
    v_cndmask_b32 v7, v7, v9, vcc
    buffer_load_dwordx4 v7, s[24:27], s56 offen lds

    s_mov_b32 m0, 0
    s_nop 0
    buffer_load_dwordx4 v5, s[28:31], s50 offen lds
    buffer_load_dwordx4 v5, s[28:31], s50 offen offset:1024 lds
    buffer_load_dwordx4 v5, s[28:31], s51 offen offset:2048 lds
    buffer_load_dwordx4 v5, s[28:31], s51 offen offset:3072 lds
    s_add_u32 s50, s50, 131072
    s_add_u32 s51, s51, 131072
    s_mov_b32 m0, 17408
    s_nop 0
    buffer_load_dwordx4 v5, s[28:31], s50 offen lds
    buffer_load_dwordx4 v5, s[28:31], s50 offen offset:1024 lds
    buffer_load_dwordx4 v5, s[28:31], s51 offen offset:2048 lds
    buffer_load_dwordx4 v5, s[28:31], s51 offen offset:3072 lds
    s_add_u32 s50, s50, 131072
    s_add_u32 s51, s51, 131072
    s_mov_b32 m0, 34816
    s_nop 0
    buffer_load_dwordx4 v5, s[28:31], s50 offen lds
    buffer_load_dwordx4 v5, s[28:31], s50 offen offset:1024 lds
    buffer_load_dwordx4 v5, s[28:31], s51 offen offset:2048 lds
    buffer_load_dwordx4 v5, s[28:31], s51 offen offset:3072 lds
    s_add_u32 s50, s50, 131072
    s_add_u32 s51, s51, 131072
    s_waitcnt vmcnt(12)
    s_barrier
    s_mov_b32 m0, 52224
    s_nop 0
    buffer_load_dwordx4 v5, s[28:31], s50 offen lds
    buffer_load_dwordx4 v5, s[28:31], s50 offen offset:1024 lds
    buffer_load_dwordx4 v5, s[28:31], s51 offen offset:2048 lds
    buffer_load_dwordx4 v5, s[28:31], s51 offen offset:3072 lds
    s_add_u32 s50, s50, 131072
    s_add_u32 s51, s51, 131072
    s_mov_b32 m0, 69632
    s_nop 0
    buffer_load_dwordx4 v5, s[28:31], s50 offen lds
    buffer_load_dwordx4 v5, s[28:31], s50 offen offset:1024 lds
    buffer_load_dwordx4 v5, s[28:31], s51 offen offset:2048 lds
    buffer_load_dwordx4 v5, s[28:31], s51 offen offset:3072 lds
    s_add_u32 s50, s50, 131072
    s_add_u32 s51, s51, 131072
    s_mov_b32 m0, 87040
    s_nop 0
    buffer_load_dwordx4 v5, s[28:31], s50 offen lds
    buffer_load_dwordx4 v5, s[28:31], s50 offen offset:1024 lds
    buffer_load_dwordx4 v5, s[28:31], s51 offen offset:2048 lds
    buffer_load_dwordx4 v5, s[28:31], s51 offen offset:3072 lds
    s_add_u32 s50, s50, 131072
    s_add_u32 s51, s51, 131072
    s_mov_b32 m0, 104448
    s_nop 0
    buffer_load_dwordx4 v5, s[28:31], s50 offen lds
    buffer_load_dwordx4 v5, s[28:31], s50 offen offset:1024 lds
    buffer_load_dwordx4 v5, s[28:31], s51 offen offset:2048 lds
    buffer_load_dwordx4 v5, s[28:31], s51 offen offset:3072 lds
    s_add_u32 s50, s50, 131072
    s_add_u32 s51, s51, 131072
    s_mov_b32 m0, 121856
    s_nop 0
    buffer_load_dwordx4 v5, s[28:31], s50 offen lds
    buffer_load_dwordx4 v5, s[28:31], s50 offen offset:1024 lds
    buffer_load_dwordx4 v5, s[28:31], s51 offen offset:2048 lds
    buffer_load_dwordx4 v5, s[28:31], s51 offen offset:3072 lds
    s_add_u32 s50, s50, 131072
    s_add_u32 s51, s51, 131072
    s_waitcnt vmcnt(28)
    s_barrier
    s_waitcnt vmcnt(24)
    s_barrier
    s_mov_b32 m0, 0
    s_nop 0
    buffer_load_dwordx4 v5, s[28:31], s50 offen lds
    buffer_load_dwordx4 v5, s[28:31], s50 offen offset:1024 lds
    buffer_load_dwordx4 v5, s[28:31], s51 offen offset:2048 lds
    buffer_load_dwordx4 v5, s[28:31], s51 offen offset:3072 lds
    s_add_u32 s50, s50, 131072
    s_add_u32 s51, s51, 131072
    s_waitcnt vmcnt(20)
    s_barrier
    s_mov_b32 m0, 17408
    s_nop 0
    buffer_load_dwordx4 v5, s[28:31], s50 offen lds
    buffer_load_dwordx4 v5, s[28:31], s50 offen offset:1024 lds
    buffer_load_dwordx4 v5, s[28:31], s51 offen offset:2048 lds
    buffer_load_dwordx4 v5, s[28:31], s51 offen offset:3072 lds
    s_add_u32 s50, s50, 131072
    s_add_u32 s51, s51, 131072
    s_waitcnt vmcnt(16)
    s_barrier
    s_mov_b32 m0, 34816
    s_nop 0
    buffer_load_dwordx4 v5, s[28:31], s50 offen lds
    buffer_load_dwordx4 v5, s[28:31], s50 offen offset:1024 lds
    buffer_load_dwordx4 v5, s[28:31], s51 offen offset:2048 lds
    buffer_load_dwordx4 v5, s[28:31], s51 offen offset:3072 lds
    s_add_u32 s50, s50, 131072
    s_add_u32 s51, s51, 131072
    s_mov_b32 m0, 52224
    s_nop 0
    buffer_load_dwordx4 v5, s[28:31], s50 offen lds
    buffer_load_dwordx4 v5, s[28:31], s50 offen offset:1024 lds
    buffer_load_dwordx4 v5, s[28:31], s51 offen offset:2048 lds
    buffer_load_dwordx4 v5, s[28:31], s51 offen offset:3072 lds
    s_add_u32 s50, s50, 131072
    s_add_u32 s51, s51, 131072
    s_waitcnt vmcnt(16)
    s_barrier
    s_mov_b32 m0, 69632
    s_nop 0
    buffer_load_dwordx4 v5, s[28:31], s50 offen lds
    buffer_load_dwordx4 v5, s[28:31], s50 offen offset:1024 lds
    buffer_load_dwordx4 v5, s[28:31], s51 offen offset:2048 lds
    buffer_load_dwordx4 v5, s[28:31], s51 offen offset:3072 lds
    s_add_u32 s50, s50, 131072
    s_add_u32 s51, s51, 131072
    s_mov_b32 m0, 87040
    s_nop 0
    buffer_load_dwordx4 v5, s[28:31], s50 offen lds
    buffer_load_dwordx4 v5, s[28:31], s50 offen offset:1024 lds
    buffer_load_dwordx4 v5, s[28:31], s51 offen offset:2048 lds
    buffer_load_dwordx4 v5, s[28:31], s51 offen offset:3072 lds
    s_add_u32 s50, s50, 131072
    s_add_u32 s51, s51, 131072
    s_waitcnt vmcnt(16)
    s_barrier
    s_mov_b32 m0, 104448
    s_nop 0
    buffer_load_dwordx4 v5, s[28:31], s50 offen lds
    buffer_load_dwordx4 v5, s[28:31], s50 offen offset:1024 lds
    buffer_load_dwordx4 v5, s[28:31], s51 offen offset:2048 lds
    buffer_load_dwordx4 v5, s[28:31], s51 offen offset:3072 lds
    s_add_u32 s50, s50, 131072
    s_add_u32 s51, s51, 131072
    s_mov_b32 m0, 121856
    s_nop 0
    buffer_load_dwordx4 v5, s[28:31], s50 offen lds
    buffer_load_dwordx4 v5, s[28:31], s50 offen offset:1024 lds
    buffer_load_dwordx4 v5, s[28:31], s51 offen offset:2048 lds
    buffer_load_dwordx4 v5, s[28:31], s51 offen offset:3072 lds
    s_add_u32 s50, s50, 131072
    s_add_u32 s51, s51, 131072
    s_waitcnt vmcnt(16)
    s_barrier
    s_mov_b32 m0, 0
    s_nop 0
    buffer_load_dwordx4 v5, s[28:31], s50 offen lds
    buffer_load_dwordx4 v5, s[28:31], s50 offen offset:1024 lds
    buffer_load_dwordx4 v5, s[28:31], s51 offen offset:2048 lds
    buffer_load_dwordx4 v5, s[28:31], s51 offen offset:3072 lds
    s_add_u32 s50, s50, 131072
    s_add_u32 s51, s51, 131072
    s_mov_b32 m0, 17408
    s_nop 0
    buffer_load_dwordx4 v5, s[28:31], s50 offen lds
    buffer_load_dwordx4 v5, s[28:31], s50 offen offset:1024 lds
    buffer_load_dwordx4 v5, s[28:31], s51 offen offset:2048 lds
    buffer_load_dwordx4 v5, s[28:31], s51 offen offset:3072 lds
    s_add_u32 s50, s50, 131072
    s_add_u32 s51, s51, 131072
    s_waitcnt vmcnt(16)
    s_barrier
    s_mov_b32 m0, 34816
    s_nop 0
    buffer_load_dwordx4 v5, s[28:31], s50 offen lds
    buffer_load_dwordx4 v5, s[28:31], s50 offen offset:1024 lds
    buffer_load_dwordx4 v5, s[28:31], s51 offen offset:2048 lds
    buffer_load_dwordx4 v5, s[28:31], s51 offen offset:3072 lds
    s_add_u32 s50, s50, 131072
    s_add_u32 s51, s51, 131072
    s_mov_b32 m0, 52224
    s_nop 0
    buffer_load_dwordx4 v5, s[28:31], s50 offen lds
    buffer_load_dwordx4 v5, s[28:31], s50 offen offset:1024 lds
    buffer_load_dwordx4 v5, s[28:31], s51 offen offset:2048 lds
    buffer_load_dwordx4 v5, s[28:31], s51 offen offset:3072 lds
    s_add_u32 s50, s50, 131072
    s_add_u32 s51, s51, 131072
    s_waitcnt vmcnt(16)
    s_barrier
    s_mov_b32 m0, 69632
    s_nop 0
    buffer_load_dwordx4 v5, s[28:31], s50 offen lds
    buffer_load_dwordx4 v5, s[28:31], s50 offen offset:1024 lds
    buffer_load_dwordx4 v5, s[28:31], s51 offen offset:2048 lds
    buffer_load_dwordx4 v5, s[28:31], s51 offen offset:3072 lds
    s_add_u32 s50, s50, 131072
    s_add_u32 s51, s51, 131072
    s_mov_b32 m0, 87040
    s_nop 0
    buffer_load_dwordx4 v5, s[28:31], s50 offen lds
    buffer_load_dwordx4 v5, s[28:31], s50 offen offset:1024 lds
    buffer_load_dwordx4 v5, s[28:31], s51 offen offset:2048 lds
    buffer_load_dwordx4 v5, s[28:31], s51 offen offset:3072 lds
    s_add_u32 s50, s50, 131072
    s_add_u32 s51, s51, 131072
    s_waitcnt vmcnt(16)
    s_barrier
    s_mov_b32 m0, 104448
    s_nop 0
    buffer_load_dwordx4 v5, s[28:31], s50 offen lds
    buffer_load_dwordx4 v5, s[28:31], s50 offen offset:1024 lds
    buffer_load_dwordx4 v5, s[28:31], s51 offen offset:2048 lds
    buffer_load_dwordx4 v5, s[28:31], s51 offen offset:3072 lds
    s_add_u32 s50, s50, 131072
    s_add_u32 s51, s51, 131072
    s_mov_b32 m0, 121856
    s_nop 0
    buffer_load_dwordx4 v5, s[28:31], s50 offen lds
    buffer_load_dwordx4 v5, s[28:31], s50 offen offset:1024 lds
    buffer_load_dwordx4 v5, s[28:31], s51 offen offset:2048 lds
    buffer_load_dwordx4 v5, s[28:31], s51 offen offset:3072 lds
    s_add_u32 s50, s50, 131072
    s_add_u32 s51, s51, 131072
    s_waitcnt vmcnt(16)
    s_barrier
    s_mov_b32 m0, 0
    s_nop 0
    buffer_load_dwordx4 v5, s[28:31], s50 offen lds
    buffer_load_dwordx4 v5, s[28:31], s50 offen offset:1024 lds
    buffer_load_dwordx4 v5, s[28:31], s51 offen offset:2048 lds
    buffer_load_dwordx4 v5, s[28:31], s51 offen offset:3072 lds
    s_add_u32 s50, s50, 131072
    s_add_u32 s51, s51, 131072
    s_mov_b32 m0, 17408
    s_nop 0
    buffer_load_dwordx4 v5, s[28:31], s50 offen lds
    buffer_load_dwordx4 v5, s[28:31], s50 offen offset:1024 lds
    buffer_load_dwordx4 v5, s[28:31], s51 offen offset:2048 lds
    buffer_load_dwordx4 v5, s[28:31], s51 offen offset:3072 lds
    s_add_u32 s50, s50, 131072
    s_add_u32 s51, s51, 131072
    s_waitcnt vmcnt(16)
    s_barrier
    s_mov_b32 m0, 34816
    s_nop 0
    buffer_load_dwordx4 v5, s[28:31], s50 offen lds
    buffer_load_dwordx4 v5, s[28:31], s50 offen offset:1024 lds
    buffer_load_dwordx4 v5, s[28:31], s51 offen offset:2048 lds
    buffer_load_dwordx4 v5, s[28:31], s51 offen offset:3072 lds
    s_add_u32 s50, s50, 131072
    s_add_u32 s51, s51, 131072
    s_mov_b32 m0, 52224
    s_nop 0
    buffer_load_dwordx4 v5, s[28:31], s50 offen lds
    buffer_load_dwordx4 v5, s[28:31], s50 offen offset:1024 lds
    buffer_load_dwordx4 v5, s[28:31], s51 offen offset:2048 lds
    buffer_load_dwordx4 v5, s[28:31], s51 offen offset:3072 lds
    s_add_u32 s50, s50, 131072
    s_add_u32 s51, s51, 131072
    s_waitcnt vmcnt(16)
    s_barrier
    s_mov_b32 m0, 69632
    s_nop 0
    buffer_load_dwordx4 v5, s[28:31], s50 offen lds
    buffer_load_dwordx4 v5, s[28:31], s50 offen offset:1024 lds
    buffer_load_dwordx4 v5, s[28:31], s51 offen offset:2048 lds
    buffer_load_dwordx4 v5, s[28:31], s51 offen offset:3072 lds
    s_add_u32 s50, s50, 131072
    s_add_u32 s51, s51, 131072
    s_mov_b32 m0, 87040
    s_nop 0
    buffer_load_dwordx4 v5, s[28:31], s50 offen lds
    buffer_load_dwordx4 v5, s[28:31], s50 offen offset:1024 lds
    buffer_load_dwordx4 v5, s[28:31], s51 offen offset:2048 lds
    buffer_load_dwordx4 v5, s[28:31], s51 offen offset:3072 lds
    s_add_u32 s50, s50, 131072
    s_add_u32 s51, s51, 131072
    s_waitcnt vmcnt(16)
    s_barrier
    s_mov_b32 m0, 104448
    s_nop 0
    buffer_load_dwordx4 v5, s[28:31], s50 offen lds
    buffer_load_dwordx4 v5, s[28:31], s50 offen offset:1024 lds
    buffer_load_dwordx4 v5, s[28:31], s51 offen offset:2048 lds
    buffer_load_dwordx4 v5, s[28:31], s51 offen offset:3072 lds
    s_add_u32 s50, s50, 131072
    s_add_u32 s51, s51, 131072
    s_mov_b32 m0, 121856
    s_nop 0
    buffer_load_dwordx4 v5, s[28:31], s50 offen lds
    buffer_load_dwordx4 v5, s[28:31], s50 offen offset:1024 lds
    buffer_load_dwordx4 v5, s[28:31], s51 offen offset:2048 lds
    buffer_load_dwordx4 v5, s[28:31], s51 offen offset:3072 lds
    s_add_u32 s50, s50, 131072
    s_add_u32 s51, s51, 131072
    s_waitcnt vmcnt(16)
    s_barrier
    s_mov_b32 m0, 0
    s_nop 0
    buffer_load_dwordx4 v5, s[28:31], s50 offen lds
    buffer_load_dwordx4 v5, s[28:31], s50 offen offset:1024 lds
    buffer_load_dwordx4 v5, s[28:31], s51 offen offset:2048 lds
    buffer_load_dwordx4 v5, s[28:31], s51 offen offset:3072 lds
    s_add_u32 s50, s50, 131072
    s_add_u32 s51, s51, 131072
    s_mov_b32 m0, 17408
    s_nop 0
    buffer_load_dwordx4 v5, s[28:31], s50 offen lds
    buffer_load_dwordx4 v5, s[28:31], s50 offen offset:1024 lds
    buffer_load_dwordx4 v5, s[28:31], s51 offen offset:2048 lds
    buffer_load_dwordx4 v5, s[28:31], s51 offen offset:3072 lds
    s_add_u32 s50, s50, 131072
    s_add_u32 s51, s51, 131072
    s_waitcnt vmcnt(16)
    s_barrier
    s_mov_b32 m0, 34816
    s_nop 0
    buffer_load_dwordx4 v5, s[28:31], s50 offen lds
    buffer_load_dwordx4 v5, s[28:31], s50 offen offset:1024 lds
    buffer_load_dwordx4 v5, s[28:31], s51 offen offset:2048 lds
    buffer_load_dwordx4 v5, s[28:31], s51 offen offset:3072 lds
    s_add_u32 s50, s50, 131072
    s_add_u32 s51, s51, 131072
    s_mov_b32 m0, 52224
    s_nop 0
    buffer_load_dwordx4 v5, s[28:31], s50 offen lds
    buffer_load_dwordx4 v5, s[28:31], s50 offen offset:1024 lds
    buffer_load_dwordx4 v5, s[28:31], s51 offen offset:2048 lds
    buffer_load_dwordx4 v5, s[28:31], s51 offen offset:3072 lds
    s_add_u32 s50, s50, 131072
    s_add_u32 s51, s51, 131072
    s_waitcnt vmcnt(16)
    s_barrier
    s_mov_b32 m0, 69632
    s_nop 0
    buffer_load_dwordx4 v6, s[20:23], s54 offen offset:0 lds
    buffer_load_dwordx4 v6, s[20:23], s54 offen offset:1024 lds
    buffer_load_dwordx4 v6, s[20:23], s54 offen offset:2048 lds
    buffer_load_dwordx4 v6, s[20:23], s54 offen offset:3072 lds
    s_mov_b32 m0, 73728
    s_add_u32 s54, s54, 27648
    buffer_load_dwordx4 v6, s[20:23], s55 offen lds
    s_add_u32 s55, s55, 27648
    s_mov_b32 m0, 87040
    s_nop 0
    buffer_load_dwordx4 v6, s[20:23], s54 offen offset:0 lds
    buffer_load_dwordx4 v6, s[20:23], s54 offen offset:1024 lds
    buffer_load_dwordx4 v6, s[20:23], s54 offen offset:2048 lds
    buffer_load_dwordx4 v6, s[20:23], s54 offen offset:3072 lds
    s_mov_b32 m0, 91136
    s_add_u32 s54, s54, 27648
    buffer_load_dwordx4 v6, s[20:23], s55 offen lds
    s_add_u32 s55, s55, 27648
    s_waitcnt vmcnt(18)
    s_barrier
    s_mov_b32 m0, 104448
    s_nop 0
    buffer_load_dwordx4 v6, s[20:23], s54 offen offset:0 lds
    buffer_load_dwordx4 v6, s[20:23], s54 offen offset:1024 lds
    buffer_load_dwordx4 v6, s[20:23], s54 offen offset:2048 lds
    buffer_load_dwordx4 v6, s[20:23], s54 offen offset:3072 lds
    s_mov_b32 m0, 108544
    s_add_u32 s54, s54, 27648
    buffer_load_dwordx4 v6, s[20:23], s55 offen lds
    s_add_u32 s55, s55, 27648
    s_mov_b32 m0, 121856
    s_nop 0
    buffer_load_dwordx4 v6, s[20:23], s54 offen offset:0 lds
    buffer_load_dwordx4 v6, s[20:23], s54 offen offset:1024 lds
    buffer_load_dwordx4 v6, s[20:23], s54 offen offset:2048 lds
    buffer_load_dwordx4 v6, s[20:23], s54 offen offset:3072 lds
    s_mov_b32 m0, 125952
    s_add_u32 s54, s54, 27648
    buffer_load_dwordx4 v6, s[20:23], s55 offen lds
    s_add_u32 s55, s55, 27648
    s_waitcnt vmcnt(20)
    s_barrier
    s_mov_b32 m0, 0
    s_nop 0
    buffer_load_dwordx4 v6, s[20:23], s54 offen offset:0 lds
    buffer_load_dwordx4 v6, s[20:23], s54 offen offset:1024 lds
    buffer_load_dwordx4 v6, s[20:23], s54 offen offset:2048 lds
    buffer_load_dwordx4 v6, s[20:23], s54 offen offset:3072 lds
    s_mov_b32 m0, 4096
    s_add_u32 s54, s54, 27648
    buffer_load_dwordx4 v6, s[20:23], s55 offen lds
    s_add_u32 s55, s55, 27648
    s_mov_b32 m0, 17408
    s_nop 0
    buffer_load_dwordx4 v6, s[20:23], s54 offen offset:0 lds
    buffer_load_dwordx4 v6, s[20:23], s54 offen offset:1024 lds
    buffer_load_dwordx4 v6, s[20:23], s54 offen offset:2048 lds
    buffer_load_dwordx4 v6, s[20:23], s54 offen offset:3072 lds
    s_mov_b32 m0, 21504
    s_add_u32 s54, s54, 27648
    buffer_load_dwordx4 v6, s[20:23], s55 offen lds
    s_add_u32 s55, s55, 27648
    s_waitcnt vmcnt(20)
    s_barrier
    s_waitcnt vmcnt(10)
    s_barrier
    s_waitcnt vmcnt(0)
    s_barrier
    s_endpgm
L_k3prod1_19:
    s_lshl_b32 s47, s43, 11
    v_add_u32 v5, s47, v6
    s_mul_i32 s50, s42, 144
    s_add_u32 s50, s50, 74
    s_lshl_b32 s50, s50, 15
    s_add_u32 s51, s50, 30720

    s_mul_i32 s54, s44, 1492992
    s_lshl_b32 s47, s41, 12
    s_add_u32 s54, s54, s47
    s_add_u32 s54, s54, 9216
    s_add_u32 s55, s54, 4096

    s_lshl_b32 s47, s41, 2
    s_add_u32 s47, s47, s44
    s_mul_i32 s47, s47, 9
    s_add_u32 s47, s47, 72
    s_lshl_b32 s56, s47, 15
    s_lshl_b32 s47, s43, 11
    s_add_u32 s56, s56, s47
    s_lshl_b32 s47, s40, 10
    s_add_u32 s56, s56, s47
    s_sub_u32 s56, s56, 256

    v_add_u32 v7, 64, v2
    v_mul_u32_u24 v8, 52429, v7
    v_lshrrev_b32 v8, 22, v8
    v_mul_u32_u24 v9, 80, v8
    v_sub_u32 v7, v7, v9
    v_lshlrev_b32 v7, 4, v7
    v_lshl_add_u32 v7, v8, 15, v7
    v_add_u32 v9, 2064384, v7
    v_cmp_le_u32 vcc, 9, v8
    s_mov_b32 m0, 140288
    s_nop 1
    v_cndmask_b32 v7, v7, v9, vcc
    buffer_load_dwordx4 v7, s[24:27], s56 offen lds

    v_add_u32 v7, 320, v2
    v_mul_u32_u24 v8, 52429, v7
    v_lshrrev_b32 v8, 22, v8
    v_mul_u32_u24 v9, 80, v8
    v_sub_u32 v7, v7, v9
    v_lshlrev_b32 v7, 4, v7
    v_lshl_add_u32 v7, v8, 15, v7
    v_add_u32 v9, 2064384, v7
    v_cmp_le_u32 vcc, 9, v8
    s_mov_b32 m0, 144384
    s_nop 1
    v_cndmask_b32 v7, v7, v9, vcc
    buffer_load_dwordx4 v7, s[24:27], s56 offen lds

    v_add_u32 v7, 576, v2
    v_mul_u32_u24 v8, 52429, v7
    v_lshrrev_b32 v8, 22, v8
    v_mul_u32_u24 v9, 80, v8
    v_sub_u32 v7, v7, v9
    v_lshlrev_b32 v7, 4, v7
    v_lshl_add_u32 v7, v8, 15, v7
    v_add_u32 v9, 2064384, v7
    v_cmp_le_u32 vcc, 9, v8
    s_mov_b32 m0, 148480
    s_nop 1
    v_cndmask_b32 v7, v7, v9, vcc
    buffer_load_dwordx4 v7, s[24:27], s56 offen lds

    v_add_u32 v7, 832, v2
    v_mul_u32_u24 v8, 52429, v7
    v_lshrrev_b32 v8, 22, v8
    v_mul_u32_u24 v9, 80, v8
    v_sub_u32 v7, v7, v9
    v_lshlrev_b32 v7, 4, v7
    v_lshl_add_u32 v7, v8, 15, v7
    v_add_u32 v9, 2064384, v7
    v_cmp_le_u32 vcc, 9, v8
    s_mov_b32 m0, 152576
    s_nop 1
    v_cndmask_b32 v7, v7, v9, vcc
    buffer_load_dwordx4 v7, s[24:27], s56 offen lds

    v_add_u32 v7, 1088, v2
    v_mul_u32_u24 v8, 52429, v7
    v_lshrrev_b32 v8, 22, v8
    v_mul_u32_u24 v9, 80, v8
    v_sub_u32 v7, v7, v9
    v_lshlrev_b32 v7, 4, v7
    v_lshl_add_u32 v7, v8, 15, v7
    v_add_u32 v9, 2064384, v7
    v_cmp_le_u32 vcc, 9, v8
    s_mov_b32 m0, 156672
    s_nop 1
    v_cndmask_b32 v7, v7, v9, vcc
    buffer_load_dwordx4 v7, s[24:27], s56 offen lds

    v_add_u32 v7, 1344, v2
    v_mul_u32_u24 v8, 52429, v7
    v_lshrrev_b32 v8, 22, v8
    v_mul_u32_u24 v9, 80, v8
    v_sub_u32 v7, v7, v9
    v_lshlrev_b32 v7, 4, v7
    v_lshl_add_u32 v7, v8, 15, v7
    v_add_u32 v9, 2064384, v7
    v_cmp_le_u32 vcc, 9, v8
    s_mov_b32 m0, 160768
    s_nop 1
    v_cndmask_b32 v7, v7, v9, vcc
    buffer_load_dwordx4 v7, s[24:27], s56 offen lds

    s_mov_b32 m0, 4096
    s_nop 0
    buffer_load_dwordx4 v5, s[28:31], s50 offen lds
    buffer_load_dwordx4 v5, s[28:31], s50 offen offset:1024 lds
    buffer_load_dwordx4 v5, s[28:31], s51 offen offset:2048 lds
    buffer_load_dwordx4 v5, s[28:31], s51 offen offset:3072 lds
    s_add_u32 s50, s50, 131072
    s_add_u32 s51, s51, 131072
    s_mov_b32 m0, 21504
    s_nop 0
    buffer_load_dwordx4 v5, s[28:31], s50 offen lds
    buffer_load_dwordx4 v5, s[28:31], s50 offen offset:1024 lds
    buffer_load_dwordx4 v5, s[28:31], s51 offen offset:2048 lds
    buffer_load_dwordx4 v5, s[28:31], s51 offen offset:3072 lds
    s_add_u32 s50, s50, 131072
    s_add_u32 s51, s51, 131072
    s_mov_b32 m0, 38912
    s_nop 0
    buffer_load_dwordx4 v5, s[28:31], s50 offen lds
    buffer_load_dwordx4 v5, s[28:31], s50 offen offset:1024 lds
    buffer_load_dwordx4 v5, s[28:31], s51 offen offset:2048 lds
    buffer_load_dwordx4 v5, s[28:31], s51 offen offset:3072 lds
    s_add_u32 s50, s50, 131072
    s_add_u32 s51, s51, 131072
    s_waitcnt vmcnt(12)
    s_barrier
    s_mov_b32 m0, 56320
    s_nop 0
    buffer_load_dwordx4 v5, s[28:31], s50 offen lds
    buffer_load_dwordx4 v5, s[28:31], s50 offen offset:1024 lds
    buffer_load_dwordx4 v5, s[28:31], s51 offen offset:2048 lds
    buffer_load_dwordx4 v5, s[28:31], s51 offen offset:3072 lds
    s_add_u32 s50, s50, 131072
    s_add_u32 s51, s51, 131072
    s_mov_b32 m0, 73728
    s_nop 0
    buffer_load_dwordx4 v5, s[28:31], s50 offen lds
    buffer_load_dwordx4 v5, s[28:31], s50 offen offset:1024 lds
    buffer_load_dwordx4 v5, s[28:31], s51 offen offset:2048 lds
    buffer_load_dwordx4 v5, s[28:31], s51 offen offset:3072 lds
    s_add_u32 s50, s50, 131072
    s_add_u32 s51, s51, 131072
    s_mov_b32 m0, 91136
    s_nop 0
    buffer_load_dwordx4 v5, s[28:31], s50 offen lds
    buffer_load_dwordx4 v5, s[28:31], s50 offen offset:1024 lds
    buffer_load_dwordx4 v5, s[28:31], s51 offen offset:2048 lds
    buffer_load_dwordx4 v5, s[28:31], s51 offen offset:3072 lds
    s_add_u32 s50, s50, 131072
    s_add_u32 s51, s51, 131072
    s_mov_b32 m0, 108544
    s_nop 0
    buffer_load_dwordx4 v5, s[28:31], s50 offen lds
    buffer_load_dwordx4 v5, s[28:31], s50 offen offset:1024 lds
    buffer_load_dwordx4 v5, s[28:31], s51 offen offset:2048 lds
    buffer_load_dwordx4 v5, s[28:31], s51 offen offset:3072 lds
    s_add_u32 s50, s50, 131072
    s_add_u32 s51, s51, 131072
    s_mov_b32 m0, 125952
    s_nop 0
    buffer_load_dwordx4 v5, s[28:31], s50 offen lds
    buffer_load_dwordx4 v5, s[28:31], s50 offen offset:1024 lds
    buffer_load_dwordx4 v5, s[28:31], s51 offen offset:2048 lds
    buffer_load_dwordx4 v5, s[28:31], s51 offen offset:3072 lds
    s_add_u32 s50, s50, 131072
    s_add_u32 s51, s51, 131072
    s_waitcnt vmcnt(28)
    s_barrier
    s_waitcnt vmcnt(24)
    s_barrier
    s_mov_b32 m0, 4096
    s_nop 0
    buffer_load_dwordx4 v5, s[28:31], s50 offen lds
    buffer_load_dwordx4 v5, s[28:31], s50 offen offset:1024 lds
    buffer_load_dwordx4 v5, s[28:31], s51 offen offset:2048 lds
    buffer_load_dwordx4 v5, s[28:31], s51 offen offset:3072 lds
    s_add_u32 s50, s50, 131072
    s_add_u32 s51, s51, 131072
    s_waitcnt vmcnt(20)
    s_barrier
    s_mov_b32 m0, 21504
    s_nop 0
    buffer_load_dwordx4 v5, s[28:31], s50 offen lds
    buffer_load_dwordx4 v5, s[28:31], s50 offen offset:1024 lds
    buffer_load_dwordx4 v5, s[28:31], s51 offen offset:2048 lds
    buffer_load_dwordx4 v5, s[28:31], s51 offen offset:3072 lds
    s_add_u32 s50, s50, 131072
    s_add_u32 s51, s51, 131072
    s_waitcnt vmcnt(16)
    s_barrier
    s_mov_b32 m0, 38912
    s_nop 0
    buffer_load_dwordx4 v5, s[28:31], s50 offen lds
    buffer_load_dwordx4 v5, s[28:31], s50 offen offset:1024 lds
    buffer_load_dwordx4 v5, s[28:31], s51 offen offset:2048 lds
    buffer_load_dwordx4 v5, s[28:31], s51 offen offset:3072 lds
    s_add_u32 s50, s50, 131072
    s_add_u32 s51, s51, 131072
    s_mov_b32 m0, 56320
    s_nop 0
    buffer_load_dwordx4 v5, s[28:31], s50 offen lds
    buffer_load_dwordx4 v5, s[28:31], s50 offen offset:1024 lds
    buffer_load_dwordx4 v5, s[28:31], s51 offen offset:2048 lds
    buffer_load_dwordx4 v5, s[28:31], s51 offen offset:3072 lds
    s_add_u32 s50, s50, 131072
    s_add_u32 s51, s51, 131072
    s_waitcnt vmcnt(16)
    s_barrier
    s_mov_b32 m0, 73728
    s_nop 0
    buffer_load_dwordx4 v5, s[28:31], s50 offen lds
    buffer_load_dwordx4 v5, s[28:31], s50 offen offset:1024 lds
    buffer_load_dwordx4 v5, s[28:31], s51 offen offset:2048 lds
    buffer_load_dwordx4 v5, s[28:31], s51 offen offset:3072 lds
    s_add_u32 s50, s50, 131072
    s_add_u32 s51, s51, 131072
    s_mov_b32 m0, 91136
    s_nop 0
    buffer_load_dwordx4 v5, s[28:31], s50 offen lds
    buffer_load_dwordx4 v5, s[28:31], s50 offen offset:1024 lds
    buffer_load_dwordx4 v5, s[28:31], s51 offen offset:2048 lds
    buffer_load_dwordx4 v5, s[28:31], s51 offen offset:3072 lds
    s_add_u32 s50, s50, 131072
    s_add_u32 s51, s51, 131072
    s_waitcnt vmcnt(16)
    s_barrier
    s_mov_b32 m0, 108544
    s_nop 0
    buffer_load_dwordx4 v5, s[28:31], s50 offen lds
    buffer_load_dwordx4 v5, s[28:31], s50 offen offset:1024 lds
    buffer_load_dwordx4 v5, s[28:31], s51 offen offset:2048 lds
    buffer_load_dwordx4 v5, s[28:31], s51 offen offset:3072 lds
    s_add_u32 s50, s50, 131072
    s_add_u32 s51, s51, 131072
    s_mov_b32 m0, 125952
    s_nop 0
    buffer_load_dwordx4 v5, s[28:31], s50 offen lds
    buffer_load_dwordx4 v5, s[28:31], s50 offen offset:1024 lds
    buffer_load_dwordx4 v5, s[28:31], s51 offen offset:2048 lds
    buffer_load_dwordx4 v5, s[28:31], s51 offen offset:3072 lds
    s_add_u32 s50, s50, 131072
    s_add_u32 s51, s51, 131072
    s_waitcnt vmcnt(16)
    s_barrier
    s_mov_b32 m0, 4096
    s_nop 0
    buffer_load_dwordx4 v5, s[28:31], s50 offen lds
    buffer_load_dwordx4 v5, s[28:31], s50 offen offset:1024 lds
    buffer_load_dwordx4 v5, s[28:31], s51 offen offset:2048 lds
    buffer_load_dwordx4 v5, s[28:31], s51 offen offset:3072 lds
    s_add_u32 s50, s50, 131072
    s_add_u32 s51, s51, 131072
    s_mov_b32 m0, 21504
    s_nop 0
    buffer_load_dwordx4 v5, s[28:31], s50 offen lds
    buffer_load_dwordx4 v5, s[28:31], s50 offen offset:1024 lds
    buffer_load_dwordx4 v5, s[28:31], s51 offen offset:2048 lds
    buffer_load_dwordx4 v5, s[28:31], s51 offen offset:3072 lds
    s_add_u32 s50, s50, 131072
    s_add_u32 s51, s51, 131072
    s_waitcnt vmcnt(16)
    s_barrier
    s_mov_b32 m0, 38912
    s_nop 0
    buffer_load_dwordx4 v5, s[28:31], s50 offen lds
    buffer_load_dwordx4 v5, s[28:31], s50 offen offset:1024 lds
    buffer_load_dwordx4 v5, s[28:31], s51 offen offset:2048 lds
    buffer_load_dwordx4 v5, s[28:31], s51 offen offset:3072 lds
    s_add_u32 s50, s50, 131072
    s_add_u32 s51, s51, 131072
    s_mov_b32 m0, 56320
    s_nop 0
    buffer_load_dwordx4 v5, s[28:31], s50 offen lds
    buffer_load_dwordx4 v5, s[28:31], s50 offen offset:1024 lds
    buffer_load_dwordx4 v5, s[28:31], s51 offen offset:2048 lds
    buffer_load_dwordx4 v5, s[28:31], s51 offen offset:3072 lds
    s_add_u32 s50, s50, 131072
    s_add_u32 s51, s51, 131072
    s_waitcnt vmcnt(16)
    s_barrier
    s_mov_b32 m0, 73728
    s_nop 0
    buffer_load_dwordx4 v5, s[28:31], s50 offen lds
    buffer_load_dwordx4 v5, s[28:31], s50 offen offset:1024 lds
    buffer_load_dwordx4 v5, s[28:31], s51 offen offset:2048 lds
    buffer_load_dwordx4 v5, s[28:31], s51 offen offset:3072 lds
    s_add_u32 s50, s50, 131072
    s_add_u32 s51, s51, 131072
    s_mov_b32 m0, 91136
    s_nop 0
    buffer_load_dwordx4 v5, s[28:31], s50 offen lds
    buffer_load_dwordx4 v5, s[28:31], s50 offen offset:1024 lds
    buffer_load_dwordx4 v5, s[28:31], s51 offen offset:2048 lds
    buffer_load_dwordx4 v5, s[28:31], s51 offen offset:3072 lds
    s_add_u32 s50, s50, 131072
    s_add_u32 s51, s51, 131072
    s_waitcnt vmcnt(16)
    s_barrier
    s_mov_b32 m0, 108544
    s_nop 0
    buffer_load_dwordx4 v5, s[28:31], s50 offen lds
    buffer_load_dwordx4 v5, s[28:31], s50 offen offset:1024 lds
    buffer_load_dwordx4 v5, s[28:31], s51 offen offset:2048 lds
    buffer_load_dwordx4 v5, s[28:31], s51 offen offset:3072 lds
    s_add_u32 s50, s50, 131072
    s_add_u32 s51, s51, 131072
    s_mov_b32 m0, 125952
    s_nop 0
    buffer_load_dwordx4 v5, s[28:31], s50 offen lds
    buffer_load_dwordx4 v5, s[28:31], s50 offen offset:1024 lds
    buffer_load_dwordx4 v5, s[28:31], s51 offen offset:2048 lds
    buffer_load_dwordx4 v5, s[28:31], s51 offen offset:3072 lds
    s_add_u32 s50, s50, 131072
    s_add_u32 s51, s51, 131072
    s_waitcnt vmcnt(16)
    s_barrier
    s_mov_b32 m0, 4096
    s_nop 0
    buffer_load_dwordx4 v5, s[28:31], s50 offen lds
    buffer_load_dwordx4 v5, s[28:31], s50 offen offset:1024 lds
    buffer_load_dwordx4 v5, s[28:31], s51 offen offset:2048 lds
    buffer_load_dwordx4 v5, s[28:31], s51 offen offset:3072 lds
    s_add_u32 s50, s50, 131072
    s_add_u32 s51, s51, 131072
    s_mov_b32 m0, 21504
    s_nop 0
    buffer_load_dwordx4 v5, s[28:31], s50 offen lds
    buffer_load_dwordx4 v5, s[28:31], s50 offen offset:1024 lds
    buffer_load_dwordx4 v5, s[28:31], s51 offen offset:2048 lds
    buffer_load_dwordx4 v5, s[28:31], s51 offen offset:3072 lds
    s_add_u32 s50, s50, 131072
    s_add_u32 s51, s51, 131072
    s_waitcnt vmcnt(16)
    s_barrier
    s_mov_b32 m0, 38912
    s_nop 0
    buffer_load_dwordx4 v5, s[28:31], s50 offen lds
    buffer_load_dwordx4 v5, s[28:31], s50 offen offset:1024 lds
    buffer_load_dwordx4 v5, s[28:31], s51 offen offset:2048 lds
    buffer_load_dwordx4 v5, s[28:31], s51 offen offset:3072 lds
    s_add_u32 s50, s50, 131072
    s_add_u32 s51, s51, 131072
    s_mov_b32 m0, 56320
    s_nop 0
    buffer_load_dwordx4 v5, s[28:31], s50 offen lds
    buffer_load_dwordx4 v5, s[28:31], s50 offen offset:1024 lds
    buffer_load_dwordx4 v5, s[28:31], s51 offen offset:2048 lds
    buffer_load_dwordx4 v5, s[28:31], s51 offen offset:3072 lds
    s_add_u32 s50, s50, 131072
    s_add_u32 s51, s51, 131072
    s_waitcnt vmcnt(16)
    s_barrier
    s_mov_b32 m0, 73728
    s_nop 0
    buffer_load_dwordx4 v5, s[28:31], s50 offen lds
    buffer_load_dwordx4 v5, s[28:31], s50 offen offset:1024 lds
    buffer_load_dwordx4 v5, s[28:31], s51 offen offset:2048 lds
    buffer_load_dwordx4 v5, s[28:31], s51 offen offset:3072 lds
    s_add_u32 s50, s50, 131072
    s_add_u32 s51, s51, 131072
    s_mov_b32 m0, 91136
    s_nop 0
    buffer_load_dwordx4 v5, s[28:31], s50 offen lds
    buffer_load_dwordx4 v5, s[28:31], s50 offen offset:1024 lds
    buffer_load_dwordx4 v5, s[28:31], s51 offen offset:2048 lds
    buffer_load_dwordx4 v5, s[28:31], s51 offen offset:3072 lds
    s_add_u32 s50, s50, 131072
    s_add_u32 s51, s51, 131072
    s_waitcnt vmcnt(16)
    s_barrier
    s_mov_b32 m0, 108544
    s_nop 0
    buffer_load_dwordx4 v5, s[28:31], s50 offen lds
    buffer_load_dwordx4 v5, s[28:31], s50 offen offset:1024 lds
    buffer_load_dwordx4 v5, s[28:31], s51 offen offset:2048 lds
    buffer_load_dwordx4 v5, s[28:31], s51 offen offset:3072 lds
    s_add_u32 s50, s50, 131072
    s_add_u32 s51, s51, 131072
    s_mov_b32 m0, 125952
    s_nop 0
    buffer_load_dwordx4 v5, s[28:31], s50 offen lds
    buffer_load_dwordx4 v5, s[28:31], s50 offen offset:1024 lds
    buffer_load_dwordx4 v5, s[28:31], s51 offen offset:2048 lds
    buffer_load_dwordx4 v5, s[28:31], s51 offen offset:3072 lds
    s_add_u32 s50, s50, 131072
    s_add_u32 s51, s51, 131072
    s_waitcnt vmcnt(16)
    s_barrier
    s_mov_b32 m0, 4096
    s_nop 0
    buffer_load_dwordx4 v5, s[28:31], s50 offen lds
    buffer_load_dwordx4 v5, s[28:31], s50 offen offset:1024 lds
    buffer_load_dwordx4 v5, s[28:31], s51 offen offset:2048 lds
    buffer_load_dwordx4 v5, s[28:31], s51 offen offset:3072 lds
    s_add_u32 s50, s50, 131072
    s_add_u32 s51, s51, 131072
    s_mov_b32 m0, 21504
    s_nop 0
    buffer_load_dwordx4 v5, s[28:31], s50 offen lds
    buffer_load_dwordx4 v5, s[28:31], s50 offen offset:1024 lds
    buffer_load_dwordx4 v5, s[28:31], s51 offen offset:2048 lds
    buffer_load_dwordx4 v5, s[28:31], s51 offen offset:3072 lds
    s_add_u32 s50, s50, 131072
    s_add_u32 s51, s51, 131072
    s_waitcnt vmcnt(16)
    s_barrier
    s_mov_b32 m0, 38912
    s_nop 0
    buffer_load_dwordx4 v5, s[28:31], s50 offen lds
    buffer_load_dwordx4 v5, s[28:31], s50 offen offset:1024 lds
    buffer_load_dwordx4 v5, s[28:31], s51 offen offset:2048 lds
    buffer_load_dwordx4 v5, s[28:31], s51 offen offset:3072 lds
    s_add_u32 s50, s50, 131072
    s_add_u32 s51, s51, 131072
    s_mov_b32 m0, 56320
    s_nop 0
    buffer_load_dwordx4 v5, s[28:31], s50 offen lds
    buffer_load_dwordx4 v5, s[28:31], s50 offen offset:1024 lds
    buffer_load_dwordx4 v5, s[28:31], s51 offen offset:2048 lds
    buffer_load_dwordx4 v5, s[28:31], s51 offen offset:3072 lds
    s_add_u32 s50, s50, 131072
    s_add_u32 s51, s51, 131072
    s_waitcnt vmcnt(16)
    s_barrier
    s_mov_b32 m0, 74752
    s_nop 0
    buffer_load_dwordx4 v6, s[20:23], s54 offen offset:0 lds
    buffer_load_dwordx4 v6, s[20:23], s54 offen offset:1024 lds
    buffer_load_dwordx4 v6, s[20:23], s54 offen offset:2048 lds
    buffer_load_dwordx4 v6, s[20:23], s54 offen offset:3072 lds
    s_mov_b32 m0, 78848
    s_add_u32 s54, s54, 27648
    buffer_load_dwordx4 v6, s[20:23], s55 offen lds
    s_add_u32 s55, s55, 27648
    s_mov_b32 m0, 92160
    s_nop 0
    buffer_load_dwordx4 v6, s[20:23], s54 offen offset:0 lds
    buffer_load_dwordx4 v6, s[20:23], s54 offen offset:1024 lds
    buffer_load_dwordx4 v6, s[20:23], s54 offen offset:2048 lds
    buffer_load_dwordx4 v6, s[20:23], s54 offen offset:3072 lds
    s_mov_b32 m0, 96256
    s_add_u32 s54, s54, 27648
    buffer_load_dwordx4 v6, s[20:23], s55 offen lds
    s_add_u32 s55, s55, 27648
    s_waitcnt vmcnt(18)
    s_barrier
    s_mov_b32 m0, 109568
    s_nop 0
    buffer_load_dwordx4 v6, s[20:23], s54 offen offset:0 lds
    buffer_load_dwordx4 v6, s[20:23], s54 offen offset:1024 lds
    buffer_load_dwordx4 v6, s[20:23], s54 offen offset:2048 lds
    buffer_load_dwordx4 v6, s[20:23], s54 offen offset:3072 lds
    s_mov_b32 m0, 113664
    s_add_u32 s54, s54, 27648
    buffer_load_dwordx4 v6, s[20:23], s55 offen lds
    s_add_u32 s55, s55, 27648
    s_mov_b32 m0, 126976
    s_nop 0
    buffer_load_dwordx4 v6, s[20:23], s54 offen offset:0 lds
    buffer_load_dwordx4 v6, s[20:23], s54 offen offset:1024 lds
    buffer_load_dwordx4 v6, s[20:23], s54 offen offset:2048 lds
    buffer_load_dwordx4 v6, s[20:23], s54 offen offset:3072 lds
    s_mov_b32 m0, 131072
    s_add_u32 s54, s54, 27648
    buffer_load_dwordx4 v6, s[20:23], s55 offen lds
    s_add_u32 s55, s55, 27648
    s_waitcnt vmcnt(20)
    s_barrier
    s_mov_b32 m0, 5120
    s_nop 0
    buffer_load_dwordx4 v6, s[20:23], s54 offen offset:0 lds
    buffer_load_dwordx4 v6, s[20:23], s54 offen offset:1024 lds
    buffer_load_dwordx4 v6, s[20:23], s54 offen offset:2048 lds
    buffer_load_dwordx4 v6, s[20:23], s54 offen offset:3072 lds
    s_mov_b32 m0, 9216
    s_add_u32 s54, s54, 27648
    buffer_load_dwordx4 v6, s[20:23], s55 offen lds
    s_add_u32 s55, s55, 27648
    s_mov_b32 m0, 22528
    s_nop 0
    buffer_load_dwordx4 v6, s[20:23], s54 offen offset:0 lds
    buffer_load_dwordx4 v6, s[20:23], s54 offen offset:1024 lds
    buffer_load_dwordx4 v6, s[20:23], s54 offen offset:2048 lds
    buffer_load_dwordx4 v6, s[20:23], s54 offen offset:3072 lds
    s_mov_b32 m0, 26624
    s_add_u32 s54, s54, 27648
    buffer_load_dwordx4 v6, s[20:23], s55 offen lds
    s_add_u32 s55, s55, 27648
    s_waitcnt vmcnt(20)
    s_barrier
    s_waitcnt vmcnt(10)
    s_barrier
    s_waitcnt vmcnt(0)
    s_barrier
    s_endpgm
L_k3prod2_20:
    s_mul_i32 s52, s44, 1492992
    s_mul_i32 s47, s42, 331776
    s_add_u32 s52, s52, s47
    s_add_u32 s52, s52, 165888
    s_add_u32 s53, s52, 4096

    s_mul_i32 s54, s44, 1492992
    s_lshl_b32 s47, s41, 12
    s_add_u32 s54, s54, s47
    s_add_u32 s54, s54, 18432
    s_add_u32 s55, s54, 4096

    s_lshl_b32 s47, s41, 2
    s_add_u32 s47, s47, s44
    s_mul_i32 s47, s47, 9
    s_add_u32 s47, s47, 72
    s_lshl_b32 s56, s47, 15
    s_lshl_b32 s47, s43, 11
    s_add_u32 s56, s56, s47
    s_lshl_b32 s47, s40, 10
    s_add_u32 s56, s56, s47
    s_sub_u32 s56, s56, 256

    v_add_u32 v7, 128, v2
    v_mul_u32_u24 v8, 52429, v7
    v_lshrrev_b32 v8, 22, v8
    v_mul_u32_u24 v9, 80, v8
    v_sub_u32 v7, v7, v9
    v_lshlrev_b32 v7, 4, v7
    v_lshl_add_u32 v7, v8, 15, v7
    v_add_u32 v9, 2064384, v7
    v_cmp_le_u32 vcc, 9, v8
    s_mov_b32 m0, 141312
    s_nop 1
    v_cndmask_b32 v7, v7, v9, vcc
    buffer_load_dwordx4 v7, s[24:27], s56 offen lds

    v_add_u32 v7, 384, v2
    v_mul_u32_u24 v8, 52429, v7
    v_lshrrev_b32 v8, 22, v8
    v_mul_u32_u24 v9, 80, v8
    v_sub_u32 v7, v7, v9
    v_lshlrev_b32 v7, 4, v7
    v_lshl_add_u32 v7, v8, 15, v7
    v_add_u32 v9, 2064384, v7
    v_cmp_le_u32 vcc, 9, v8
    s_mov_b32 m0, 145408
    s_nop 1
    v_cndmask_b32 v7, v7, v9, vcc
    buffer_load_dwordx4 v7, s[24:27], s56 offen lds

    v_add_u32 v7, 640, v2
    v_mul_u32_u24 v8, 52429, v7
    v_lshrrev_b32 v8, 22, v8
    v_mul_u32_u24 v9, 80, v8
    v_sub_u32 v7, v7, v9
    v_lshlrev_b32 v7, 4, v7
    v_lshl_add_u32 v7, v8, 15, v7
    v_add_u32 v9, 2064384, v7
    v_cmp_le_u32 vcc, 9, v8
    s_mov_b32 m0, 149504
    s_nop 1
    v_cndmask_b32 v7, v7, v9, vcc
    buffer_load_dwordx4 v7, s[24:27], s56 offen lds

    v_add_u32 v7, 896, v2
    v_mul_u32_u24 v8, 52429, v7
    v_lshrrev_b32 v8, 22, v8
    v_mul_u32_u24 v9, 80, v8
    v_sub_u32 v7, v7, v9
    v_lshlrev_b32 v7, 4, v7
    v_lshl_add_u32 v7, v8, 15, v7
    v_add_u32 v9, 2064384, v7
    v_cmp_le_u32 vcc, 9, v8
    s_mov_b32 m0, 153600
    s_nop 1
    v_cndmask_b32 v7, v7, v9, vcc
    buffer_load_dwordx4 v7, s[24:27], s56 offen lds

    v_add_u32 v7, 1152, v2
    v_mul_u32_u24 v8, 52429, v7
    v_lshrrev_b32 v8, 22, v8
    v_mul_u32_u24 v9, 80, v8
    v_sub_u32 v7, v7, v9
    v_lshlrev_b32 v7, 4, v7
    v_lshl_add_u32 v7, v8, 15, v7
    v_add_u32 v9, 2064384, v7
    v_cmp_le_u32 vcc, 9, v8
    s_mov_b32 m0, 157696
    s_nop 1
    v_cndmask_b32 v7, v7, v9, vcc
    buffer_load_dwordx4 v7, s[24:27], s56 offen lds

    v_add_u32 v7, 1408, v2
    v_mul_u32_u24 v8, 52429, v7
    v_lshrrev_b32 v8, 22, v8
    v_mul_u32_u24 v9, 80, v8
    v_sub_u32 v7, v7, v9
    v_lshlrev_b32 v7, 4, v7
    v_lshl_add_u32 v7, v8, 15, v7
    v_add_u32 v9, 2064384, v7
    v_cmp_le_u32 vcc, 9, v8
    s_mov_b32 m0, 161792
    s_nop 1
    v_cndmask_b32 v7, v7, v9, vcc
    buffer_load_dwordx4 v7, s[24:27], s56 offen lds

    s_mov_b32 m0, 8192
    s_nop 0
    buffer_load_dwordx4 v6, s[20:23], s52 offen offset:0 lds
    buffer_load_dwordx4 v6, s[20:23], s52 offen offset:1024 lds
    buffer_load_dwordx4 v6, s[20:23], s52 offen offset:2048 lds
    buffer_load_dwordx4 v6, s[20:23], s52 offen offset:3072 lds
    s_mov_b32 m0, 12288
    s_add_u32 s52, s52, 9216
    buffer_load_dwordx4 v6, s[20:23], s53 offen lds
    s_add_u32 s53, s53, 9216
    s_mov_b32 m0, 25600
    s_nop 0
    buffer_load_dwordx4 v6, s[20:23], s52 offen offset:0 lds
    buffer_load_dwordx4 v6, s[20:23], s52 offen offset:1024 lds
    buffer_load_dwordx4 v6, s[20:23], s52 offen offset:2048 lds
    buffer_load_dwordx4 v6, s[20:23], s52 offen offset:3072 lds
    s_mov_b32 m0, 29696
    s_add_u32 s52, s52, 9216
    buffer_load_dwordx4 v6, s[20:23], s53 offen lds
    s_add_u32 s53, s53, 9216
    s_mov_b32 m0, 43008
    s_nop 0
    buffer_load_dwordx4 v6, s[20:23], s52 offen offset:0 lds
    buffer_load_dwordx4 v6, s[20:23], s52 offen offset:1024 lds
    buffer_load_dwordx4 v6, s[20:23], s52 offen offset:2048 lds
    buffer_load_dwordx4 v6, s[20:23], s52 offen offset:3072 lds
    s_mov_b32 m0, 47104
    s_add_u32 s52, s52, 9216
    buffer_load_dwordx4 v6, s[20:23], s53 offen lds
    s_add_u32 s53, s53, 9216
    s_waitcnt vmcnt(15)
    s_barrier
    s_mov_b32 m0, 60416
    s_nop 0
    buffer_load_dwordx4 v6, s[20:23], s52 offen offset:0 lds
    buffer_load_dwordx4 v6, s[20:23], s52 offen offset:1024 lds
    buffer_load_dwordx4 v6, s[20:23], s52 offen offset:2048 lds
    buffer_load_dwordx4 v6, s[20:23], s52 offen offset:3072 lds
    s_mov_b32 m0, 64512
    s_add_u32 s52, s52, 9216
    buffer_load_dwordx4 v6, s[20:23], s53 offen lds
    s_add_u32 s53, s53, 9216
    s_mov_b32 m0, 77824
    s_nop 0
    buffer_load_dwordx4 v6, s[20:23], s52 offen offset:0 lds
    buffer_load_dwordx4 v6, s[20:23], s52 offen offset:1024 lds
    buffer_load_dwordx4 v6, s[20:23], s52 offen offset:2048 lds
    buffer_load_dwordx4 v6, s[20:23], s52 offen offset:3072 lds
    s_mov_b32 m0, 81920
    s_add_u32 s52, s52, 9216
    buffer_load_dwordx4 v6, s[20:23], s53 offen lds
    s_add_u32 s53, s53, 9216
    s_mov_b32 m0, 95232
    s_nop 0
    buffer_load_dwordx4 v6, s[20:23], s52 offen offset:0 lds
    buffer_load_dwordx4 v6, s[20:23], s52 offen offset:1024 lds
    buffer_load_dwordx4 v6, s[20:23], s52 offen offset:2048 lds
    buffer_load_dwordx4 v6, s[20:23], s52 offen offset:3072 lds
    s_mov_b32 m0, 99328
    s_add_u32 s52, s52, 9216
    buffer_load_dwordx4 v6, s[20:23], s53 offen lds
    s_add_u32 s53, s53, 9216
    s_mov_b32 m0, 112640
    s_nop 0
    buffer_load_dwordx4 v6, s[20:23], s52 offen offset:0 lds
    buffer_load_dwordx4 v6, s[20:23], s52 offen offset:1024 lds
    buffer_load_dwordx4 v6, s[20:23], s52 offen offset:2048 lds
    buffer_load_dwordx4 v6, s[20:23], s52 offen offset:3072 lds
    s_mov_b32 m0, 116736
    s_add_u32 s52, s52, 9216
    buffer_load_dwordx4 v6, s[20:23], s53 offen lds
    s_add_u32 s53, s53, 9216
    s_mov_b32 m0, 130048
    s_nop 0
    buffer_load_dwordx4 v6, s[20:23], s52 offen offset:0 lds
    buffer_load_dwordx4 v6, s[20:23], s52 offen offset:1024 lds
    buffer_load_dwordx4 v6, s[20:23], s52 offen offset:2048 lds
    buffer_load_dwordx4 v6, s[20:23], s52 offen offset:3072 lds
    s_mov_b32 m0, 134144
    s_add_u32 s52, s52, 9216
    buffer_load_dwordx4 v6, s[20:23], s53 offen lds
    s_add_u32 s53, s53, 9216
    s_waitcnt vmcnt(35)
    s_barrier
    s_waitcnt vmcnt(30)
    s_barrier
    s_mov_b32 m0, 8192
    s_nop 0
    buffer_load_dwordx4 v6, s[20:23], s52 offen offset:0 lds
    buffer_load_dwordx4 v6, s[20:23], s52 offen offset:1024 lds
    buffer_load_dwordx4 v6, s[20:23], s52 offen offset:2048 lds
    buffer_load_dwordx4 v6, s[20:23], s52 offen offset:3072 lds
    s_mov_b32 m0, 12288
    s_add_u32 s52, s52, 9216
    buffer_load_dwordx4 v6, s[20:23], s53 offen lds
    s_add_u32 s53, s53, 9216
    s_waitcnt vmcnt(25)
    s_barrier
    s_mov_b32 m0, 25600
    s_nop 0
    buffer_load_dwordx4 v6, s[20:23], s52 offen offset:0 lds
    buffer_load_dwordx4 v6, s[20:23], s52 offen offset:1024 lds
    buffer_load_dwordx4 v6, s[20:23], s52 offen offset:2048 lds
    buffer_load_dwordx4 v6, s[20:23], s52 offen offset:3072 lds
    s_mov_b32 m0, 29696
    s_add_u32 s52, s52, 9216
    buffer_load_dwordx4 v6, s[20:23], s53 offen lds
    s_add_u32 s53, s53, 9216
    s_waitcnt vmcnt(20)
    s_barrier
    s_mov_b32 m0, 43008
    s_nop 0
    buffer_load_dwordx4 v6, s[20:23], s52 offen offset:0 lds
    buffer_load_dwordx4 v6, s[20:23], s52 offen offset:1024 lds
    buffer_load_dwordx4 v6, s[20:23], s52 offen offset:2048 lds
    buffer_load_dwordx4 v6, s[20:23], s52 offen offset:3072 lds
    s_mov_b32 m0, 47104
    s_add_u32 s52, s52, 9216
    buffer_load_dwordx4 v6, s[20:23], s53 offen lds
    s_add_u32 s53, s53, 9216
    s_mov_b32 m0, 60416
    s_nop 0
    buffer_load_dwordx4 v6, s[20:23], s52 offen offset:0 lds
    buffer_load_dwordx4 v6, s[20:23], s52 offen offset:1024 lds
    buffer_load_dwordx4 v6, s[20:23], s52 offen offset:2048 lds
    buffer_load_dwordx4 v6, s[20:23], s52 offen offset:3072 lds
    s_mov_b32 m0, 64512
    s_add_u32 s52, s52, 9216
    buffer_load_dwordx4 v6, s[20:23], s53 offen lds
    s_add_u32 s53, s53, 9216
    s_waitcnt vmcnt(20)
    s_barrier
    s_mov_b32 m0, 77824
    s_nop 0
    buffer_load_dwordx4 v6, s[20:23], s52 offen offset:0 lds
    buffer_load_dwordx4 v6, s[20:23], s52 offen offset:1024 lds
    buffer_load_dwordx4 v6, s[20:23], s52 offen offset:2048 lds
    buffer_load_dwordx4 v6, s[20:23], s52 offen offset:3072 lds
    s_mov_b32 m0, 81920
    s_add_u32 s52, s52, 9216
    buffer_load_dwordx4 v6, s[20:23], s53 offen lds
    s_add_u32 s53, s53, 9216
    s_mov_b32 m0, 95232
    s_nop 0
    buffer_load_dwordx4 v6, s[20:23], s52 offen offset:0 lds
    buffer_load_dwordx4 v6, s[20:23], s52 offen offset:1024 lds
    buffer_load_dwordx4 v6, s[20:23], s52 offen offset:2048 lds
    buffer_load_dwordx4 v6, s[20:23], s52 offen offset:3072 lds
    s_mov_b32 m0, 99328
    s_add_u32 s52, s52, 9216
    buffer_load_dwordx4 v6, s[20:23], s53 offen lds
    s_add_u32 s53, s53, 9216
    s_waitcnt vmcnt(20)
    s_barrier
    s_mov_b32 m0, 112640
    s_nop 0
    buffer_load_dwordx4 v6, s[20:23], s52 offen offset:0 lds
    buffer_load_dwordx4 v6, s[20:23], s52 offen offset:1024 lds
    buffer_load_dwordx4 v6, s[20:23], s52 offen offset:2048 lds
    buffer_load_dwordx4 v6, s[20:23], s52 offen offset:3072 lds
    s_mov_b32 m0, 116736
    s_add_u32 s52, s52, 9216
    buffer_load_dwordx4 v6, s[20:23], s53 offen lds
    s_add_u32 s53, s53, 9216
    s_mov_b32 m0, 130048
    s_nop 0
    buffer_load_dwordx4 v6, s[20:23], s52 offen offset:0 lds
    buffer_load_dwordx4 v6, s[20:23], s52 offen offset:1024 lds
    buffer_load_dwordx4 v6, s[20:23], s52 offen offset:2048 lds
    buffer_load_dwordx4 v6, s[20:23], s52 offen offset:3072 lds
    s_mov_b32 m0, 134144
    s_add_u32 s52, s52, 9216
    buffer_load_dwordx4 v6, s[20:23], s53 offen lds
    s_add_u32 s53, s53, 9216
    s_waitcnt vmcnt(20)
    s_barrier
    s_mov_b32 m0, 8192
    s_nop 0
    buffer_load_dwordx4 v6, s[20:23], s52 offen offset:0 lds
    buffer_load_dwordx4 v6, s[20:23], s52 offen offset:1024 lds
    buffer_load_dwordx4 v6, s[20:23], s52 offen offset:2048 lds
    buffer_load_dwordx4 v6, s[20:23], s52 offen offset:3072 lds
    s_mov_b32 m0, 12288
    s_add_u32 s52, s52, 9216
    buffer_load_dwordx4 v6, s[20:23], s53 offen lds
    s_add_u32 s53, s53, 9216
    s_mov_b32 m0, 25600
    s_nop 0
    buffer_load_dwordx4 v6, s[20:23], s52 offen offset:0 lds
    buffer_load_dwordx4 v6, s[20:23], s52 offen offset:1024 lds
    buffer_load_dwordx4 v6, s[20:23], s52 offen offset:2048 lds
    buffer_load_dwordx4 v6, s[20:23], s52 offen offset:3072 lds
    s_mov_b32 m0, 29696
    s_add_u32 s52, s52, 9216
    buffer_load_dwordx4 v6, s[20:23], s53 offen lds
    s_add_u32 s53, s53, 9216
    s_waitcnt vmcnt(20)
    s_barrier
    s_mov_b32 m0, 43008
    s_nop 0
    buffer_load_dwordx4 v6, s[20:23], s52 offen offset:0 lds
    buffer_load_dwordx4 v6, s[20:23], s52 offen offset:1024 lds
    buffer_load_dwordx4 v6, s[20:23], s52 offen offset:2048 lds
    buffer_load_dwordx4 v6, s[20:23], s52 offen offset:3072 lds
    s_mov_b32 m0, 47104
    s_add_u32 s52, s52, 9216
    buffer_load_dwordx4 v6, s[20:23], s53 offen lds
    s_add_u32 s53, s53, 9216
    s_mov_b32 m0, 60416
    s_nop 0
    buffer_load_dwordx4 v6, s[20:23], s52 offen offset:0 lds
    buffer_load_dwordx4 v6, s[20:23], s52 offen offset:1024 lds
    buffer_load_dwordx4 v6, s[20:23], s52 offen offset:2048 lds
    buffer_load_dwordx4 v6, s[20:23], s52 offen offset:3072 lds
    s_mov_b32 m0, 64512
    s_add_u32 s52, s52, 9216
    buffer_load_dwordx4 v6, s[20:23], s53 offen lds
    s_add_u32 s53, s53, 9216
    s_waitcnt vmcnt(20)
    s_barrier
    s_mov_b32 m0, 77824
    s_nop 0
    buffer_load_dwordx4 v6, s[20:23], s52 offen offset:0 lds
    buffer_load_dwordx4 v6, s[20:23], s52 offen offset:1024 lds
    buffer_load_dwordx4 v6, s[20:23], s52 offen offset:2048 lds
    buffer_load_dwordx4 v6, s[20:23], s52 offen offset:3072 lds
    s_mov_b32 m0, 81920
    s_add_u32 s52, s52, 9216
    buffer_load_dwordx4 v6, s[20:23], s53 offen lds
    s_add_u32 s53, s53, 9216
    s_mov_b32 m0, 95232
    s_nop 0
    buffer_load_dwordx4 v6, s[20:23], s52 offen offset:0 lds
    buffer_load_dwordx4 v6, s[20:23], s52 offen offset:1024 lds
    buffer_load_dwordx4 v6, s[20:23], s52 offen offset:2048 lds
    buffer_load_dwordx4 v6, s[20:23], s52 offen offset:3072 lds
    s_mov_b32 m0, 99328
    s_add_u32 s52, s52, 9216
    buffer_load_dwordx4 v6, s[20:23], s53 offen lds
    s_add_u32 s53, s53, 9216
    s_waitcnt vmcnt(20)
    s_barrier
    s_mov_b32 m0, 112640
    s_nop 0
    buffer_load_dwordx4 v6, s[20:23], s52 offen offset:0 lds
    buffer_load_dwordx4 v6, s[20:23], s52 offen offset:1024 lds
    buffer_load_dwordx4 v6, s[20:23], s52 offen offset:2048 lds
    buffer_load_dwordx4 v6, s[20:23], s52 offen offset:3072 lds
    s_mov_b32 m0, 116736
    s_add_u32 s52, s52, 9216
    buffer_load_dwordx4 v6, s[20:23], s53 offen lds
    s_add_u32 s53, s53, 9216
    s_mov_b32 m0, 130048
    s_nop 0
    buffer_load_dwordx4 v6, s[20:23], s52 offen offset:0 lds
    buffer_load_dwordx4 v6, s[20:23], s52 offen offset:1024 lds
    buffer_load_dwordx4 v6, s[20:23], s52 offen offset:2048 lds
    buffer_load_dwordx4 v6, s[20:23], s52 offen offset:3072 lds
    s_mov_b32 m0, 134144
    s_add_u32 s52, s52, 9216
    buffer_load_dwordx4 v6, s[20:23], s53 offen lds
    s_add_u32 s53, s53, 9216
    s_waitcnt vmcnt(20)
    s_barrier
    s_mov_b32 m0, 8192
    s_nop 0
    buffer_load_dwordx4 v6, s[20:23], s52 offen offset:0 lds
    buffer_load_dwordx4 v6, s[20:23], s52 offen offset:1024 lds
    buffer_load_dwordx4 v6, s[20:23], s52 offen offset:2048 lds
    buffer_load_dwordx4 v6, s[20:23], s52 offen offset:3072 lds
    s_mov_b32 m0, 12288
    s_add_u32 s52, s52, 9216
    buffer_load_dwordx4 v6, s[20:23], s53 offen lds
    s_add_u32 s53, s53, 9216
    s_mov_b32 m0, 25600
    s_nop 0
    buffer_load_dwordx4 v6, s[20:23], s52 offen offset:0 lds
    buffer_load_dwordx4 v6, s[20:23], s52 offen offset:1024 lds
    buffer_load_dwordx4 v6, s[20:23], s52 offen offset:2048 lds
    buffer_load_dwordx4 v6, s[20:23], s52 offen offset:3072 lds
    s_mov_b32 m0, 29696
    s_add_u32 s52, s52, 9216
    buffer_load_dwordx4 v6, s[20:23], s53 offen lds
    s_add_u32 s53, s53, 9216
    s_waitcnt vmcnt(20)
    s_barrier
    s_mov_b32 m0, 43008
    s_nop 0
    buffer_load_dwordx4 v6, s[20:23], s52 offen offset:0 lds
    buffer_load_dwordx4 v6, s[20:23], s52 offen offset:1024 lds
    buffer_load_dwordx4 v6, s[20:23], s52 offen offset:2048 lds
    buffer_load_dwordx4 v6, s[20:23], s52 offen offset:3072 lds
    s_mov_b32 m0, 47104
    s_add_u32 s52, s52, 9216
    buffer_load_dwordx4 v6, s[20:23], s53 offen lds
    s_add_u32 s53, s53, 9216
    s_mov_b32 m0, 60416
    s_nop 0
    buffer_load_dwordx4 v6, s[20:23], s52 offen offset:0 lds
    buffer_load_dwordx4 v6, s[20:23], s52 offen offset:1024 lds
    buffer_load_dwordx4 v6, s[20:23], s52 offen offset:2048 lds
    buffer_load_dwordx4 v6, s[20:23], s52 offen offset:3072 lds
    s_mov_b32 m0, 64512
    s_add_u32 s52, s52, 9216
    buffer_load_dwordx4 v6, s[20:23], s53 offen lds
    s_add_u32 s53, s53, 9216
    s_waitcnt vmcnt(20)
    s_barrier
    s_mov_b32 m0, 77824
    s_nop 0
    buffer_load_dwordx4 v6, s[20:23], s52 offen offset:0 lds
    buffer_load_dwordx4 v6, s[20:23], s52 offen offset:1024 lds
    buffer_load_dwordx4 v6, s[20:23], s52 offen offset:2048 lds
    buffer_load_dwordx4 v6, s[20:23], s52 offen offset:3072 lds
    s_mov_b32 m0, 81920
    s_add_u32 s52, s52, 9216
    buffer_load_dwordx4 v6, s[20:23], s53 offen lds
    s_add_u32 s53, s53, 9216
    s_mov_b32 m0, 95232
    s_nop 0
    buffer_load_dwordx4 v6, s[20:23], s52 offen offset:0 lds
    buffer_load_dwordx4 v6, s[20:23], s52 offen offset:1024 lds
    buffer_load_dwordx4 v6, s[20:23], s52 offen offset:2048 lds
    buffer_load_dwordx4 v6, s[20:23], s52 offen offset:3072 lds
    s_mov_b32 m0, 99328
    s_add_u32 s52, s52, 9216
    buffer_load_dwordx4 v6, s[20:23], s53 offen lds
    s_add_u32 s53, s53, 9216
    s_waitcnt vmcnt(20)
    s_barrier
    s_mov_b32 m0, 112640
    s_nop 0
    buffer_load_dwordx4 v6, s[20:23], s52 offen offset:0 lds
    buffer_load_dwordx4 v6, s[20:23], s52 offen offset:1024 lds
    buffer_load_dwordx4 v6, s[20:23], s52 offen offset:2048 lds
    buffer_load_dwordx4 v6, s[20:23], s52 offen offset:3072 lds
    s_mov_b32 m0, 116736
    s_add_u32 s52, s52, 9216
    buffer_load_dwordx4 v6, s[20:23], s53 offen lds
    s_add_u32 s53, s53, 9216
    s_mov_b32 m0, 130048
    s_nop 0
    buffer_load_dwordx4 v6, s[20:23], s52 offen offset:0 lds
    buffer_load_dwordx4 v6, s[20:23], s52 offen offset:1024 lds
    buffer_load_dwordx4 v6, s[20:23], s52 offen offset:2048 lds
    buffer_load_dwordx4 v6, s[20:23], s52 offen offset:3072 lds
    s_mov_b32 m0, 134144
    s_add_u32 s52, s52, 9216
    buffer_load_dwordx4 v6, s[20:23], s53 offen lds
    s_add_u32 s53, s53, 9216
    s_waitcnt vmcnt(20)
    s_barrier
    s_mov_b32 m0, 8192
    s_nop 0
    buffer_load_dwordx4 v6, s[20:23], s52 offen offset:0 lds
    buffer_load_dwordx4 v6, s[20:23], s52 offen offset:1024 lds
    buffer_load_dwordx4 v6, s[20:23], s52 offen offset:2048 lds
    buffer_load_dwordx4 v6, s[20:23], s52 offen offset:3072 lds
    s_mov_b32 m0, 12288
    s_add_u32 s52, s52, 9216
    buffer_load_dwordx4 v6, s[20:23], s53 offen lds
    s_add_u32 s53, s53, 9216
    s_mov_b32 m0, 25600
    s_nop 0
    buffer_load_dwordx4 v6, s[20:23], s52 offen offset:0 lds
    buffer_load_dwordx4 v6, s[20:23], s52 offen offset:1024 lds
    buffer_load_dwordx4 v6, s[20:23], s52 offen offset:2048 lds
    buffer_load_dwordx4 v6, s[20:23], s52 offen offset:3072 lds
    s_mov_b32 m0, 29696
    s_add_u32 s52, s52, 9216
    buffer_load_dwordx4 v6, s[20:23], s53 offen lds
    s_add_u32 s53, s53, 9216
    s_waitcnt vmcnt(20)
    s_barrier
    s_mov_b32 m0, 43008
    s_nop 0
    buffer_load_dwordx4 v6, s[20:23], s52 offen offset:0 lds
    buffer_load_dwordx4 v6, s[20:23], s52 offen offset:1024 lds
    buffer_load_dwordx4 v6, s[20:23], s52 offen offset:2048 lds
    buffer_load_dwordx4 v6, s[20:23], s52 offen offset:3072 lds
    s_mov_b32 m0, 47104
    s_add_u32 s52, s52, 9216
    buffer_load_dwordx4 v6, s[20:23], s53 offen lds
    s_add_u32 s53, s53, 9216
    s_mov_b32 m0, 60416
    s_nop 0
    buffer_load_dwordx4 v6, s[20:23], s52 offen offset:0 lds
    buffer_load_dwordx4 v6, s[20:23], s52 offen offset:1024 lds
    buffer_load_dwordx4 v6, s[20:23], s52 offen offset:2048 lds
    buffer_load_dwordx4 v6, s[20:23], s52 offen offset:3072 lds
    s_mov_b32 m0, 64512
    s_add_u32 s52, s52, 9216
    buffer_load_dwordx4 v6, s[20:23], s53 offen lds
    s_add_u32 s53, s53, 9216
    s_waitcnt vmcnt(20)
    s_barrier
    s_mov_b32 m0, 79872
    s_nop 0
    buffer_load_dwordx4 v6, s[20:23], s54 offen offset:0 lds
    buffer_load_dwordx4 v6, s[20:23], s54 offen offset:1024 lds
    buffer_load_dwordx4 v6, s[20:23], s54 offen offset:2048 lds
    buffer_load_dwordx4 v6, s[20:23], s54 offen offset:3072 lds
    s_mov_b32 m0, 83968
    s_add_u32 s54, s54, 27648
    buffer_load_dwordx4 v6, s[20:23], s55 offen lds
    s_add_u32 s55, s55, 27648
    s_mov_b32 m0, 97280
    s_nop 0
    buffer_load_dwordx4 v6, s[20:23], s54 offen offset:0 lds
    buffer_load_dwordx4 v6, s[20:23], s54 offen offset:1024 lds
    buffer_load_dwordx4 v6, s[20:23], s54 offen offset:2048 lds
    buffer_load_dwordx4 v6, s[20:23], s54 offen offset:3072 lds
    s_mov_b32 m0, 101376
    s_add_u32 s54, s54, 27648
    buffer_load_dwordx4 v6, s[20:23], s55 offen lds
    s_add_u32 s55, s55, 27648
    s_waitcnt vmcnt(20)
    s_barrier
    s_mov_b32 m0, 114688
    s_nop 0
    buffer_load_dwordx4 v6, s[20:23], s54 offen offset:0 lds
    buffer_load_dwordx4 v6, s[20:23], s54 offen offset:1024 lds
    buffer_load_dwordx4 v6, s[20:23], s54 offen offset:2048 lds
    buffer_load_dwordx4 v6, s[20:23], s54 offen offset:3072 lds
    s_mov_b32 m0, 118784
    s_add_u32 s54, s54, 27648
    buffer_load_dwordx4 v6, s[20:23], s55 offen lds
    s_add_u32 s55, s55, 27648
    s_mov_b32 m0, 132096
    s_nop 0
    buffer_load_dwordx4 v6, s[20:23], s54 offen offset:0 lds
    buffer_load_dwordx4 v6, s[20:23], s54 offen offset:1024 lds
    buffer_load_dwordx4 v6, s[20:23], s54 offen offset:2048 lds
    buffer_load_dwordx4 v6, s[20:23], s54 offen offset:3072 lds
    s_mov_b32 m0, 136192
    s_add_u32 s54, s54, 27648
    buffer_load_dwordx4 v6, s[20:23], s55 offen lds
    s_add_u32 s55, s55, 27648
    s_waitcnt vmcnt(20)
    s_barrier
    s_mov_b32 m0, 10240
    s_nop 0
    buffer_load_dwordx4 v6, s[20:23], s54 offen offset:0 lds
    buffer_load_dwordx4 v6, s[20:23], s54 offen offset:1024 lds
    buffer_load_dwordx4 v6, s[20:23], s54 offen offset:2048 lds
    buffer_load_dwordx4 v6, s[20:23], s54 offen offset:3072 lds
    s_mov_b32 m0, 14336
    s_add_u32 s54, s54, 27648
    buffer_load_dwordx4 v6, s[20:23], s55 offen lds
    s_add_u32 s55, s55, 27648
    s_mov_b32 m0, 27648
    s_nop 0
    buffer_load_dwordx4 v6, s[20:23], s54 offen offset:0 lds
    buffer_load_dwordx4 v6, s[20:23], s54 offen offset:1024 lds
    buffer_load_dwordx4 v6, s[20:23], s54 offen offset:2048 lds
    buffer_load_dwordx4 v6, s[20:23], s54 offen offset:3072 lds
    s_mov_b32 m0, 31744
    s_add_u32 s54, s54, 27648
    buffer_load_dwordx4 v6, s[20:23], s55 offen lds
    s_add_u32 s55, s55, 27648
    s_waitcnt vmcnt(20)
    s_barrier
    s_waitcnt vmcnt(10)
    s_barrier
    s_waitcnt vmcnt(0)
    s_barrier
    s_endpgm
L_k3prod3_21:
    s_mul_i32 s52, s44, 1492992
    s_mul_i32 s47, s42, 331776
    s_add_u32 s52, s52, s47
    s_add_u32 s52, s52, 171008
    s_add_u32 s53, s52, 4096

    s_mul_i32 s54, s44, 1492992
    s_lshl_b32 s47, s41, 12
    s_add_u32 s54, s54, s47
    s_add_u32 s54, s54, 27648
    s_add_u32 s55, s54, 4096

    s_lshl_b32 s47, s41, 2
    s_add_u32 s47, s47, s44
    s_mul_i32 s47, s47, 9
    s_add_u32 s47, s47, 72
    s_lshl_b32 s56, s47, 15
    s_lshl_b32 s47, s43, 11
    s_add_u32 s56, s56, s47
    s_lshl_b32 s47, s40, 10
    s_add_u32 s56, s56, s47
    s_sub_u32 s56, s56, 256

    v_add_u32 v7, 192, v2
    v_mul_u32_u24 v8, 52429, v7
    v_lshrrev_b32 v8, 22, v8
    v_mul_u32_u24 v9, 80, v8
    v_sub_u32 v7, v7, v9
    v_lshlrev_b32 v7, 4, v7
    v_lshl_add_u32 v7, v8, 15, v7
    v_add_u32 v9, 2064384, v7
    v_cmp_le_u32 vcc, 9, v8
    s_mov_b32 m0, 142336
    s_nop 1
    v_cndmask_b32 v7, v7, v9, vcc
    buffer_load_dwordx4 v7, s[24:27], s56 offen lds

    v_add_u32 v7, 448, v2
    v_mul_u32_u24 v8, 52429, v7
    v_lshrrev_b32 v8, 22, v8
    v_mul_u32_u24 v9, 80, v8
    v_sub_u32 v7, v7, v9
    v_lshlrev_b32 v7, 4, v7
    v_lshl_add_u32 v7, v8, 15, v7
    v_add_u32 v9, 2064384, v7
    v_cmp_le_u32 vcc, 9, v8
    s_mov_b32 m0, 146432
    s_nop 1
    v_cndmask_b32 v7, v7, v9, vcc
    buffer_load_dwordx4 v7, s[24:27], s56 offen lds

    v_add_u32 v7, 704, v2
    v_mul_u32_u24 v8, 52429, v7
    v_lshrrev_b32 v8, 22, v8
    v_mul_u32_u24 v9, 80, v8
    v_sub_u32 v7, v7, v9
    v_lshlrev_b32 v7, 4, v7
    v_lshl_add_u32 v7, v8, 15, v7
    v_add_u32 v9, 2064384, v7
    v_cmp_le_u32 vcc, 9, v8
    s_mov_b32 m0, 150528
    s_nop 1
    v_cndmask_b32 v7, v7, v9, vcc
    buffer_load_dwordx4 v7, s[24:27], s56 offen lds

    v_add_u32 v7, 960, v2
    v_mul_u32_u24 v8, 52429, v7
    v_lshrrev_b32 v8, 22, v8
    v_mul_u32_u24 v9, 80, v8
    v_sub_u32 v7, v7, v9
    v_lshlrev_b32 v7, 4, v7
    v_lshl_add_u32 v7, v8, 15, v7
    v_add_u32 v9, 2064384, v7
    v_cmp_le_u32 vcc, 9, v8
    s_mov_b32 m0, 154624
    s_nop 1
    v_cndmask_b32 v7, v7, v9, vcc
    buffer_load_dwordx4 v7, s[24:27], s56 offen lds

    v_add_u32 v7, 1216, v2
    v_mul_u32_u24 v8, 52429, v7
    v_lshrrev_b32 v8, 22, v8
    v_mul_u32_u24 v9, 80, v8
    v_sub_u32 v7, v7, v9
    v_lshlrev_b32 v7, 4, v7
    v_lshl_add_u32 v7, v8, 15, v7
    v_add_u32 v9, 2064384, v7
    v_cmp_le_u32 vcc, 9, v8
    s_mov_b32 m0, 158720
    s_nop 1
    v_cndmask_b32 v7, v7, v9, vcc
    buffer_load_dwordx4 v7, s[24:27], s56 offen lds

    s_mov_b32 m0, 13312
    s_nop 0
    buffer_load_dwordx4 v6, s[20:23], s52 offen offset:0 lds
    buffer_load_dwordx4 v6, s[20:23], s52 offen offset:1024 lds
    buffer_load_dwordx4 v6, s[20:23], s52 offen offset:2048 lds
    buffer_load_dwordx4 v6, s[20:23], s52 offen offset:3072 lds
    s_add_u32 s52, s52, 9216
    s_mov_b32 m0, 30720
    s_nop 0
    buffer_load_dwordx4 v6, s[20:23], s52 offen offset:0 lds
    buffer_load_dwordx4 v6, s[20:23], s52 offen offset:1024 lds
    buffer_load_dwordx4 v6, s[20:23], s52 offen offset:2048 lds
    buffer_load_dwordx4 v6, s[20:23], s52 offen offset:3072 lds
    s_add_u32 s52, s52, 9216
    s_mov_b32 m0, 48128
    s_nop 0
    buffer_load_dwordx4 v6, s[20:23], s52 offen offset:0 lds
    buffer_load_dwordx4 v6, s[20:23], s52 offen offset:1024 lds
    buffer_load_dwordx4 v6, s[20:23], s52 offen offset:2048 lds
    buffer_load_dwordx4 v6, s[20:23], s52 offen offset:3072 lds
    s_add_u32 s52, s52, 9216
    s_waitcnt vmcnt(12)
    s_barrier
    s_mov_b32 m0, 65536
    s_nop 0
    buffer_load_dwordx4 v6, s[20:23], s52 offen offset:0 lds
    buffer_load_dwordx4 v6, s[20:23], s52 offen offset:1024 lds
    buffer_load_dwordx4 v6, s[20:23], s52 offen offset:2048 lds
    buffer_load_dwordx4 v6, s[20:23], s52 offen offset:3072 lds
    s_add_u32 s52, s52, 9216
    s_mov_b32 m0, 82944
    s_nop 0
    buffer_load_dwordx4 v6, s[20:23], s52 offen offset:0 lds
    buffer_load_dwordx4 v6, s[20:23], s52 offen offset:1024 lds
    buffer_load_dwordx4 v6, s[20:23], s52 offen offset:2048 lds
    buffer_load_dwordx4 v6, s[20:23], s52 offen offset:3072 lds
    s_add_u32 s52, s52, 9216
    s_mov_b32 m0, 100352
    s_nop 0
    buffer_load_dwordx4 v6, s[20:23], s52 offen offset:0 lds
    buffer_load_dwordx4 v6, s[20:23], s52 offen offset:1024 lds
    buffer_load_dwordx4 v6, s[20:23], s52 offen offset:2048 lds
    buffer_load_dwordx4 v6, s[20:23], s52 offen offset:3072 lds
    s_add_u32 s52, s52, 9216
    s_mov_b32 m0, 117760
    s_nop 0
    buffer_load_dwordx4 v6, s[20:23], s52 offen offset:0 lds
    buffer_load_dwordx4 v6, s[20:23], s52 offen offset:1024 lds
    buffer_load_dwordx4 v6, s[20:23], s52 offen offset:2048 lds
    buffer_load_dwordx4 v6, s[20:23], s52 offen offset:3072 lds
    s_add_u32 s52, s52, 9216
    s_mov_b32 m0, 135168
    s_nop 0
    buffer_load_dwordx4 v6, s[20:23], s52 offen offset:0 lds
    buffer_load_dwordx4 v6, s[20:23], s52 offen offset:1024 lds
    buffer_load_dwordx4 v6, s[20:23], s52 offen offset:2048 lds
    buffer_load_dwordx4 v6, s[20:23], s52 offen offset:3072 lds
    s_add_u32 s52, s52, 9216
    s_waitcnt vmcnt(28)
    s_barrier
    s_waitcnt vmcnt(24)
    s_barrier
    s_mov_b32 m0, 13312
    s_nop 0
    buffer_load_dwordx4 v6, s[20:23], s52 offen offset:0 lds
    buffer_load_dwordx4 v6, s[20:23], s52 offen offset:1024 lds
    buffer_load_dwordx4 v6, s[20:23], s52 offen offset:2048 lds
    buffer_load_dwordx4 v6, s[20:23], s52 offen offset:3072 lds
    s_add_u32 s52, s52, 9216
    s_waitcnt vmcnt(20)
    s_barrier
    s_mov_b32 m0, 30720
    s_nop 0
    buffer_load_dwordx4 v6, s[20:23], s52 offen offset:0 lds
    buffer_load_dwordx4 v6, s[20:23], s52 offen offset:1024 lds
    buffer_load_dwordx4 v6, s[20:23], s52 offen offset:2048 lds
    buffer_load_dwordx4 v6, s[20:23], s52 offen offset:3072 lds
    s_add_u32 s52, s52, 9216
    s_waitcnt vmcnt(16)
    s_barrier
    s_mov_b32 m0, 48128
    s_nop 0
    buffer_load_dwordx4 v6, s[20:23], s52 offen offset:0 lds
    buffer_load_dwordx4 v6, s[20:23], s52 offen offset:1024 lds
    buffer_load_dwordx4 v6, s[20:23], s52 offen offset:2048 lds
    buffer_load_dwordx4 v6, s[20:23], s52 offen offset:3072 lds
    s_add_u32 s52, s52, 9216
    s_mov_b32 m0, 65536
    s_nop 0
    buffer_load_dwordx4 v6, s[20:23], s52 offen offset:0 lds
    buffer_load_dwordx4 v6, s[20:23], s52 offen offset:1024 lds
    buffer_load_dwordx4 v6, s[20:23], s52 offen offset:2048 lds
    buffer_load_dwordx4 v6, s[20:23], s52 offen offset:3072 lds
    s_add_u32 s52, s52, 9216
    s_waitcnt vmcnt(16)
    s_barrier
    s_mov_b32 m0, 82944
    s_nop 0
    buffer_load_dwordx4 v6, s[20:23], s52 offen offset:0 lds
    buffer_load_dwordx4 v6, s[20:23], s52 offen offset:1024 lds
    buffer_load_dwordx4 v6, s[20:23], s52 offen offset:2048 lds
    buffer_load_dwordx4 v6, s[20:23], s52 offen offset:3072 lds
    s_add_u32 s52, s52, 9216
    s_mov_b32 m0, 100352
    s_nop 0
    buffer_load_dwordx4 v6, s[20:23], s52 offen offset:0 lds
    buffer_load_dwordx4 v6, s[20:23], s52 offen offset:1024 lds
    buffer_load_dwordx4 v6, s[20:23], s52 offen offset:2048 lds
    buffer_load_dwordx4 v6, s[20:23], s52 offen offset:3072 lds
    s_add_u32 s52, s52, 9216
    s_waitcnt vmcnt(16)
    s_barrier
    s_mov_b32 m0, 117760
    s_nop 0
    buffer_load_dwordx4 v6, s[20:23], s52 offen offset:0 lds
    buffer_load_dwordx4 v6, s[20:23], s52 offen offset:1024 lds
    buffer_load_dwordx4 v6, s[20:23], s52 offen offset:2048 lds
    buffer_load_dwordx4 v6, s[20:23], s52 offen offset:3072 lds
    s_add_u32 s52, s52, 9216
    s_mov_b32 m0, 135168
    s_nop 0
    buffer_load_dwordx4 v6, s[20:23], s52 offen offset:0 lds
    buffer_load_dwordx4 v6, s[20:23], s52 offen offset:1024 lds
    buffer_load_dwordx4 v6, s[20:23], s52 offen offset:2048 lds
    buffer_load_dwordx4 v6, s[20:23], s52 offen offset:3072 lds
    s_add_u32 s52, s52, 9216
    s_waitcnt vmcnt(16)
    s_barrier
    s_mov_b32 m0, 13312
    s_nop 0
    buffer_load_dwordx4 v6, s[20:23], s52 offen offset:0 lds
    buffer_load_dwordx4 v6, s[20:23], s52 offen offset:1024 lds
    buffer_load_dwordx4 v6, s[20:23], s52 offen offset:2048 lds
    buffer_load_dwordx4 v6, s[20:23], s52 offen offset:3072 lds
    s_add_u32 s52, s52, 9216
    s_mov_b32 m0, 30720
    s_nop 0
    buffer_load_dwordx4 v6, s[20:23], s52 offen offset:0 lds
    buffer_load_dwordx4 v6, s[20:23], s52 offen offset:1024 lds
    buffer_load_dwordx4 v6, s[20:23], s52 offen offset:2048 lds
    buffer_load_dwordx4 v6, s[20:23], s52 offen offset:3072 lds
    s_add_u32 s52, s52, 9216
    s_waitcnt vmcnt(16)
    s_barrier
    s_mov_b32 m0, 48128
    s_nop 0
    buffer_load_dwordx4 v6, s[20:23], s52 offen offset:0 lds
    buffer_load_dwordx4 v6, s[20:23], s52 offen offset:1024 lds
    buffer_load_dwordx4 v6, s[20:23], s52 offen offset:2048 lds
    buffer_load_dwordx4 v6, s[20:23], s52 offen offset:3072 lds
    s_add_u32 s52, s52, 9216
    s_mov_b32 m0, 65536
    s_nop 0
    buffer_load_dwordx4 v6, s[20:23], s52 offen offset:0 lds
    buffer_load_dwordx4 v6, s[20:23], s52 offen offset:1024 lds
    buffer_load_dwordx4 v6, s[20:23], s52 offen offset:2048 lds
    buffer_load_dwordx4 v6, s[20:23], s52 offen offset:3072 lds
    s_add_u32 s52, s52, 9216
    s_waitcnt vmcnt(16)
    s_barrier
    s_mov_b32 m0, 82944
    s_nop 0
    buffer_load_dwordx4 v6, s[20:23], s52 offen offset:0 lds
    buffer_load_dwordx4 v6, s[20:23], s52 offen offset:1024 lds
    buffer_load_dwordx4 v6, s[20:23], s52 offen offset:2048 lds
    buffer_load_dwordx4 v6, s[20:23], s52 offen offset:3072 lds
    s_add_u32 s52, s52, 9216
    s_mov_b32 m0, 100352
    s_nop 0
    buffer_load_dwordx4 v6, s[20:23], s52 offen offset:0 lds
    buffer_load_dwordx4 v6, s[20:23], s52 offen offset:1024 lds
    buffer_load_dwordx4 v6, s[20:23], s52 offen offset:2048 lds
    buffer_load_dwordx4 v6, s[20:23], s52 offen offset:3072 lds
    s_add_u32 s52, s52, 9216
    s_waitcnt vmcnt(16)
    s_barrier
    s_mov_b32 m0, 117760
    s_nop 0
    buffer_load_dwordx4 v6, s[20:23], s52 offen offset:0 lds
    buffer_load_dwordx4 v6, s[20:23], s52 offen offset:1024 lds
    buffer_load_dwordx4 v6, s[20:23], s52 offen offset:2048 lds
    buffer_load_dwordx4 v6, s[20:23], s52 offen offset:3072 lds
    s_add_u32 s52, s52, 9216
    s_mov_b32 m0, 135168
    s_nop 0
    buffer_load_dwordx4 v6, s[20:23], s52 offen offset:0 lds
    buffer_load_dwordx4 v6, s[20:23], s52 offen offset:1024 lds
    buffer_load_dwordx4 v6, s[20:23], s52 offen offset:2048 lds
    buffer_load_dwordx4 v6, s[20:23], s52 offen offset:3072 lds
    s_add_u32 s52, s52, 9216
    s_waitcnt vmcnt(16)
    s_barrier
    s_mov_b32 m0, 13312
    s_nop 0
    buffer_load_dwordx4 v6, s[20:23], s52 offen offset:0 lds
    buffer_load_dwordx4 v6, s[20:23], s52 offen offset:1024 lds
    buffer_load_dwordx4 v6, s[20:23], s52 offen offset:2048 lds
    buffer_load_dwordx4 v6, s[20:23], s52 offen offset:3072 lds
    s_add_u32 s52, s52, 9216
    s_mov_b32 m0, 30720
    s_nop 0
    buffer_load_dwordx4 v6, s[20:23], s52 offen offset:0 lds
    buffer_load_dwordx4 v6, s[20:23], s52 offen offset:1024 lds
    buffer_load_dwordx4 v6, s[20:23], s52 offen offset:2048 lds
    buffer_load_dwordx4 v6, s[20:23], s52 offen offset:3072 lds
    s_add_u32 s52, s52, 9216
    s_waitcnt vmcnt(16)
    s_barrier
    s_mov_b32 m0, 48128
    s_nop 0
    buffer_load_dwordx4 v6, s[20:23], s52 offen offset:0 lds
    buffer_load_dwordx4 v6, s[20:23], s52 offen offset:1024 lds
    buffer_load_dwordx4 v6, s[20:23], s52 offen offset:2048 lds
    buffer_load_dwordx4 v6, s[20:23], s52 offen offset:3072 lds
    s_add_u32 s52, s52, 9216
    s_mov_b32 m0, 65536
    s_nop 0
    buffer_load_dwordx4 v6, s[20:23], s52 offen offset:0 lds
    buffer_load_dwordx4 v6, s[20:23], s52 offen offset:1024 lds
    buffer_load_dwordx4 v6, s[20:23], s52 offen offset:2048 lds
    buffer_load_dwordx4 v6, s[20:23], s52 offen offset:3072 lds
    s_add_u32 s52, s52, 9216
    s_waitcnt vmcnt(16)
    s_barrier
    s_mov_b32 m0, 82944
    s_nop 0
    buffer_load_dwordx4 v6, s[20:23], s52 offen offset:0 lds
    buffer_load_dwordx4 v6, s[20:23], s52 offen offset:1024 lds
    buffer_load_dwordx4 v6, s[20:23], s52 offen offset:2048 lds
    buffer_load_dwordx4 v6, s[20:23], s52 offen offset:3072 lds
    s_add_u32 s52, s52, 9216
    s_mov_b32 m0, 100352
    s_nop 0
    buffer_load_dwordx4 v6, s[20:23], s52 offen offset:0 lds
    buffer_load_dwordx4 v6, s[20:23], s52 offen offset:1024 lds
    buffer_load_dwordx4 v6, s[20:23], s52 offen offset:2048 lds
    buffer_load_dwordx4 v6, s[20:23], s52 offen offset:3072 lds
    s_add_u32 s52, s52, 9216
    s_waitcnt vmcnt(16)
    s_barrier
    s_mov_b32 m0, 117760
    s_nop 0
    buffer_load_dwordx4 v6, s[20:23], s52 offen offset:0 lds
    buffer_load_dwordx4 v6, s[20:23], s52 offen offset:1024 lds
    buffer_load_dwordx4 v6, s[20:23], s52 offen offset:2048 lds
    buffer_load_dwordx4 v6, s[20:23], s52 offen offset:3072 lds
    s_add_u32 s52, s52, 9216
    s_mov_b32 m0, 135168
    s_nop 0
    buffer_load_dwordx4 v6, s[20:23], s52 offen offset:0 lds
    buffer_load_dwordx4 v6, s[20:23], s52 offen offset:1024 lds
    buffer_load_dwordx4 v6, s[20:23], s52 offen offset:2048 lds
    buffer_load_dwordx4 v6, s[20:23], s52 offen offset:3072 lds
    s_add_u32 s52, s52, 9216
    s_waitcnt vmcnt(16)
    s_barrier
    s_mov_b32 m0, 13312
    s_nop 0
    buffer_load_dwordx4 v6, s[20:23], s52 offen offset:0 lds
    buffer_load_dwordx4 v6, s[20:23], s52 offen offset:1024 lds
    buffer_load_dwordx4 v6, s[20:23], s52 offen offset:2048 lds
    buffer_load_dwordx4 v6, s[20:23], s52 offen offset:3072 lds
    s_add_u32 s52, s52, 9216
    s_mov_b32 m0, 30720
    s_nop 0
    buffer_load_dwordx4 v6, s[20:23], s52 offen offset:0 lds
    buffer_load_dwordx4 v6, s[20:23], s52 offen offset:1024 lds
    buffer_load_dwordx4 v6, s[20:23], s52 offen offset:2048 lds
    buffer_load_dwordx4 v6, s[20:23], s52 offen offset:3072 lds
    s_add_u32 s52, s52, 9216
    s_waitcnt vmcnt(16)
    s_barrier
    s_mov_b32 m0, 48128
    s_nop 0
    buffer_load_dwordx4 v6, s[20:23], s52 offen offset:0 lds
    buffer_load_dwordx4 v6, s[20:23], s52 offen offset:1024 lds
    buffer_load_dwordx4 v6, s[20:23], s52 offen offset:2048 lds
    buffer_load_dwordx4 v6, s[20:23], s52 offen offset:3072 lds
    s_add_u32 s52, s52, 9216
    s_mov_b32 m0, 65536
    s_nop 0
    buffer_load_dwordx4 v6, s[20:23], s52 offen offset:0 lds
    buffer_load_dwordx4 v6, s[20:23], s52 offen offset:1024 lds
    buffer_load_dwordx4 v6, s[20:23], s52 offen offset:2048 lds
    buffer_load_dwordx4 v6, s[20:23], s52 offen offset:3072 lds
    s_add_u32 s52, s52, 9216
    s_waitcnt vmcnt(16)
    s_barrier
    s_waitcnt vmcnt(8)
    s_barrier
    s_waitcnt vmcnt(0)
    s_barrier
    s_waitcnt vmcnt(0)
    s_barrier
    s_waitcnt vmcnt(0)
    s_barrier
    s_waitcnt vmcnt(0)
    s_barrier
    s_endpgm
L_k3end_17:
    s_endpgm
.section .rodata,"a"
.p2align 6
.amdhsa_kernel k1_kernel
  .amdhsa_next_free_vgpr 256
  .amdhsa_next_free_sgpr 102
  .amdhsa_accum_offset 256
  .amdhsa_group_segment_fixed_size 0
  .amdhsa_kernarg_size 88
  .amdhsa_user_sgpr_count 2
  .amdhsa_user_sgpr_kernarg_segment_ptr 1
  .amdhsa_system_sgpr_workgroup_id_x 1
.end_amdhsa_kernel
.p2align 6
.amdhsa_kernel k3_kernel
  .amdhsa_next_free_vgpr 256
  .amdhsa_next_free_sgpr 102
  .amdhsa_accum_offset 256
  .amdhsa_group_segment_fixed_size 0
  .amdhsa_kernarg_size 88
  .amdhsa_user_sgpr_count 2
  .amdhsa_user_sgpr_kernarg_segment_ptr 1
  .amdhsa_system_sgpr_workgroup_id_x 1
.end_amdhsa_kernel
```
